```python
import torch

def _softmax(x, axis=-1):
    return torch.softmax(x, dim=axis)
def _gelu(x):
    return torch.nn.functional.gelu(x, approximate="tanh")
def _silu(x):
    return torch.nn.functional.silu(x)
def _sigmoid(x):
    return torch.sigmoid(x)
def _layernorm(x, axis=-1, eps=1e-5):
    m = x.mean(dim=axis, keepdim=True)
    v = x.var(dim=axis, keepdim=True, unbiased=False)
    return (x - m) / torch.sqrt(v + eps)
def _scatter_add(tgt, idx, src, axis=0):
    return tgt.clone().index_add_(axis, idx, src)
def _segment_sum(src, seg, n):
    out = torch.zeros((n,) + src.shape[1:], dtype=src.dtype)
    return out.index_add_(0, seg, src)
def _pad(x, pw):
    flat = tuple(v for pair in reversed(pw) for v in pair)
    return torch.nn.functional.pad(x, flat)

kernel_name = 'gated_mix__mha_block__dense_activation_squared_relu__prompt'

def setup_inputs():

    _w = (lambda a: (lambda t: t.to(torch.bfloat16) if t.is_floating_point() else t)(torch.as_tensor(a)))
    def _A_setup():
        B, S, D, H = 1, 2048, 640, 32
        return {
            "x": _w((lambda *s: torch.randn(*s, dtype=torch.bfloat16) * 0.05)(B, S, D)),
            "wqkv": _w((lambda *s: torch.randn(*s, dtype=torch.bfloat16) * 0.8)(D, 3 * D)),
            "wo": _w((lambda *s: torch.randn(*s, dtype=torch.bfloat16) * 0.1)(D, D)),
        }
    _A_in = _A_setup()

    def _B_setup():
        B, S, D, F = 1, 2048, 640, 1536
        return {
            "x": _w((lambda *s: torch.randn(*s, dtype=torch.bfloat16) * 0.05)(B, S, D)),
            "w1": _w((lambda *s: torch.randn(*s, dtype=torch.bfloat16) * 0.1)(D, F)),
            "b1": _w((lambda *s: torch.randn(*s, dtype=torch.bfloat16) * 0.1)(F)),
            "w2": _w((lambda *s: torch.randn(*s, dtype=torch.bfloat16) * 0.1)(F, D)),
            "b2": _w((lambda *s: torch.randn(*s, dtype=torch.bfloat16) * 0.05)(D)),
        }
    _B_in = _B_setup()

    return {
        "A_x": _A_in["x"],
        "A_wqkv": _A_in["wqkv"],
        "A_wo": _A_in["wo"],
        "B_x": _B_in["x"],
        "B_w1": _B_in["w1"],
        "B_b1": _B_in["b1"],
        "B_w2": _B_in["w2"],
        "B_b2": _B_in["b2"],
        "gate_w": _w((lambda *s: torch.randn(*s, dtype=torch.bfloat16) * 0.05)(640) * 16.0),
    }

def reference(A_x, A_wqkv, A_wo, B_x, B_w1, B_b1, B_w2, B_b2, gate_w):
    def _A_ref(x, wqkv, wo):
        B, S, D = x.shape
        H = 32
        Dh = D // H
        qkv = (lambda x, *d: x.permute(*d))((x @ wqkv).reshape(B, S, 3, H, Dh), 2, 0, 3, 1, 4)
        q, k, v = qkv[0], qkv[1], qkv[2]
        scores = torch.einsum("bhqd,bhkd->bhqk", q, k) * (Dh ** -0.5)
        p = _softmax(scores, axis=-1)
        o = torch.einsum("bhqk,bhkd->bhqd", p, v)
        return (lambda x, *d: x.permute(*d))(o, 0, 2, 1, 3).reshape(B, S, D) @ wo

    def _B_ref(x, w1, b1, w2, b2):
        h = torch.einsum("bsd,df->bsf", x, w1) + b1
        zero = torch.zeros_like(h)
        r = torch.where(h > zero, h, zero)
        h = r * r
        out = torch.einsum("bsf,fd->bsd", h, w2) + b2
        return out

    x = A_x
    g = _sigmoid((x * gate_w).sum(-1, keepdims=True))
    a = _A_ref(x, A_wqkv, A_wo)
    b = _B_ref(x, B_w1, B_b1, B_w2, B_b2)
    return g * a + (1 - g) * b
```

```asm
; @launch kernel=fz_kernel grid=(512,1,1) block=(512,1,1) lds=81920
.amdgcn_target "amdgcn-amd-amdhsa--gfx950"
.text
.globl fz_kernel
.p2align 8
.type fz_kernel,@function
fz_kernel:
    s_cmp_ge_u32 s2, 512
    s_cbranch_scc1 fz_exit
    v_lshrrev_b32 v1, 6, v0
    v_and_b32 v0, 63, v0
    v_readfirstlane_b32 s20, v1
    s_cmp_ge_u32 s2, 256
    s_cbranch_scc1 fz_F
    s_load_dwordx2 s[4:5], s[0:1], 0
    s_load_dwordx2 s[6:7], s[0:1], 8
    s_load_dwordx2 s[50:51], s[0:1], 88
    s_load_dwordx2 s[56:57], s[0:1], 64
    s_load_dwordx2 s[90:91], s[0:1], 80
    s_and_b32 s24, s2, 7
    s_lshr_b32 s25, s2, 3
    s_and_b32 s26, s24, 3
    s_lshl_b32 s26, s26, 2
    s_and_b32 s27, s25, 3
    s_add_u32 s41, s26, s27
    s_lshr_b32 s26, s24, 2
    s_lshl_b32 s26, s26, 3
    s_lshr_b32 s27, s25, 2
    s_add_u32 s40, s26, s27
    s_mul_i32 s24, s41, 3
    s_add_u32 s24, s24, s40
    s_mul_i32 s25, s24, 6554
    s_lshr_b32 s25, s25, 16
    s_mul_i32 s25, s25, 10
    s_sub_u32 s48, s24, s25
    s_mul_i32 s21, s41, 163840
    s_lshl_b32 s22, s40, 8
    s_cmp_ge_u32 s20, 4
    s_cbranch_scc0 a1_c
    s_setprio 3
    s_sub_u32 s24, s20, 4
    v_lshrrev_b32 v20, 3, v0
    v_and_b32 v21, 7, v0
    s_lshl_b32 s25, s24, 5
    v_add_u32 v22, s25, v20
    v_bfe_u32 v23, v22, 1, 3
    v_xor_b32 v23, v23, v21
    v_lshlrev_b32 v23, 4, v23
    v_mul_u32_u24 v22, 1280, v22
    v_add_u32 v2, v22, v23
    v_add_u32 v22, s25, v20
    v_add_u32 v22, 8, v22
    v_bfe_u32 v23, v22, 1, 3
    v_xor_b32 v23, v23, v21
    v_lshlrev_b32 v23, 4, v23
    v_mul_u32_u24 v22, 1280, v22
    v_add_u32 v3, v22, v23
    v_subrev_u32 v3, 1024, v3
    v_add_u32 v22, s25, v20
    v_add_u32 v22, 16, v22
    v_bfe_u32 v23, v22, 1, 3
    v_xor_b32 v23, v23, v21
    v_lshlrev_b32 v23, 4, v23
    v_mul_u32_u24 v22, 1280, v22
    v_add_u32 v4, v22, v23
    v_subrev_u32 v4, 2048, v4
    v_add_u32 v22, s25, v20
    v_add_u32 v22, 24, v22
    v_bfe_u32 v23, v22, 1, 3
    v_xor_b32 v23, v23, v21
    v_lshlrev_b32 v23, 4, v23
    v_mul_u32_u24 v22, 1280, v22
    v_add_u32 v5, v22, v23
    v_subrev_u32 v5, 3072, v5
    s_mul_i32 s25, s24, 128
    v_add_u32 v22, s25, v0
    v_lshrrev_b32 v23, 4, v22
    v_and_b32 v22, 15, v22
    v_and_b32 v20, 3, v23
    v_lshlrev_b32 v20, 2, v20
    v_xor_b32 v22, v22, v20
    v_lshlrev_b32 v22, 4, v22
    v_mul_u32_u24 v23, 3840, v23
    v_add_u32 v6, v22, v23
    v_add_u32 v22, s25, v0
    v_add_u32 v22, 64, v22
    v_lshrrev_b32 v23, 4, v22
    v_and_b32 v22, 15, v22
    v_and_b32 v20, 3, v23
    v_lshlrev_b32 v20, 2, v20
    v_xor_b32 v22, v22, v20
    v_lshlrev_b32 v22, 4, v22
    v_mul_u32_u24 v23, 3840, v23
    v_add_u32 v7, v22, v23
    v_subrev_u32 v7, 1024, v7
    s_lshl_b32 s26, s24, 12
    s_mul_i32 s27, s24, 2048
    s_add_u32 s27, s27, 49152
    s_waitcnt lgkmcnt(0)
    s_mov_b32 s8, s4
    s_and_b32 s9, s5, 0xffff
    s_mov_b32 s10, 2621440
    s_mov_b32 s11, 0x20000
    s_mov_b32 s12, s6
    s_and_b32 s13, s7, 0xffff
    s_mov_b32 s14, 2457600
    s_mov_b32 s15, 0x20000
    s_add_u32 s32, s48, 0
    s_cmp_ge_u32 s32, 10
    s_cselect_b32 s33, 10, 0
    s_sub_u32 s32, s32, s33
    s_lshl_b32 s64, s32, 7
    s_add_u32 s64, s64, s21
    s_add_u32 s65, s26, 0
    s_mov_b32 m0, s65
    s_nop 0
    buffer_load_dwordx4 v2, s[8:11], s64 offen offset:0 lds
    buffer_load_dwordx4 v3, s[8:11], s64 offen offset:1024 lds
    buffer_load_dwordx4 v4, s[8:11], s64 offen offset:2048 lds
    buffer_load_dwordx4 v5, s[8:11], s64 offen offset:3072 lds
    s_add_u32 s32, s48, 0
    s_cmp_ge_u32 s32, 10
    s_cselect_b32 s33, 10, 0
    s_sub_u32 s32, s32, s33
    s_lshl_b32 s32, s32, 1
    s_mul_i32 s66, s32, 122880
    s_add_u32 s66, s66, s22
    s_add_u32 s67, s27, 0
    s_mov_b32 m0, s67
    s_nop 0
    buffer_load_dwordx4 v6, s[12:15], s66 offen lds
    buffer_load_dwordx4 v7, s[12:15], s66 offen offset:1024 lds
    s_add_u32 s32, s48, 0
    s_cmp_ge_u32 s32, 10
    s_cselect_b32 s33, 10, 0
    s_sub_u32 s32, s32, s33
    s_lshl_b32 s32, s32, 1
    s_add_u32 s32, s32, 1
    s_mul_i32 s68, s32, 122880
    s_add_u32 s68, s68, s22
    s_add_u32 s69, s27, 8192
    s_mov_b32 m0, s69
    s_nop 0
    buffer_load_dwordx4 v6, s[12:15], s68 offen lds
    buffer_load_dwordx4 v7, s[12:15], s68 offen offset:1024 lds
    s_add_u32 s32, s48, 1
    s_cmp_ge_u32 s32, 10
    s_cselect_b32 s33, 10, 0
    s_sub_u32 s32, s32, s33
    s_lshl_b32 s64, s32, 7
    s_add_u32 s64, s64, s21
    s_add_u32 s65, s26, 16384
    s_mov_b32 m0, s65
    s_nop 0
    buffer_load_dwordx4 v2, s[8:11], s64 offen offset:0 lds
    buffer_load_dwordx4 v3, s[8:11], s64 offen offset:1024 lds
    buffer_load_dwordx4 v4, s[8:11], s64 offen offset:2048 lds
    buffer_load_dwordx4 v5, s[8:11], s64 offen offset:3072 lds
    s_add_u32 s32, s48, 1
    s_cmp_ge_u32 s32, 10
    s_cselect_b32 s33, 10, 0
    s_sub_u32 s32, s32, s33
    s_lshl_b32 s32, s32, 1
    s_mul_i32 s66, s32, 122880
    s_add_u32 s66, s66, s22
    s_add_u32 s67, s27, 16384
    s_mov_b32 m0, s67
    s_nop 0
    buffer_load_dwordx4 v6, s[12:15], s66 offen lds
    buffer_load_dwordx4 v7, s[12:15], s66 offen offset:1024 lds
    s_add_u32 s32, s48, 1
    s_cmp_ge_u32 s32, 10
    s_cselect_b32 s33, 10, 0
    s_sub_u32 s32, s32, s33
    s_lshl_b32 s32, s32, 1
    s_add_u32 s32, s32, 1
    s_mul_i32 s68, s32, 122880
    s_add_u32 s68, s68, s22
    s_add_u32 s69, s27, 24576
    s_mov_b32 m0, s69
    s_nop 0
    buffer_load_dwordx4 v6, s[12:15], s68 offen lds
    buffer_load_dwordx4 v7, s[12:15], s68 offen offset:1024 lds
    s_add_u32 s32, s48, 2
    s_cmp_ge_u32 s32, 10
    s_cselect_b32 s33, 10, 0
    s_sub_u32 s32, s32, s33
    s_lshl_b32 s64, s32, 7
    s_add_u32 s64, s64, s21
    s_add_u32 s65, s26, 32768
    s_mov_b32 m0, s65
    s_nop 0
    buffer_load_dwordx4 v2, s[8:11], s64 offen offset:0 lds
    buffer_load_dwordx4 v3, s[8:11], s64 offen offset:1024 lds
    buffer_load_dwordx4 v4, s[8:11], s64 offen offset:2048 lds
    buffer_load_dwordx4 v5, s[8:11], s64 offen offset:3072 lds
    s_waitcnt vmcnt(14)
    s_barrier
    s_waitcnt vmcnt(12)
    s_barrier
    s_add_u32 s32, s48, 2
    s_cmp_ge_u32 s32, 10
    s_cselect_b32 s33, 10, 0
    s_sub_u32 s32, s32, s33
    s_lshl_b32 s32, s32, 1
    s_mul_i32 s66, s32, 122880
    s_add_u32 s66, s66, s22
    s_add_u32 s67, s27, 0
    s_waitcnt vmcnt(6)
    s_barrier
    s_mov_b32 m0, s67
    s_nop 0
    buffer_load_dwordx4 v6, s[12:15], s66 offen lds
    buffer_load_dwordx4 v7, s[12:15], s66 offen offset:1024 lds
    s_add_u32 s32, s48, 3
    s_cmp_ge_u32 s32, 10
    s_cselect_b32 s33, 10, 0
    s_sub_u32 s32, s32, s33
    s_lshl_b32 s68, s32, 7
    s_add_u32 s68, s68, s21
    s_add_u32 s69, s26, 0
    s_add_u32 s32, s48, 2
    s_cmp_ge_u32 s32, 10
    s_cselect_b32 s33, 10, 0
    s_sub_u32 s32, s32, s33
    s_lshl_b32 s32, s32, 1
    s_add_u32 s32, s32, 1
    s_mul_i32 s64, s32, 122880
    s_add_u32 s64, s64, s22
    s_add_u32 s65, s27, 8192
    s_waitcnt vmcnt(6)
    s_barrier
    s_mov_b32 m0, s69
    s_nop 0
    buffer_load_dwordx4 v2, s[8:11], s68 offen offset:0 lds
    buffer_load_dwordx4 v3, s[8:11], s68 offen offset:1024 lds
    buffer_load_dwordx4 v4, s[8:11], s68 offen offset:2048 lds
    buffer_load_dwordx4 v5, s[8:11], s68 offen offset:3072 lds
    s_mov_b32 m0, s65
    s_nop 0
    buffer_load_dwordx4 v6, s[12:15], s64 offen lds
    buffer_load_dwordx4 v7, s[12:15], s64 offen offset:1024 lds
    s_add_u32 s32, s48, 3
    s_cmp_ge_u32 s32, 10
    s_cselect_b32 s33, 10, 0
    s_sub_u32 s32, s32, s33
    s_lshl_b32 s32, s32, 1
    s_mul_i32 s66, s32, 122880
    s_add_u32 s66, s66, s22
    s_add_u32 s67, s27, 16384
    s_waitcnt vmcnt(6)
    s_barrier
    s_mov_b32 m0, s67
    s_nop 0
    buffer_load_dwordx4 v6, s[12:15], s66 offen lds
    buffer_load_dwordx4 v7, s[12:15], s66 offen offset:1024 lds
    s_add_u32 s32, s48, 4
    s_cmp_ge_u32 s32, 10
    s_cselect_b32 s33, 10, 0
    s_sub_u32 s32, s32, s33
    s_lshl_b32 s68, s32, 7
    s_add_u32 s68, s68, s21
    s_add_u32 s69, s26, 16384
    s_add_u32 s32, s48, 3
    s_cmp_ge_u32 s32, 10
    s_cselect_b32 s33, 10, 0
    s_sub_u32 s32, s32, s33
    s_lshl_b32 s32, s32, 1
    s_add_u32 s32, s32, 1
    s_mul_i32 s64, s32, 122880
    s_add_u32 s64, s64, s22
    s_add_u32 s65, s27, 24576
    s_waitcnt vmcnt(2)
    s_barrier
    s_mov_b32 m0, s69
    s_nop 0
    buffer_load_dwordx4 v2, s[8:11], s68 offen offset:0 lds
    buffer_load_dwordx4 v3, s[8:11], s68 offen offset:1024 lds
    buffer_load_dwordx4 v4, s[8:11], s68 offen offset:2048 lds
    buffer_load_dwordx4 v5, s[8:11], s68 offen offset:3072 lds
    s_mov_b32 m0, s65
    s_nop 0
    buffer_load_dwordx4 v6, s[12:15], s64 offen lds
    buffer_load_dwordx4 v7, s[12:15], s64 offen offset:1024 lds
    s_add_u32 s32, s48, 4
    s_cmp_ge_u32 s32, 10
    s_cselect_b32 s33, 10, 0
    s_sub_u32 s32, s32, s33
    s_lshl_b32 s32, s32, 1
    s_mul_i32 s66, s32, 122880
    s_add_u32 s66, s66, s22
    s_add_u32 s67, s27, 0
    s_waitcnt vmcnt(6)
    s_barrier
    s_mov_b32 m0, s67
    s_nop 0
    buffer_load_dwordx4 v6, s[12:15], s66 offen lds
    buffer_load_dwordx4 v7, s[12:15], s66 offen offset:1024 lds
    s_add_u32 s32, s48, 5
    s_cmp_ge_u32 s32, 10
    s_cselect_b32 s33, 10, 0
    s_sub_u32 s32, s32, s33
    s_lshl_b32 s68, s32, 7
    s_add_u32 s68, s68, s21
    s_add_u32 s69, s26, 32768
    s_add_u32 s32, s48, 4
    s_cmp_ge_u32 s32, 10
    s_cselect_b32 s33, 10, 0
    s_sub_u32 s32, s32, s33
    s_lshl_b32 s32, s32, 1
    s_add_u32 s32, s32, 1
    s_mul_i32 s64, s32, 122880
    s_add_u32 s64, s64, s22
    s_add_u32 s65, s27, 8192
    s_waitcnt vmcnt(2)
    s_barrier
    s_mov_b32 m0, s69
    s_nop 0
    buffer_load_dwordx4 v2, s[8:11], s68 offen offset:0 lds
    buffer_load_dwordx4 v3, s[8:11], s68 offen offset:1024 lds
    buffer_load_dwordx4 v4, s[8:11], s68 offen offset:2048 lds
    buffer_load_dwordx4 v5, s[8:11], s68 offen offset:3072 lds
    s_mov_b32 m0, s65
    s_nop 0
    buffer_load_dwordx4 v6, s[12:15], s64 offen lds
    buffer_load_dwordx4 v7, s[12:15], s64 offen offset:1024 lds
    s_add_u32 s32, s48, 5
    s_cmp_ge_u32 s32, 10
    s_cselect_b32 s33, 10, 0
    s_sub_u32 s32, s32, s33
    s_lshl_b32 s32, s32, 1
    s_mul_i32 s66, s32, 122880
    s_add_u32 s66, s66, s22
    s_add_u32 s67, s27, 16384
    s_waitcnt vmcnt(6)
    s_barrier
    s_mov_b32 m0, s67
    s_nop 0
    buffer_load_dwordx4 v6, s[12:15], s66 offen lds
    buffer_load_dwordx4 v7, s[12:15], s66 offen offset:1024 lds
    s_cmp_lg_u32 s2, 0
    s_cbranch_scc1 a1l_ng
    s_cmp_lg_u32 s20, 4
    s_cbranch_scc1 a1l_ng
    s_memrealtime s[88:89]
    s_load_dwordx2 s[90:91], s[0:1], 80
    s_waitcnt lgkmcnt(0)
    s_or_b32 s88, s88, 1
    v_mov_b32 v30, 0
    v_mov_b32 v31, s88
    s_mov_b64 exec, 1
    global_store_dword v30, v31, s[90:91] sc1
    s_mov_b64 exec, -1
a1l_ng:
    s_add_u32 s32, s48, 6
    s_cmp_ge_u32 s32, 10
    s_cselect_b32 s33, 10, 0
    s_sub_u32 s32, s32, s33
    s_lshl_b32 s68, s32, 7
    s_add_u32 s68, s68, s21
    s_add_u32 s69, s26, 0
    s_add_u32 s32, s48, 5
    s_cmp_ge_u32 s32, 10
    s_cselect_b32 s33, 10, 0
    s_sub_u32 s32, s32, s33
    s_lshl_b32 s32, s32, 1
    s_add_u32 s32, s32, 1
    s_mul_i32 s64, s32, 122880
    s_add_u32 s64, s64, s22
    s_add_u32 s65, s27, 24576
    s_waitcnt vmcnt(2)
    s_barrier
    s_mov_b32 m0, s69
    s_nop 0
    buffer_load_dwordx4 v2, s[8:11], s68 offen offset:0 lds
    buffer_load_dwordx4 v3, s[8:11], s68 offen offset:1024 lds
    buffer_load_dwordx4 v4, s[8:11], s68 offen offset:2048 lds
    buffer_load_dwordx4 v5, s[8:11], s68 offen offset:3072 lds
    s_mov_b32 m0, s65
    s_nop 0
    buffer_load_dwordx4 v6, s[12:15], s64 offen lds
    buffer_load_dwordx4 v7, s[12:15], s64 offen offset:1024 lds
    s_add_u32 s32, s48, 6
    s_cmp_ge_u32 s32, 10
    s_cselect_b32 s33, 10, 0
    s_sub_u32 s32, s32, s33
    s_lshl_b32 s32, s32, 1
    s_mul_i32 s66, s32, 122880
    s_add_u32 s66, s66, s22
    s_add_u32 s67, s27, 0
    s_waitcnt vmcnt(6)
    s_barrier
    s_mov_b32 m0, s67
    s_nop 0
    buffer_load_dwordx4 v6, s[12:15], s66 offen lds
    buffer_load_dwordx4 v7, s[12:15], s66 offen offset:1024 lds
    s_add_u32 s32, s48, 7
    s_cmp_ge_u32 s32, 10
    s_cselect_b32 s33, 10, 0
    s_sub_u32 s32, s32, s33
    s_lshl_b32 s68, s32, 7
    s_add_u32 s68, s68, s21
    s_add_u32 s69, s26, 16384
    s_add_u32 s32, s48, 6
    s_cmp_ge_u32 s32, 10
    s_cselect_b32 s33, 10, 0
    s_sub_u32 s32, s32, s33
    s_lshl_b32 s32, s32, 1
    s_add_u32 s32, s32, 1
    s_mul_i32 s64, s32, 122880
    s_add_u32 s64, s64, s22
    s_add_u32 s65, s27, 8192
    s_waitcnt vmcnt(2)
    s_barrier
    s_mov_b32 m0, s69
    s_nop 0
    buffer_load_dwordx4 v2, s[8:11], s68 offen offset:0 lds
    buffer_load_dwordx4 v3, s[8:11], s68 offen offset:1024 lds
    buffer_load_dwordx4 v4, s[8:11], s68 offen offset:2048 lds
    buffer_load_dwordx4 v5, s[8:11], s68 offen offset:3072 lds
    s_mov_b32 m0, s65
    s_nop 0
    buffer_load_dwordx4 v6, s[12:15], s64 offen lds
    buffer_load_dwordx4 v7, s[12:15], s64 offen offset:1024 lds
    s_add_u32 s32, s48, 7
    s_cmp_ge_u32 s32, 10
    s_cselect_b32 s33, 10, 0
    s_sub_u32 s32, s32, s33
    s_lshl_b32 s32, s32, 1
    s_mul_i32 s66, s32, 122880
    s_add_u32 s66, s66, s22
    s_add_u32 s67, s27, 16384
    s_waitcnt vmcnt(6)
    s_barrier
    s_mov_b32 m0, s67
    s_nop 0
    buffer_load_dwordx4 v6, s[12:15], s66 offen lds
    buffer_load_dwordx4 v7, s[12:15], s66 offen offset:1024 lds
    s_add_u32 s32, s48, 8
    s_cmp_ge_u32 s32, 10
    s_cselect_b32 s33, 10, 0
    s_sub_u32 s32, s32, s33
    s_lshl_b32 s68, s32, 7
    s_add_u32 s68, s68, s21
    s_add_u32 s69, s26, 32768
    s_add_u32 s32, s48, 7
    s_cmp_ge_u32 s32, 10
    s_cselect_b32 s33, 10, 0
    s_sub_u32 s32, s32, s33
    s_lshl_b32 s32, s32, 1
    s_add_u32 s32, s32, 1
    s_mul_i32 s64, s32, 122880
    s_add_u32 s64, s64, s22
    s_add_u32 s65, s27, 24576
    s_waitcnt vmcnt(2)
    s_barrier
    s_mov_b32 m0, s69
    s_nop 0
    buffer_load_dwordx4 v2, s[8:11], s68 offen offset:0 lds
    buffer_load_dwordx4 v3, s[8:11], s68 offen offset:1024 lds
    buffer_load_dwordx4 v4, s[8:11], s68 offen offset:2048 lds
    buffer_load_dwordx4 v5, s[8:11], s68 offen offset:3072 lds
    s_mov_b32 m0, s65
    s_nop 0
    buffer_load_dwordx4 v6, s[12:15], s64 offen lds
    buffer_load_dwordx4 v7, s[12:15], s64 offen offset:1024 lds
    s_add_u32 s32, s48, 8
    s_cmp_ge_u32 s32, 10
    s_cselect_b32 s33, 10, 0
    s_sub_u32 s32, s32, s33
    s_lshl_b32 s32, s32, 1
    s_mul_i32 s66, s32, 122880
    s_add_u32 s66, s66, s22
    s_add_u32 s67, s27, 0
    s_waitcnt vmcnt(6)
    s_barrier
    s_mov_b32 m0, s67
    s_nop 0
    buffer_load_dwordx4 v6, s[12:15], s66 offen lds
    buffer_load_dwordx4 v7, s[12:15], s66 offen offset:1024 lds
    s_add_u32 s32, s48, 9
    s_cmp_ge_u32 s32, 10
    s_cselect_b32 s33, 10, 0
    s_sub_u32 s32, s32, s33
    s_lshl_b32 s68, s32, 7
    s_add_u32 s68, s68, s21
    s_add_u32 s69, s26, 0
    s_add_u32 s32, s48, 8
    s_cmp_ge_u32 s32, 10
    s_cselect_b32 s33, 10, 0
    s_sub_u32 s32, s32, s33
    s_lshl_b32 s32, s32, 1
    s_add_u32 s32, s32, 1
    s_mul_i32 s64, s32, 122880
    s_add_u32 s64, s64, s22
    s_add_u32 s65, s27, 8192
    s_waitcnt vmcnt(2)
    s_barrier
    s_mov_b32 m0, s69
    s_nop 0
    buffer_load_dwordx4 v2, s[8:11], s68 offen offset:0 lds
    buffer_load_dwordx4 v3, s[8:11], s68 offen offset:1024 lds
    buffer_load_dwordx4 v4, s[8:11], s68 offen offset:2048 lds
    buffer_load_dwordx4 v5, s[8:11], s68 offen offset:3072 lds
    s_mov_b32 m0, s65
    s_nop 0
    buffer_load_dwordx4 v6, s[12:15], s64 offen lds
    buffer_load_dwordx4 v7, s[12:15], s64 offen offset:1024 lds
    s_add_u32 s32, s48, 9
    s_cmp_ge_u32 s32, 10
    s_cselect_b32 s33, 10, 0
    s_sub_u32 s32, s32, s33
    s_lshl_b32 s32, s32, 1
    s_mul_i32 s66, s32, 122880
    s_add_u32 s66, s66, s22
    s_add_u32 s67, s27, 16384
    s_waitcnt vmcnt(6)
    s_barrier
    s_mov_b32 m0, s67
    s_nop 0
    buffer_load_dwordx4 v6, s[12:15], s66 offen lds
    buffer_load_dwordx4 v7, s[12:15], s66 offen offset:1024 lds
    s_add_u32 s32, s48, 9
    s_cmp_ge_u32 s32, 10
    s_cselect_b32 s33, 10, 0
    s_sub_u32 s32, s32, s33
    s_lshl_b32 s32, s32, 1
    s_add_u32 s32, s32, 1
    s_mul_i32 s68, s32, 122880
    s_add_u32 s68, s68, s22
    s_add_u32 s69, s27, 24576
    s_waitcnt vmcnt(2)
    s_barrier
    s_mov_b32 m0, s69
    s_nop 0
    buffer_load_dwordx4 v6, s[12:15], s68 offen lds
    buffer_load_dwordx4 v7, s[12:15], s68 offen offset:1024 lds
    s_waitcnt vmcnt(2)
    s_barrier
    s_waitcnt vmcnt(0)
    s_barrier
    s_branch a1_done
a1_c:
    s_setprio 2
    s_waitcnt lgkmcnt(0)
    s_mov_b32 s16, s50
    s_and_b32 s17, s51, 0xffff
    s_mov_b32 s18, 50331648
    s_mov_b32 s19, 0x20000
    s_cmp_eq_u32 s40, 15
    s_cbranch_scc1 a1_gate
    s_lshr_b32 s42, s20, 1
    s_and_b32 s43, s20, 1
    s_lshl_b32 s24, s42, 6
    v_and_b32 v104, 31, v0
    v_lshrrev_b32 v105, 5, v0
    v_bfe_u32 v106, v104, 1, 3
    v_xor_b32 v106, v106, v105
    v_lshlrev_b32 v106, 4, v106
    v_add_u32 v104, s24, v104
    v_lshlrev_b32 v104, 7, v104
    v_add_u32 v104, v104, v106
    v_xor_b32 v2, 0, v104
    v_xor_b32 v3, 32, v104
    v_xor_b32 v4, 64, v104
    v_xor_b32 v5, 96, v104
    v_lshrrev_b32 v104, 4, v0
    v_and_b32 v105, 15, v0
    v_lshrrev_b32 v106, 2, v105
    v_and_b32 v105, 3, v105
    v_lshrrev_b32 v107, 1, v104
    v_and_b32 v104, 1, v104
    v_lshl_add_u32 v107, v107, 3, v106
    v_mul_u32_u24 v107, 256, v107
    v_lshlrev_b32 v104, 5, v104
    v_lshlrev_b32 v105, 3, v105
    v_add3_u32 v108, v107, v104, v105
    v_lshlrev_b32 v106, 6, v106
    v_add_u32 v108, v108, v106
    v_add_u32 v108, 49152, v108
    s_lshl_b32 s26, s43, 7
    s_add_u32 s27, s26, 0
    v_xor_b32 v6, s27, v108
    s_add_u32 s27, s26, 64
    v_xor_b32 v7, s27, v108
    v_mov_b32 v40, 0
    v_mov_b32 v41, 0
    v_mov_b32 v42, 0
    v_mov_b32 v43, 0
    v_mov_b32 v44, 0
    v_mov_b32 v45, 0
    v_mov_b32 v46, 0
    v_mov_b32 v47, 0
    v_mov_b32 v48, 0
    v_mov_b32 v49, 0
    v_mov_b32 v50, 0
    v_mov_b32 v51, 0
    v_mov_b32 v52, 0
    v_mov_b32 v53, 0
    v_mov_b32 v54, 0
    v_mov_b32 v55, 0
    v_mov_b32 v56, 0
    v_mov_b32 v57, 0
    v_mov_b32 v58, 0
    v_mov_b32 v59, 0
    v_mov_b32 v60, 0
    v_mov_b32 v61, 0
    v_mov_b32 v62, 0
    v_mov_b32 v63, 0
    v_mov_b32 v64, 0
    v_mov_b32 v65, 0
    v_mov_b32 v66, 0
    v_mov_b32 v67, 0
    v_mov_b32 v68, 0
    v_mov_b32 v69, 0
    v_mov_b32 v70, 0
    v_mov_b32 v71, 0
    v_mov_b32 v72, 0
    v_mov_b32 v73, 0
    v_mov_b32 v74, 0
    v_mov_b32 v75, 0
    v_mov_b32 v76, 0
    v_mov_b32 v77, 0
    v_mov_b32 v78, 0
    v_mov_b32 v79, 0
    v_mov_b32 v80, 0
    v_mov_b32 v81, 0
    v_mov_b32 v82, 0
    v_mov_b32 v83, 0
    v_mov_b32 v84, 0
    v_mov_b32 v85, 0
    v_mov_b32 v86, 0
    v_mov_b32 v87, 0
    v_mov_b32 v88, 0
    v_mov_b32 v89, 0
    v_mov_b32 v90, 0
    v_mov_b32 v91, 0
    v_mov_b32 v92, 0
    v_mov_b32 v93, 0
    v_mov_b32 v94, 0
    v_mov_b32 v95, 0
    v_mov_b32 v96, 0
    v_mov_b32 v97, 0
    v_mov_b32 v98, 0
    v_mov_b32 v99, 0
    v_mov_b32 v100, 0
    v_mov_b32 v101, 0
    v_mov_b32 v102, 0
    v_mov_b32 v103, 0
    s_cmp_ge_u32 s40, 10
    s_cbranch_scc1 a1_v
    s_cmp_ge_u32 s40, 5
    s_cselect_b32 s24, 5, 0
    s_cselect_b32 s25, 2621440, 0
    s_mov_b32 s72, 1051011932
    s_sub_u32 s24, s40, s24
    s_lshl_b32 s24, s24, 4
    s_lshl_b32 s26, s43, 3
    s_add_u32 s24, s24, s26
    s_lshl_b32 s26, s41, 2
    s_lshl_b32 s27, s42, 1
    s_add_u32 s26, s26, s27
    s_mul_i32 s26, s26, 1280
    s_add_u32 s73, s25, s26
    s_add_u32 s74, s73, 81920
    v_and_b32 v104, 31, v0
    v_lshrrev_b32 v105, 5, v0
    v_lshlrev_b32 v106, 4, v104
    v_lshlrev_b32 v107, 3, v104
    v_add_u32 v107, 1024, v107
    v_add_u32 v105, s24, v105
    v_add_u32 v116, 0, v105
    v_mul_u32_u24 v117, 52429, v116
    v_lshrrev_b32 v117, 18, v117
    v_mul_u32_u24 v118, 5, v117
    v_sub_u32 v116, v116, v118
    v_mul_u32_u24 v117, 163840, v117
    v_add_u32 v112, v117, v107
    v_lshlrev_b32 v118, 9, v116
    v_add_u32 v118, v118, v117
    v_add_u32 v118, v118, v106
    v_add_u32 v119, 80384, v118
    v_cmp_lt_u32 vcc, 2, v116
    s_nop 1
    v_cndmask_b32 v108, v118, v119, vcc
    v_cmp_eq_u32 s[64:65], 2, v116
    v_add_u32 v116, 2, v105
    v_mul_u32_u24 v117, 52429, v116
    v_lshrrev_b32 v117, 18, v117
    v_mul_u32_u24 v118, 5, v117
    v_sub_u32 v116, v116, v118
    v_mul_u32_u24 v117, 163840, v117
    v_add_u32 v113, v117, v107
    v_lshlrev_b32 v118, 9, v116
    v_add_u32 v118, v118, v117
    v_add_u32 v118, v118, v106
    v_add_u32 v119, 80384, v118
    v_cmp_lt_u32 vcc, 2, v116
    s_nop 1
    v_cndmask_b32 v109, v118, v119, vcc
    v_cmp_eq_u32 s[66:67], 2, v116
    v_add_u32 v116, 4, v105
    v_mul_u32_u24 v117, 52429, v116
    v_lshrrev_b32 v117, 18, v117
    v_mul_u32_u24 v118, 5, v117
    v_sub_u32 v116, v116, v118
    v_mul_u32_u24 v117, 163840, v117
    v_add_u32 v114, v117, v107
    v_lshlrev_b32 v118, 9, v116
    v_add_u32 v118, v118, v117
    v_add_u32 v118, v118, v106
    v_add_u32 v119, 80384, v118
    v_cmp_lt_u32 vcc, 2, v116
    s_nop 1
    v_cndmask_b32 v110, v118, v119, vcc
    v_cmp_eq_u32 s[68:69], 2, v116
    v_add_u32 v116, 6, v105
    v_mul_u32_u24 v117, 52429, v116
    v_lshrrev_b32 v117, 18, v117
    v_mul_u32_u24 v118, 5, v117
    v_sub_u32 v116, v116, v118
    v_mul_u32_u24 v117, 163840, v117
    v_add_u32 v115, v117, v107
    v_lshlrev_b32 v118, 9, v116
    v_add_u32 v118, v118, v117
    v_add_u32 v118, v118, v106
    v_add_u32 v119, 80384, v118
    v_cmp_lt_u32 vcc, 2, v116
    s_nop 1
    v_cndmask_b32 v111, v118, v119, vcc
    v_cmp_eq_u32 s[70:71], 2, v116
    s_mov_b32 s38, 0
    s_mov_b32 s39, 0
    s_barrier
    ds_read_b128 v[8:11], v2 offset:0
    ds_read_b128 v[12:15], v2 offset:4096
    ds_read_b64_tr_b16 v[24:25], v6 offset:0
    ds_read_b64_tr_b16 v[26:27], v6 offset:1024
    ds_read_b64_tr_b16 v[28:29], v7 offset:0
    ds_read_b64_tr_b16 v[30:31], v7 offset:1024
    s_mov_b32 s36, 9
a1_ml1:
    s_waitcnt lgkmcnt(0)
    v_mfma_f32_32x32x16_bf16 v[40:55], v[24:27], v[8:11], v[40:55]
    ds_read_b128 v[16:19], v3 offset:0
    ds_read_b128 v[20:23], v3 offset:4096
    ds_read_b64_tr_b16 v[32:33], v6 offset:4096
    v_mfma_f32_32x32x16_bf16 v[56:71], v[28:31], v[8:11], v[56:71]
    ds_read_b64_tr_b16 v[34:35], v6 offset:5120
    v_mfma_f32_32x32x16_bf16 v[88:103], v[28:31], v[12:15], v[88:103]
    ds_read_b64_tr_b16 v[36:37], v7 offset:4096
    v_mfma_f32_32x32x16_bf16 v[72:87], v[24:27], v[12:15], v[72:87]
    ds_read_b64_tr_b16 v[38:39], v7 offset:5120
    s_add_u32 s38, s38, 8192
    s_cmp_ge_u32 s38, 32768
    s_cselect_b32 s37, 32768, 0
    s_sub_u32 s38, s38, s37
    s_sub_u32 s37, 8192, s37
    v_add_u32 v6, s37, v6
    v_add_u32 v7, s37, v7
    s_waitcnt lgkmcnt(0)
    s_barrier
    v_mfma_f32_32x32x16_bf16 v[40:55], v[32:35], v[16:19], v[40:55]
    ds_read_b128 v[8:11], v4 offset:0
    ds_read_b128 v[12:15], v4 offset:4096
    ds_read_b64_tr_b16 v[24:25], v6 offset:0
    v_mfma_f32_32x32x16_bf16 v[56:71], v[36:39], v[16:19], v[56:71]
    ds_read_b64_tr_b16 v[26:27], v6 offset:1024
    v_mfma_f32_32x32x16_bf16 v[88:103], v[36:39], v[20:23], v[88:103]
    ds_read_b64_tr_b16 v[28:29], v7 offset:0
    v_mfma_f32_32x32x16_bf16 v[72:87], v[32:35], v[20:23], v[72:87]
    ds_read_b64_tr_b16 v[30:31], v7 offset:1024
    s_waitcnt lgkmcnt(0)
    v_mfma_f32_32x32x16_bf16 v[40:55], v[24:27], v[8:11], v[40:55]
    ds_read_b128 v[16:19], v5 offset:0
    ds_read_b128 v[20:23], v5 offset:4096
    ds_read_b64_tr_b16 v[32:33], v6 offset:4096
    v_mfma_f32_32x32x16_bf16 v[56:71], v[28:31], v[8:11], v[56:71]
    ds_read_b64_tr_b16 v[34:35], v6 offset:5120
    v_mfma_f32_32x32x16_bf16 v[88:103], v[28:31], v[12:15], v[88:103]
    ds_read_b64_tr_b16 v[36:37], v7 offset:4096
    v_mfma_f32_32x32x16_bf16 v[72:87], v[24:27], v[12:15], v[72:87]
    ds_read_b64_tr_b16 v[38:39], v7 offset:5120
    s_add_u32 s38, s38, 8192
    s_cmp_ge_u32 s38, 32768
    s_cselect_b32 s37, 32768, 0
    s_sub_u32 s38, s38, s37
    s_sub_u32 s37, 8192, s37
    v_add_u32 v6, s37, v6
    v_add_u32 v7, s37, v7
    s_add_u32 s39, s39, 16384
    s_cmp_ge_u32 s39, 49152
    s_cselect_b32 s37, 49152, 0
    s_sub_u32 s39, s39, s37
    s_sub_u32 s37, 16384, s37
    v_add_u32 v2, s37, v2
    v_add_u32 v3, s37, v3
    v_add_u32 v4, s37, v4
    v_add_u32 v5, s37, v5
    s_waitcnt lgkmcnt(0)
    s_barrier
    v_mfma_f32_32x32x16_bf16 v[40:55], v[32:35], v[16:19], v[40:55]
    ds_read_b128 v[8:11], v2 offset:0
    ds_read_b128 v[12:15], v2 offset:4096
    ds_read_b64_tr_b16 v[24:25], v6 offset:0
    v_mfma_f32_32x32x16_bf16 v[56:71], v[36:39], v[16:19], v[56:71]
    ds_read_b64_tr_b16 v[26:27], v6 offset:1024
    v_mfma_f32_32x32x16_bf16 v[88:103], v[36:39], v[20:23], v[88:103]
    ds_read_b64_tr_b16 v[28:29], v7 offset:0
    v_mfma_f32_32x32x16_bf16 v[72:87], v[32:35], v[20:23], v[72:87]
    ds_read_b64_tr_b16 v[30:31], v7 offset:1024
    s_sub_u32 s36, s36, 1
    s_cmp_lg_u32 s36, 0
    s_cbranch_scc1 a1_ml1
    s_waitcnt lgkmcnt(0)
    v_mfma_f32_32x32x16_bf16 v[40:55], v[24:27], v[8:11], v[40:55]
    ds_read_b128 v[16:19], v3 offset:0
    ds_read_b128 v[20:23], v3 offset:4096
    ds_read_b64_tr_b16 v[32:33], v6 offset:4096
    v_mfma_f32_32x32x16_bf16 v[56:71], v[28:31], v[8:11], v[56:71]
    ds_read_b64_tr_b16 v[34:35], v6 offset:5120
    v_mfma_f32_32x32x16_bf16 v[88:103], v[28:31], v[12:15], v[88:103]
    ds_read_b64_tr_b16 v[36:37], v7 offset:4096
    v_mfma_f32_32x32x16_bf16 v[72:87], v[24:27], v[12:15], v[72:87]
    ds_read_b64_tr_b16 v[38:39], v7 offset:5120
    s_add_u32 s38, s38, 8192
    s_cmp_ge_u32 s38, 32768
    s_cselect_b32 s37, 32768, 0
    s_sub_u32 s38, s38, s37
    s_sub_u32 s37, 8192, s37
    v_add_u32 v6, s37, v6
    v_add_u32 v7, s37, v7
    s_waitcnt lgkmcnt(0)
    s_barrier
    v_mfma_f32_32x32x16_bf16 v[40:55], v[32:35], v[16:19], v[40:55]
    ds_read_b128 v[8:11], v4 offset:0
    ds_read_b128 v[12:15], v4 offset:4096
    ds_read_b64_tr_b16 v[24:25], v6 offset:0
    v_mfma_f32_32x32x16_bf16 v[56:71], v[36:39], v[16:19], v[56:71]
    ds_read_b64_tr_b16 v[26:27], v6 offset:1024
    v_mfma_f32_32x32x16_bf16 v[88:103], v[36:39], v[20:23], v[88:103]
    ds_read_b64_tr_b16 v[28:29], v7 offset:0
    v_mfma_f32_32x32x16_bf16 v[72:87], v[32:35], v[20:23], v[72:87]
    ds_read_b64_tr_b16 v[30:31], v7 offset:1024
    s_waitcnt lgkmcnt(0)
    v_mfma_f32_32x32x16_bf16 v[40:55], v[24:27], v[8:11], v[40:55]
    ds_read_b128 v[16:19], v5 offset:0
    ds_read_b128 v[20:23], v5 offset:4096
    ds_read_b64_tr_b16 v[32:33], v6 offset:4096
    v_mfma_f32_32x32x16_bf16 v[56:71], v[28:31], v[8:11], v[56:71]
    ds_read_b64_tr_b16 v[34:35], v6 offset:5120
    v_mfma_f32_32x32x16_bf16 v[88:103], v[28:31], v[12:15], v[88:103]
    ds_read_b64_tr_b16 v[36:37], v7 offset:4096
    v_mfma_f32_32x32x16_bf16 v[72:87], v[24:27], v[12:15], v[72:87]
    ds_read_b64_tr_b16 v[38:39], v7 offset:5120
    s_waitcnt lgkmcnt(0)
    v_mfma_f32_32x32x16_bf16 v[40:55], v[32:35], v[16:19], v[40:55]
    v_mfma_f32_32x32x16_bf16 v[56:71], v[36:39], v[16:19], v[56:71]
    v_mfma_f32_32x32x16_bf16 v[88:103], v[36:39], v[20:23], v[88:103]
    v_mfma_f32_32x32x16_bf16 v[72:87], v[32:35], v[20:23], v[72:87]
    v_mov_b32 v124, 0
    global_load_dword v125, v124, s[90:91] sc1
    s_nop 7
    s_cmp_ge_u32 s40, 5
    s_cbranch_scc1 a1_nosc
    v_mul_f32 v40, s72, v40
    v_mul_f32 v41, s72, v41
    v_mul_f32 v42, s72, v42
    v_mul_f32 v43, s72, v43
    v_mul_f32 v44, s72, v44
    v_mul_f32 v45, s72, v45
    v_mul_f32 v46, s72, v46
    v_mul_f32 v47, s72, v47
    v_mul_f32 v48, s72, v48
    v_mul_f32 v49, s72, v49
    v_mul_f32 v50, s72, v50
    v_mul_f32 v51, s72, v51
    v_mul_f32 v52, s72, v52
    v_mul_f32 v53, s72, v53
    v_mul_f32 v54, s72, v54
    v_mul_f32 v55, s72, v55
    v_mul_f32 v56, s72, v56
    v_mul_f32 v57, s72, v57
    v_mul_f32 v58, s72, v58
    v_mul_f32 v59, s72, v59
    v_mul_f32 v60, s72, v60
    v_mul_f32 v61, s72, v61
    v_mul_f32 v62, s72, v62
    v_mul_f32 v63, s72, v63
    v_mul_f32 v64, s72, v64
    v_mul_f32 v65, s72, v65
    v_mul_f32 v66, s72, v66
    v_mul_f32 v67, s72, v67
    v_mul_f32 v68, s72, v68
    v_mul_f32 v69, s72, v69
    v_mul_f32 v70, s72, v70
    v_mul_f32 v71, s72, v71
    v_mul_f32 v72, s72, v72
    v_mul_f32 v73, s72, v73
    v_mul_f32 v74, s72, v74
    v_mul_f32 v75, s72, v75
    v_mul_f32 v76, s72, v76
    v_mul_f32 v77, s72, v77
    v_mul_f32 v78, s72, v78
    v_mul_f32 v79, s72, v79
    v_mul_f32 v80, s72, v80
    v_mul_f32 v81, s72, v81
    v_mul_f32 v82, s72, v82
    v_mul_f32 v83, s72, v83
    v_mul_f32 v84, s72, v84
    v_mul_f32 v85, s72, v85
    v_mul_f32 v86, s72, v86
    v_mul_f32 v87, s72, v87
    v_mul_f32 v88, s72, v88
    v_mul_f32 v89, s72, v89
    v_mul_f32 v90, s72, v90
    v_mul_f32 v91, s72, v91
    v_mul_f32 v92, s72, v92
    v_mul_f32 v93, s72, v93
    v_mul_f32 v94, s72, v94
    v_mul_f32 v95, s72, v95
    v_mul_f32 v96, s72, v96
    v_mul_f32 v97, s72, v97
    v_mul_f32 v98, s72, v98
    v_mul_f32 v99, s72, v99
    v_mul_f32 v100, s72, v100
    v_mul_f32 v101, s72, v101
    v_mul_f32 v102, s72, v102
    v_mul_f32 v103, s72, v103
a1_nosc:
    v_cvt_pk_bf16_f32 v116, v40, v41
    v_cvt_pk_bf16_f32 v117, v42, v43
    v_cvt_pk_bf16_f32 v118, v44, v45
    v_cvt_pk_bf16_f32 v119, v46, v47
    s_nop 1
    v_permlane32_swap_b32 v116, v118
    v_permlane32_swap_b32 v117, v119
    s_andn2_b64 exec, -1, s[64:65]
    buffer_store_dwordx4 v[116:119], v108, s[16:19], s73 offen offset:0 sc0 sc1
    s_mov_b64 exec, s[64:65]
    s_cbranch_execz a1_nr2
    buffer_store_dwordx2 v[116:117], v112, s[16:19], s73 offen offset:0 sc0 sc1
    buffer_store_dwordx2 v[118:119], v112, s[16:19], s74 offen offset:0 sc0 sc1
a1_nr2:
    s_mov_b64 exec, -1
    v_cvt_pk_bf16_f32 v120, v72, v73
    v_cvt_pk_bf16_f32 v121, v74, v75
    v_cvt_pk_bf16_f32 v122, v76, v77
    v_cvt_pk_bf16_f32 v123, v78, v79
    s_nop 1
    v_permlane32_swap_b32 v120, v122
    v_permlane32_swap_b32 v121, v123
    s_andn2_b64 exec, -1, s[64:65]
    buffer_store_dwordx4 v[120:123], v108, s[16:19], s73 offen offset:1280 sc0 sc1
    s_mov_b64 exec, s[64:65]
    s_cbranch_execz a1_nr3
    buffer_store_dwordx2 v[120:121], v112, s[16:19], s73 offen offset:1280 sc0 sc1
    buffer_store_dwordx2 v[122:123], v112, s[16:19], s74 offen offset:1280 sc0 sc1
a1_nr3:
    s_mov_b64 exec, -1
    v_cvt_pk_bf16_f32 v116, v48, v49
    v_cvt_pk_bf16_f32 v117, v50, v51
    v_cvt_pk_bf16_f32 v118, v52, v53
    v_cvt_pk_bf16_f32 v119, v54, v55
    s_nop 1
    v_permlane32_swap_b32 v116, v118
    v_permlane32_swap_b32 v117, v119
    s_andn2_b64 exec, -1, s[66:67]
    buffer_store_dwordx4 v[116:119], v109, s[16:19], s73 offen offset:0 sc0 sc1
    s_mov_b64 exec, s[66:67]
    s_cbranch_execz a1_nr4
    buffer_store_dwordx2 v[116:117], v113, s[16:19], s73 offen offset:0 sc0 sc1
    buffer_store_dwordx2 v[118:119], v113, s[16:19], s74 offen offset:0 sc0 sc1
a1_nr4:
    s_mov_b64 exec, -1
    v_cvt_pk_bf16_f32 v120, v80, v81
    v_cvt_pk_bf16_f32 v121, v82, v83
    v_cvt_pk_bf16_f32 v122, v84, v85
    v_cvt_pk_bf16_f32 v123, v86, v87
    s_nop 1
    v_permlane32_swap_b32 v120, v122
    v_permlane32_swap_b32 v121, v123
    s_andn2_b64 exec, -1, s[66:67]
    buffer_store_dwordx4 v[120:123], v109, s[16:19], s73 offen offset:1280 sc0 sc1
    s_mov_b64 exec, s[66:67]
    s_cbranch_execz a1_nr5
    buffer_store_dwordx2 v[120:121], v113, s[16:19], s73 offen offset:1280 sc0 sc1
    buffer_store_dwordx2 v[122:123], v113, s[16:19], s74 offen offset:1280 sc0 sc1
a1_nr5:
    s_mov_b64 exec, -1
    v_cvt_pk_bf16_f32 v116, v56, v57
    v_cvt_pk_bf16_f32 v117, v58, v59
    v_cvt_pk_bf16_f32 v118, v60, v61
    v_cvt_pk_bf16_f32 v119, v62, v63
    s_nop 1
    v_permlane32_swap_b32 v116, v118
    v_permlane32_swap_b32 v117, v119
    s_andn2_b64 exec, -1, s[68:69]
    buffer_store_dwordx4 v[116:119], v110, s[16:19], s73 offen offset:0 sc0 sc1
    s_mov_b64 exec, s[68:69]
    s_cbranch_execz a1_nr6
    buffer_store_dwordx2 v[116:117], v114, s[16:19], s73 offen offset:0 sc0 sc1
    buffer_store_dwordx2 v[118:119], v114, s[16:19], s74 offen offset:0 sc0 sc1
a1_nr6:
    s_mov_b64 exec, -1
    v_cvt_pk_bf16_f32 v120, v88, v89
    v_cvt_pk_bf16_f32 v121, v90, v91
    v_cvt_pk_bf16_f32 v122, v92, v93
    v_cvt_pk_bf16_f32 v123, v94, v95
    s_nop 1
    v_permlane32_swap_b32 v120, v122
    v_permlane32_swap_b32 v121, v123
    s_andn2_b64 exec, -1, s[68:69]
    buffer_store_dwordx4 v[120:123], v110, s[16:19], s73 offen offset:1280 sc0 sc1
    s_mov_b64 exec, s[68:69]
    s_cbranch_execz a1_nr7
    buffer_store_dwordx2 v[120:121], v114, s[16:19], s73 offen offset:1280 sc0 sc1
    buffer_store_dwordx2 v[122:123], v114, s[16:19], s74 offen offset:1280 sc0 sc1
a1_nr7:
    s_mov_b64 exec, -1
    v_cvt_pk_bf16_f32 v116, v64, v65
    v_cvt_pk_bf16_f32 v117, v66, v67
    v_cvt_pk_bf16_f32 v118, v68, v69
    v_cvt_pk_bf16_f32 v119, v70, v71
    s_nop 1
    v_permlane32_swap_b32 v116, v118
    v_permlane32_swap_b32 v117, v119
    s_andn2_b64 exec, -1, s[70:71]
    buffer_store_dwordx4 v[116:119], v111, s[16:19], s73 offen offset:0 sc0 sc1
    s_mov_b64 exec, s[70:71]
    s_cbranch_execz a1_nr8
    buffer_store_dwordx2 v[116:117], v115, s[16:19], s73 offen offset:0 sc0 sc1
    buffer_store_dwordx2 v[118:119], v115, s[16:19], s74 offen offset:0 sc0 sc1
a1_nr8:
    s_mov_b64 exec, -1
    v_cvt_pk_bf16_f32 v120, v96, v97
    v_cvt_pk_bf16_f32 v121, v98, v99
    v_cvt_pk_bf16_f32 v122, v100, v101
    v_cvt_pk_bf16_f32 v123, v102, v103
    s_nop 1
    v_permlane32_swap_b32 v120, v122
    v_permlane32_swap_b32 v121, v123
    s_andn2_b64 exec, -1, s[70:71]
    buffer_store_dwordx4 v[120:123], v111, s[16:19], s73 offen offset:1280 sc0 sc1
    s_mov_b64 exec, s[70:71]
    s_cbranch_execz a1_nr9
    buffer_store_dwordx2 v[120:121], v115, s[16:19], s73 offen offset:1280 sc0 sc1
    buffer_store_dwordx2 v[122:123], v115, s[16:19], s74 offen offset:1280 sc0 sc1
a1_nr9:
    s_mov_b64 exec, -1
    s_branch a1_pub
a1_v:
    s_mov_b32 s38, 0
    s_mov_b32 s39, 0
    s_barrier
    ds_read_b128 v[8:11], v2 offset:0
    ds_read_b128 v[12:15], v2 offset:4096
    ds_read_b64_tr_b16 v[24:25], v6 offset:0
    ds_read_b64_tr_b16 v[26:27], v6 offset:1024
    ds_read_b64_tr_b16 v[28:29], v7 offset:0
    ds_read_b64_tr_b16 v[30:31], v7 offset:1024
    s_mov_b32 s36, 9
a1_ml10:
    s_waitcnt lgkmcnt(0)
    v_mfma_f32_32x32x16_bf16 v[40:55], v[8:11], v[24:27], v[40:55]
    ds_read_b128 v[16:19], v3 offset:0
    ds_read_b128 v[20:23], v3 offset:4096
    ds_read_b64_tr_b16 v[32:33], v6 offset:4096
    v_mfma_f32_32x32x16_bf16 v[56:71], v[8:11], v[28:31], v[56:71]
    ds_read_b64_tr_b16 v[34:35], v6 offset:5120
    v_mfma_f32_32x32x16_bf16 v[88:103], v[12:15], v[28:31], v[88:103]
    ds_read_b64_tr_b16 v[36:37], v7 offset:4096
    v_mfma_f32_32x32x16_bf16 v[72:87], v[12:15], v[24:27], v[72:87]
    ds_read_b64_tr_b16 v[38:39], v7 offset:5120
    s_add_u32 s38, s38, 8192
    s_cmp_ge_u32 s38, 32768
    s_cselect_b32 s37, 32768, 0
    s_sub_u32 s38, s38, s37
    s_sub_u32 s37, 8192, s37
    v_add_u32 v6, s37, v6
    v_add_u32 v7, s37, v7
    s_waitcnt lgkmcnt(0)
    s_barrier
    v_mfma_f32_32x32x16_bf16 v[40:55], v[16:19], v[32:35], v[40:55]
    ds_read_b128 v[8:11], v4 offset:0
    ds_read_b128 v[12:15], v4 offset:4096
    ds_read_b64_tr_b16 v[24:25], v6 offset:0
    v_mfma_f32_32x32x16_bf16 v[56:71], v[16:19], v[36:39], v[56:71]
    ds_read_b64_tr_b16 v[26:27], v6 offset:1024
    v_mfma_f32_32x32x16_bf16 v[88:103], v[20:23], v[36:39], v[88:103]
    ds_read_b64_tr_b16 v[28:29], v7 offset:0
    v_mfma_f32_32x32x16_bf16 v[72:87], v[20:23], v[32:35], v[72:87]
    ds_read_b64_tr_b16 v[30:31], v7 offset:1024
    s_waitcnt lgkmcnt(0)
    v_mfma_f32_32x32x16_bf16 v[40:55], v[8:11], v[24:27], v[40:55]
    ds_read_b128 v[16:19], v5 offset:0
    ds_read_b128 v[20:23], v5 offset:4096
    ds_read_b64_tr_b16 v[32:33], v6 offset:4096
    v_mfma_f32_32x32x16_bf16 v[56:71], v[8:11], v[28:31], v[56:71]
    ds_read_b64_tr_b16 v[34:35], v6 offset:5120
    v_mfma_f32_32x32x16_bf16 v[88:103], v[12:15], v[28:31], v[88:103]
    ds_read_b64_tr_b16 v[36:37], v7 offset:4096
    v_mfma_f32_32x32x16_bf16 v[72:87], v[12:15], v[24:27], v[72:87]
    ds_read_b64_tr_b16 v[38:39], v7 offset:5120
    s_add_u32 s38, s38, 8192
    s_cmp_ge_u32 s38, 32768
    s_cselect_b32 s37, 32768, 0
    s_sub_u32 s38, s38, s37
    s_sub_u32 s37, 8192, s37
    v_add_u32 v6, s37, v6
    v_add_u32 v7, s37, v7
    s_add_u32 s39, s39, 16384
    s_cmp_ge_u32 s39, 49152
    s_cselect_b32 s37, 49152, 0
    s_sub_u32 s39, s39, s37
    s_sub_u32 s37, 16384, s37
    v_add_u32 v2, s37, v2
    v_add_u32 v3, s37, v3
    v_add_u32 v4, s37, v4
    v_add_u32 v5, s37, v5
    s_waitcnt lgkmcnt(0)
    s_barrier
    v_mfma_f32_32x32x16_bf16 v[40:55], v[16:19], v[32:35], v[40:55]
    ds_read_b128 v[8:11], v2 offset:0
    ds_read_b128 v[12:15], v2 offset:4096
    ds_read_b64_tr_b16 v[24:25], v6 offset:0
    v_mfma_f32_32x32x16_bf16 v[56:71], v[16:19], v[36:39], v[56:71]
    ds_read_b64_tr_b16 v[26:27], v6 offset:1024
    v_mfma_f32_32x32x16_bf16 v[88:103], v[20:23], v[36:39], v[88:103]
    ds_read_b64_tr_b16 v[28:29], v7 offset:0
    v_mfma_f32_32x32x16_bf16 v[72:87], v[20:23], v[32:35], v[72:87]
    ds_read_b64_tr_b16 v[30:31], v7 offset:1024
    s_sub_u32 s36, s36, 1
    s_cmp_lg_u32 s36, 0
    s_cbranch_scc1 a1_ml10
    s_waitcnt lgkmcnt(0)
    v_mfma_f32_32x32x16_bf16 v[40:55], v[8:11], v[24:27], v[40:55]
    ds_read_b128 v[16:19], v3 offset:0
    ds_read_b128 v[20:23], v3 offset:4096
    ds_read_b64_tr_b16 v[32:33], v6 offset:4096
    v_mfma_f32_32x32x16_bf16 v[56:71], v[8:11], v[28:31], v[56:71]
    ds_read_b64_tr_b16 v[34:35], v6 offset:5120
    v_mfma_f32_32x32x16_bf16 v[88:103], v[12:15], v[28:31], v[88:103]
    ds_read_b64_tr_b16 v[36:37], v7 offset:4096
    v_mfma_f32_32x32x16_bf16 v[72:87], v[12:15], v[24:27], v[72:87]
    ds_read_b64_tr_b16 v[38:39], v7 offset:5120
    s_add_u32 s38, s38, 8192
    s_cmp_ge_u32 s38, 32768
    s_cselect_b32 s37, 32768, 0
    s_sub_u32 s38, s38, s37
    s_sub_u32 s37, 8192, s37
    v_add_u32 v6, s37, v6
    v_add_u32 v7, s37, v7
    s_waitcnt lgkmcnt(0)
    s_barrier
    v_mfma_f32_32x32x16_bf16 v[40:55], v[16:19], v[32:35], v[40:55]
    ds_read_b128 v[8:11], v4 offset:0
    ds_read_b128 v[12:15], v4 offset:4096
    ds_read_b64_tr_b16 v[24:25], v6 offset:0
    v_mfma_f32_32x32x16_bf16 v[56:71], v[16:19], v[36:39], v[56:71]
    ds_read_b64_tr_b16 v[26:27], v6 offset:1024
    v_mfma_f32_32x32x16_bf16 v[88:103], v[20:23], v[36:39], v[88:103]
    ds_read_b64_tr_b16 v[28:29], v7 offset:0
    v_mfma_f32_32x32x16_bf16 v[72:87], v[20:23], v[32:35], v[72:87]
    ds_read_b64_tr_b16 v[30:31], v7 offset:1024
    s_waitcnt lgkmcnt(0)
    v_mfma_f32_32x32x16_bf16 v[40:55], v[8:11], v[24:27], v[40:55]
    ds_read_b128 v[16:19], v5 offset:0
    ds_read_b128 v[20:23], v5 offset:4096
    ds_read_b64_tr_b16 v[32:33], v6 offset:4096
    v_mfma_f32_32x32x16_bf16 v[56:71], v[8:11], v[28:31], v[56:71]
    ds_read_b64_tr_b16 v[34:35], v6 offset:5120
    v_mfma_f32_32x32x16_bf16 v[88:103], v[12:15], v[28:31], v[88:103]
    ds_read_b64_tr_b16 v[36:37], v7 offset:4096
    v_mfma_f32_32x32x16_bf16 v[72:87], v[12:15], v[24:27], v[72:87]
    ds_read_b64_tr_b16 v[38:39], v7 offset:5120
    s_waitcnt lgkmcnt(0)
    v_mfma_f32_32x32x16_bf16 v[40:55], v[16:19], v[32:35], v[40:55]
    v_mfma_f32_32x32x16_bf16 v[56:71], v[16:19], v[36:39], v[56:71]
    v_mfma_f32_32x32x16_bf16 v[88:103], v[20:23], v[36:39], v[88:103]
    v_mfma_f32_32x32x16_bf16 v[72:87], v[20:23], v[32:35], v[72:87]
    v_mov_b32 v124, 0
    global_load_dword v125, v124, s[90:91] sc1
    s_sub_u32 s24, s40, 10
    s_lshl_b32 s24, s24, 7
    s_lshl_b32 s26, s43, 6
    s_add_u32 s24, s24, s26
    s_lshl_b32 s26, s41, 2
    s_lshl_b32 s27, s42, 1
    s_add_u32 s26, s26, s27
    s_mul_i32 s26, s26, 1280
    s_add_u32 s25, s26, 5242880
    v_and_b32 v104, 31, v0
    v_lshrrev_b32 v105, 5, v0
    v_mul_u32_u24 v105, 320, v105
    v_add_u32 v104, s24, v104
    s_nop 7
    v_add_u32 v108, 0, v104
    v_mul_u32_u24 v109, 52429, v108
    v_lshrrev_b32 v109, 20, v109
    v_mul_u32_u24 v110, 20, v109
    v_sub_u32 v108, v108, v110
    v_mul_u32_u24 v109, 81920, v109
    v_lshl_add_u32 v110, v108, 4, v109
    v_add_u32 v110, v110, v105
    v_cvt_pk_bf16_f32 v112, v40, v41
    v_cvt_pk_bf16_f32 v113, v42, v43
    v_cvt_pk_bf16_f32 v114, v44, v45
    v_cvt_pk_bf16_f32 v115, v46, v47
    buffer_store_dwordx4 v[112:115], v110, s[16:19], s25 offen offset:0 sc0 sc1
    s_nop 1
    v_cvt_pk_bf16_f32 v116, v48, v49
    v_cvt_pk_bf16_f32 v117, v50, v51
    v_cvt_pk_bf16_f32 v118, v52, v53
    v_cvt_pk_bf16_f32 v119, v54, v55
    buffer_store_dwordx4 v[116:119], v110, s[16:19], s25 offen offset:640 sc0 sc1
    s_nop 1
    v_cvt_pk_bf16_f32 v112, v72, v73
    v_cvt_pk_bf16_f32 v113, v74, v75
    v_cvt_pk_bf16_f32 v114, v76, v77
    v_cvt_pk_bf16_f32 v115, v78, v79
    buffer_store_dwordx4 v[112:115], v110, s[16:19], s25 offen offset:1280 sc0 sc1
    s_nop 1
    v_cvt_pk_bf16_f32 v116, v80, v81
    v_cvt_pk_bf16_f32 v117, v82, v83
    v_cvt_pk_bf16_f32 v118, v84, v85
    v_cvt_pk_bf16_f32 v119, v86, v87
    buffer_store_dwordx4 v[116:119], v110, s[16:19], s25 offen offset:1920 sc0 sc1
    s_nop 1
    v_add_u32 v108, 32, v104
    v_mul_u32_u24 v109, 52429, v108
    v_lshrrev_b32 v109, 20, v109
    v_mul_u32_u24 v110, 20, v109
    v_sub_u32 v108, v108, v110
    v_mul_u32_u24 v109, 81920, v109
    v_lshl_add_u32 v110, v108, 4, v109
    v_add_u32 v110, v110, v105
    v_cvt_pk_bf16_f32 v112, v56, v57
    v_cvt_pk_bf16_f32 v113, v58, v59
    v_cvt_pk_bf16_f32 v114, v60, v61
    v_cvt_pk_bf16_f32 v115, v62, v63
    buffer_store_dwordx4 v[112:115], v110, s[16:19], s25 offen offset:0 sc0 sc1
    s_nop 1
    v_cvt_pk_bf16_f32 v116, v64, v65
    v_cvt_pk_bf16_f32 v117, v66, v67
    v_cvt_pk_bf16_f32 v118, v68, v69
    v_cvt_pk_bf16_f32 v119, v70, v71
    buffer_store_dwordx4 v[116:119], v110, s[16:19], s25 offen offset:640 sc0 sc1
    s_nop 1
    v_cvt_pk_bf16_f32 v112, v88, v89
    v_cvt_pk_bf16_f32 v113, v90, v91
    v_cvt_pk_bf16_f32 v114, v92, v93
    v_cvt_pk_bf16_f32 v115, v94, v95
    buffer_store_dwordx4 v[112:115], v110, s[16:19], s25 offen offset:1280 sc0 sc1
    s_nop 1
    v_cvt_pk_bf16_f32 v116, v96, v97
    v_cvt_pk_bf16_f32 v117, v98, v99
    v_cvt_pk_bf16_f32 v118, v100, v101
    v_cvt_pk_bf16_f32 v119, v102, v103
    buffer_store_dwordx4 v[116:119], v110, s[16:19], s25 offen offset:1920 sc0 sc1
    s_nop 1
a1_pub:
    s_waitcnt vmcnt(0)
    v_readfirstlane_b32 s95, v125
    s_cmp_lg_u32 s95, 0
    s_cbranch_scc1 a1q_ok
    s_load_dwordx2 s[90:91], s[0:1], 80
    v_mov_b32 v124, 0
    s_mov_b32 s89, 0x40000
    s_waitcnt lgkmcnt(0)
a1q_nl:
    global_load_dword v125, v124, s[90:91] sc1
    s_waitcnt vmcnt(0)
    v_readfirstlane_b32 s95, v125
    s_cmp_lg_u32 s95, 0
    s_cbranch_scc1 a1q_nd
    s_sleep 1
    s_sub_u32 s89, s89, 1
    s_cmp_lg_u32 s89, 0
    s_cbranch_scc1 a1q_nl
a1q_nd:
a1q_ok:
    s_lshl_b32 s24, s40, 4
    s_add_u32 s24, s24, s41
    s_lshl_b32 s24, s24, 7
    s_lshl_b32 s25, s20, 2
    s_add_u32 s24, s24, s25
    s_add_u32 s24, s24, 34603008
    v_mov_b32 v120, 0
    v_mov_b32 v121, s95
    s_mov_b64 exec, 1
    buffer_store_dword v121, v120, s[16:19], s24 offen sc1
    s_mov_b64 exec, -1
    s_branch a1_done
a1_gate:
    s_mov_b32 s28, s56
    s_and_b32 s29, s57, 0xffff
    s_mov_b32 s30, 1280
    s_mov_b32 s31, 0x20000
    s_lshl_b32 s24, s20, 5
    v_and_b32 v52, 31, v0
    v_lshrrev_b32 v53, 5, v0
    v_bfe_u32 v54, v52, 1, 3
    v_xor_b32 v54, v54, v53
    v_lshlrev_b32 v54, 4, v54
    v_add_u32 v52, s24, v52
    v_lshlrev_b32 v52, 7, v52
    v_add_u32 v52, v52, v54
    v_xor_b32 v2, 0, v52
    v_xor_b32 v3, 32, v52
    v_xor_b32 v4, 64, v52
    v_xor_b32 v5, 96, v52
    v_lshrrev_b32 v6, 5, v0
    v_lshlrev_b32 v6, 4, v6
    s_lshl_b32 s46, s48, 7
    buffer_load_dwordx4 v[16:19], v6, s[28:31], s46 offen offset:0
    buffer_load_dwordx4 v[20:23], v6, s[28:31], s46 offen offset:32
    buffer_load_dwordx4 v[24:27], v6, s[28:31], s46 offen offset:64
    buffer_load_dwordx4 v[28:31], v6, s[28:31], s46 offen offset:96
    s_add_u32 s46, s46, 128
    s_cmp_ge_u32 s46, 1280
    s_cselect_b32 s46, 0, s46
    v_mov_b32 v48, 0
    v_mov_b32 v49, 0
    s_mov_b32 s39, 0
    s_barrier
    buffer_load_dwordx4 v[32:35], v6, s[28:31], s46 offen offset:0
    buffer_load_dwordx4 v[36:39], v6, s[28:31], s46 offen offset:32
    buffer_load_dwordx4 v[40:43], v6, s[28:31], s46 offen offset:64
    buffer_load_dwordx4 v[44:47], v6, s[28:31], s46 offen offset:96
    s_add_u32 s46, s46, 128
    s_cmp_ge_u32 s46, 1280
    s_cselect_b32 s46, 0, s46
    ds_read_b128 v[8:11], v2
    s_waitcnt lgkmcnt(0)
    s_waitcnt vmcnt(4)
    v_dot2_f32_bf16 v48, v8, v16, v48
    v_dot2_f32_bf16 v49, v9, v17, v49
    v_dot2_f32_bf16 v48, v10, v18, v48
    v_dot2_f32_bf16 v49, v11, v19, v49
    ds_read_b128 v[8:11], v3
    s_waitcnt lgkmcnt(0)
    v_dot2_f32_bf16 v48, v8, v20, v48
    v_dot2_f32_bf16 v49, v9, v21, v49
    v_dot2_f32_bf16 v48, v10, v22, v48
    v_dot2_f32_bf16 v49, v11, v23, v49
    s_barrier
    ds_read_b128 v[8:11], v4
    s_waitcnt lgkmcnt(0)
    v_dot2_f32_bf16 v48, v8, v24, v48
    v_dot2_f32_bf16 v49, v9, v25, v49
    v_dot2_f32_bf16 v48, v10, v26, v48
    v_dot2_f32_bf16 v49, v11, v27, v49
    ds_read_b128 v[8:11], v5
    s_waitcnt lgkmcnt(0)
    v_dot2_f32_bf16 v48, v8, v28, v48
    v_dot2_f32_bf16 v49, v9, v29, v49
    v_dot2_f32_bf16 v48, v10, v30, v48
    v_dot2_f32_bf16 v49, v11, v31, v49
    s_add_u32 s39, s39, 16384
    s_cmp_ge_u32 s39, 49152
    s_cselect_b32 s37, 49152, 0
    s_sub_u32 s39, s39, s37
    s_sub_u32 s37, 16384, s37
    v_add_u32 v2, s37, v2
    v_add_u32 v3, s37, v3
    v_add_u32 v4, s37, v4
    v_add_u32 v5, s37, v5
    s_barrier
    buffer_load_dwordx4 v[16:19], v6, s[28:31], s46 offen offset:0
    buffer_load_dwordx4 v[20:23], v6, s[28:31], s46 offen offset:32
    buffer_load_dwordx4 v[24:27], v6, s[28:31], s46 offen offset:64
    buffer_load_dwordx4 v[28:31], v6, s[28:31], s46 offen offset:96
    s_add_u32 s46, s46, 128
    s_cmp_ge_u32 s46, 1280
    s_cselect_b32 s46, 0, s46
    ds_read_b128 v[8:11], v2
    s_waitcnt lgkmcnt(0)
    s_waitcnt vmcnt(4)
    v_dot2_f32_bf16 v48, v8, v32, v48
    v_dot2_f32_bf16 v49, v9, v33, v49
    v_dot2_f32_bf16 v48, v10, v34, v48
    v_dot2_f32_bf16 v49, v11, v35, v49
    ds_read_b128 v[8:11], v3
    s_waitcnt lgkmcnt(0)
    v_dot2_f32_bf16 v48, v8, v36, v48
    v_dot2_f32_bf16 v49, v9, v37, v49
    v_dot2_f32_bf16 v48, v10, v38, v48
    v_dot2_f32_bf16 v49, v11, v39, v49
    s_barrier
    ds_read_b128 v[8:11], v4
    s_waitcnt lgkmcnt(0)
    v_dot2_f32_bf16 v48, v8, v40, v48
    v_dot2_f32_bf16 v49, v9, v41, v49
    v_dot2_f32_bf16 v48, v10, v42, v48
    v_dot2_f32_bf16 v49, v11, v43, v49
    ds_read_b128 v[8:11], v5
    s_waitcnt lgkmcnt(0)
    v_dot2_f32_bf16 v48, v8, v44, v48
    v_dot2_f32_bf16 v49, v9, v45, v49
    v_dot2_f32_bf16 v48, v10, v46, v48
    v_dot2_f32_bf16 v49, v11, v47, v49
    s_add_u32 s39, s39, 16384
    s_cmp_ge_u32 s39, 49152
    s_cselect_b32 s37, 49152, 0
    s_sub_u32 s39, s39, s37
    s_sub_u32 s37, 16384, s37
    v_add_u32 v2, s37, v2
    v_add_u32 v3, s37, v3
    v_add_u32 v4, s37, v4
    v_add_u32 v5, s37, v5
    s_barrier
    buffer_load_dwordx4 v[32:35], v6, s[28:31], s46 offen offset:0
    buffer_load_dwordx4 v[36:39], v6, s[28:31], s46 offen offset:32
    buffer_load_dwordx4 v[40:43], v6, s[28:31], s46 offen offset:64
    buffer_load_dwordx4 v[44:47], v6, s[28:31], s46 offen offset:96
    s_add_u32 s46, s46, 128
    s_cmp_ge_u32 s46, 1280
    s_cselect_b32 s46, 0, s46
    ds_read_b128 v[8:11], v2
    s_waitcnt lgkmcnt(0)
    s_waitcnt vmcnt(4)
    v_dot2_f32_bf16 v48, v8, v16, v48
    v_dot2_f32_bf16 v49, v9, v17, v49
    v_dot2_f32_bf16 v48, v10, v18, v48
    v_dot2_f32_bf16 v49, v11, v19, v49
    ds_read_b128 v[8:11], v3
    s_waitcnt lgkmcnt(0)
    v_dot2_f32_bf16 v48, v8, v20, v48
    v_dot2_f32_bf16 v49, v9, v21, v49
    v_dot2_f32_bf16 v48, v10, v22, v48
    v_dot2_f32_bf16 v49, v11, v23, v49
    s_barrier
    ds_read_b128 v[8:11], v4
    s_waitcnt lgkmcnt(0)
    v_dot2_f32_bf16 v48, v8, v24, v48
    v_dot2_f32_bf16 v49, v9, v25, v49
    v_dot2_f32_bf16 v48, v10, v26, v48
    v_dot2_f32_bf16 v49, v11, v27, v49
    ds_read_b128 v[8:11], v5
    s_waitcnt lgkmcnt(0)
    v_dot2_f32_bf16 v48, v8, v28, v48
    v_dot2_f32_bf16 v49, v9, v29, v49
    v_dot2_f32_bf16 v48, v10, v30, v48
    v_dot2_f32_bf16 v49, v11, v31, v49
    s_add_u32 s39, s39, 16384
    s_cmp_ge_u32 s39, 49152
    s_cselect_b32 s37, 49152, 0
    s_sub_u32 s39, s39, s37
    s_sub_u32 s37, 16384, s37
    v_add_u32 v2, s37, v2
    v_add_u32 v3, s37, v3
    v_add_u32 v4, s37, v4
    v_add_u32 v5, s37, v5
    s_barrier
    buffer_load_dwordx4 v[16:19], v6, s[28:31], s46 offen offset:0
    buffer_load_dwordx4 v[20:23], v6, s[28:31], s46 offen offset:32
    buffer_load_dwordx4 v[24:27], v6, s[28:31], s46 offen offset:64
    buffer_load_dwordx4 v[28:31], v6, s[28:31], s46 offen offset:96
    s_add_u32 s46, s46, 128
    s_cmp_ge_u32 s46, 1280
    s_cselect_b32 s46, 0, s46
    ds_read_b128 v[8:11], v2
    s_waitcnt lgkmcnt(0)
    s_waitcnt vmcnt(4)
    v_dot2_f32_bf16 v48, v8, v32, v48
    v_dot2_f32_bf16 v49, v9, v33, v49
    v_dot2_f32_bf16 v48, v10, v34, v48
    v_dot2_f32_bf16 v49, v11, v35, v49
    ds_read_b128 v[8:11], v3
    s_waitcnt lgkmcnt(0)
    v_dot2_f32_bf16 v48, v8, v36, v48
    v_dot2_f32_bf16 v49, v9, v37, v49
    v_dot2_f32_bf16 v48, v10, v38, v48
    v_dot2_f32_bf16 v49, v11, v39, v49
    s_barrier
    ds_read_b128 v[8:11], v4
    s_waitcnt lgkmcnt(0)
    v_dot2_f32_bf16 v48, v8, v40, v48
    v_dot2_f32_bf16 v49, v9, v41, v49
    v_dot2_f32_bf16 v48, v10, v42, v48
    v_dot2_f32_bf16 v49, v11, v43, v49
    ds_read_b128 v[8:11], v5
    s_waitcnt lgkmcnt(0)
    v_dot2_f32_bf16 v48, v8, v44, v48
    v_dot2_f32_bf16 v49, v9, v45, v49
    v_dot2_f32_bf16 v48, v10, v46, v48
    v_dot2_f32_bf16 v49, v11, v47, v49
    s_add_u32 s39, s39, 16384
    s_cmp_ge_u32 s39, 49152
    s_cselect_b32 s37, 49152, 0
    s_sub_u32 s39, s39, s37
    s_sub_u32 s37, 16384, s37
    v_add_u32 v2, s37, v2
    v_add_u32 v3, s37, v3
    v_add_u32 v4, s37, v4
    v_add_u32 v5, s37, v5
    s_barrier
    buffer_load_dwordx4 v[32:35], v6, s[28:31], s46 offen offset:0
    buffer_load_dwordx4 v[36:39], v6, s[28:31], s46 offen offset:32
    buffer_load_dwordx4 v[40:43], v6, s[28:31], s46 offen offset:64
    buffer_load_dwordx4 v[44:47], v6, s[28:31], s46 offen offset:96
    s_add_u32 s46, s46, 128
    s_cmp_ge_u32 s46, 1280
    s_cselect_b32 s46, 0, s46
    ds_read_b128 v[8:11], v2
    s_waitcnt lgkmcnt(0)
    s_waitcnt vmcnt(4)
    v_dot2_f32_bf16 v48, v8, v16, v48
    v_dot2_f32_bf16 v49, v9, v17, v49
    v_dot2_f32_bf16 v48, v10, v18, v48
    v_dot2_f32_bf16 v49, v11, v19, v49
    ds_read_b128 v[8:11], v3
    s_waitcnt lgkmcnt(0)
    v_dot2_f32_bf16 v48, v8, v20, v48
    v_dot2_f32_bf16 v49, v9, v21, v49
    v_dot2_f32_bf16 v48, v10, v22, v48
    v_dot2_f32_bf16 v49, v11, v23, v49
    s_barrier
    ds_read_b128 v[8:11], v4
    s_waitcnt lgkmcnt(0)
    v_dot2_f32_bf16 v48, v8, v24, v48
    v_dot2_f32_bf16 v49, v9, v25, v49
    v_dot2_f32_bf16 v48, v10, v26, v48
    v_dot2_f32_bf16 v49, v11, v27, v49
    ds_read_b128 v[8:11], v5
    s_waitcnt lgkmcnt(0)
    v_dot2_f32_bf16 v48, v8, v28, v48
    v_dot2_f32_bf16 v49, v9, v29, v49
    v_dot2_f32_bf16 v48, v10, v30, v48
    v_dot2_f32_bf16 v49, v11, v31, v49
    s_add_u32 s39, s39, 16384
    s_cmp_ge_u32 s39, 49152
    s_cselect_b32 s37, 49152, 0
    s_sub_u32 s39, s39, s37
    s_sub_u32 s37, 16384, s37
    v_add_u32 v2, s37, v2
    v_add_u32 v3, s37, v3
    v_add_u32 v4, s37, v4
    v_add_u32 v5, s37, v5
    s_barrier
    buffer_load_dwordx4 v[16:19], v6, s[28:31], s46 offen offset:0
    buffer_load_dwordx4 v[20:23], v6, s[28:31], s46 offen offset:32
    buffer_load_dwordx4 v[24:27], v6, s[28:31], s46 offen offset:64
    buffer_load_dwordx4 v[28:31], v6, s[28:31], s46 offen offset:96
    s_add_u32 s46, s46, 128
    s_cmp_ge_u32 s46, 1280
    s_cselect_b32 s46, 0, s46
    ds_read_b128 v[8:11], v2
    s_waitcnt lgkmcnt(0)
    s_waitcnt vmcnt(4)
    v_dot2_f32_bf16 v48, v8, v32, v48
    v_dot2_f32_bf16 v49, v9, v33, v49
    v_dot2_f32_bf16 v48, v10, v34, v48
    v_dot2_f32_bf16 v49, v11, v35, v49
    ds_read_b128 v[8:11], v3
    s_waitcnt lgkmcnt(0)
    v_dot2_f32_bf16 v48, v8, v36, v48
    v_dot2_f32_bf16 v49, v9, v37, v49
    v_dot2_f32_bf16 v48, v10, v38, v48
    v_dot2_f32_bf16 v49, v11, v39, v49
    s_barrier
    ds_read_b128 v[8:11], v4
    s_waitcnt lgkmcnt(0)
    v_dot2_f32_bf16 v48, v8, v40, v48
    v_dot2_f32_bf16 v49, v9, v41, v49
    v_dot2_f32_bf16 v48, v10, v42, v48
    v_dot2_f32_bf16 v49, v11, v43, v49
    ds_read_b128 v[8:11], v5
    s_waitcnt lgkmcnt(0)
    v_dot2_f32_bf16 v48, v8, v44, v48
    v_dot2_f32_bf16 v49, v9, v45, v49
    v_dot2_f32_bf16 v48, v10, v46, v48
    v_dot2_f32_bf16 v49, v11, v47, v49
    s_add_u32 s39, s39, 16384
    s_cmp_ge_u32 s39, 49152
    s_cselect_b32 s37, 49152, 0
    s_sub_u32 s39, s39, s37
    s_sub_u32 s37, 16384, s37
    v_add_u32 v2, s37, v2
    v_add_u32 v3, s37, v3
    v_add_u32 v4, s37, v4
    v_add_u32 v5, s37, v5
    s_barrier
    buffer_load_dwordx4 v[32:35], v6, s[28:31], s46 offen offset:0
    buffer_load_dwordx4 v[36:39], v6, s[28:31], s46 offen offset:32
    buffer_load_dwordx4 v[40:43], v6, s[28:31], s46 offen offset:64
    buffer_load_dwordx4 v[44:47], v6, s[28:31], s46 offen offset:96
    s_add_u32 s46, s46, 128
    s_cmp_ge_u32 s46, 1280
    s_cselect_b32 s46, 0, s46
    ds_read_b128 v[8:11], v2
    s_waitcnt lgkmcnt(0)
    s_waitcnt vmcnt(4)
    v_dot2_f32_bf16 v48, v8, v16, v48
    v_dot2_f32_bf16 v49, v9, v17, v49
    v_dot2_f32_bf16 v48, v10, v18, v48
    v_dot2_f32_bf16 v49, v11, v19, v49
    ds_read_b128 v[8:11], v3
    s_waitcnt lgkmcnt(0)
    v_dot2_f32_bf16 v48, v8, v20, v48
    v_dot2_f32_bf16 v49, v9, v21, v49
    v_dot2_f32_bf16 v48, v10, v22, v48
    v_dot2_f32_bf16 v49, v11, v23, v49
    s_barrier
    ds_read_b128 v[8:11], v4
    s_waitcnt lgkmcnt(0)
    v_dot2_f32_bf16 v48, v8, v24, v48
    v_dot2_f32_bf16 v49, v9, v25, v49
    v_dot2_f32_bf16 v48, v10, v26, v48
    v_dot2_f32_bf16 v49, v11, v27, v49
    ds_read_b128 v[8:11], v5
    s_waitcnt lgkmcnt(0)
    v_dot2_f32_bf16 v48, v8, v28, v48
    v_dot2_f32_bf16 v49, v9, v29, v49
    v_dot2_f32_bf16 v48, v10, v30, v48
    v_dot2_f32_bf16 v49, v11, v31, v49
    s_add_u32 s39, s39, 16384
    s_cmp_ge_u32 s39, 49152
    s_cselect_b32 s37, 49152, 0
    s_sub_u32 s39, s39, s37
    s_sub_u32 s37, 16384, s37
    v_add_u32 v2, s37, v2
    v_add_u32 v3, s37, v3
    v_add_u32 v4, s37, v4
    v_add_u32 v5, s37, v5
    s_barrier
    buffer_load_dwordx4 v[16:19], v6, s[28:31], s46 offen offset:0
    buffer_load_dwordx4 v[20:23], v6, s[28:31], s46 offen offset:32
    buffer_load_dwordx4 v[24:27], v6, s[28:31], s46 offen offset:64
    buffer_load_dwordx4 v[28:31], v6, s[28:31], s46 offen offset:96
    s_add_u32 s46, s46, 128
    s_cmp_ge_u32 s46, 1280
    s_cselect_b32 s46, 0, s46
    ds_read_b128 v[8:11], v2
    s_waitcnt lgkmcnt(0)
    s_waitcnt vmcnt(4)
    v_dot2_f32_bf16 v48, v8, v32, v48
    v_dot2_f32_bf16 v49, v9, v33, v49
    v_dot2_f32_bf16 v48, v10, v34, v48
    v_dot2_f32_bf16 v49, v11, v35, v49
    ds_read_b128 v[8:11], v3
    s_waitcnt lgkmcnt(0)
    v_dot2_f32_bf16 v48, v8, v36, v48
    v_dot2_f32_bf16 v49, v9, v37, v49
    v_dot2_f32_bf16 v48, v10, v38, v48
    v_dot2_f32_bf16 v49, v11, v39, v49
    s_barrier
    ds_read_b128 v[8:11], v4
    s_waitcnt lgkmcnt(0)
    v_dot2_f32_bf16 v48, v8, v40, v48
    v_dot2_f32_bf16 v49, v9, v41, v49
    v_dot2_f32_bf16 v48, v10, v42, v48
    v_dot2_f32_bf16 v49, v11, v43, v49
    ds_read_b128 v[8:11], v5
    s_waitcnt lgkmcnt(0)
    v_dot2_f32_bf16 v48, v8, v44, v48
    v_dot2_f32_bf16 v49, v9, v45, v49
    v_dot2_f32_bf16 v48, v10, v46, v48
    v_dot2_f32_bf16 v49, v11, v47, v49
    s_add_u32 s39, s39, 16384
    s_cmp_ge_u32 s39, 49152
    s_cselect_b32 s37, 49152, 0
    s_sub_u32 s39, s39, s37
    s_sub_u32 s37, 16384, s37
    v_add_u32 v2, s37, v2
    v_add_u32 v3, s37, v3
    v_add_u32 v4, s37, v4
    v_add_u32 v5, s37, v5
    s_barrier
    buffer_load_dwordx4 v[32:35], v6, s[28:31], s46 offen offset:0
    buffer_load_dwordx4 v[36:39], v6, s[28:31], s46 offen offset:32
    buffer_load_dwordx4 v[40:43], v6, s[28:31], s46 offen offset:64
    buffer_load_dwordx4 v[44:47], v6, s[28:31], s46 offen offset:96
    s_add_u32 s46, s46, 128
    s_cmp_ge_u32 s46, 1280
    s_cselect_b32 s46, 0, s46
    ds_read_b128 v[8:11], v2
    s_waitcnt lgkmcnt(0)
    s_waitcnt vmcnt(4)
    v_dot2_f32_bf16 v48, v8, v16, v48
    v_dot2_f32_bf16 v49, v9, v17, v49
    v_dot2_f32_bf16 v48, v10, v18, v48
    v_dot2_f32_bf16 v49, v11, v19, v49
    ds_read_b128 v[8:11], v3
    s_waitcnt lgkmcnt(0)
    v_dot2_f32_bf16 v48, v8, v20, v48
    v_dot2_f32_bf16 v49, v9, v21, v49
    v_dot2_f32_bf16 v48, v10, v22, v48
    v_dot2_f32_bf16 v49, v11, v23, v49
    s_barrier
    ds_read_b128 v[8:11], v4
    s_waitcnt lgkmcnt(0)
    v_dot2_f32_bf16 v48, v8, v24, v48
    v_dot2_f32_bf16 v49, v9, v25, v49
    v_dot2_f32_bf16 v48, v10, v26, v48
    v_dot2_f32_bf16 v49, v11, v27, v49
    ds_read_b128 v[8:11], v5
    s_waitcnt lgkmcnt(0)
    v_dot2_f32_bf16 v48, v8, v28, v48
    v_dot2_f32_bf16 v49, v9, v29, v49
    v_dot2_f32_bf16 v48, v10, v30, v48
    v_dot2_f32_bf16 v49, v11, v31, v49
    s_add_u32 s39, s39, 16384
    s_cmp_ge_u32 s39, 49152
    s_cselect_b32 s37, 49152, 0
    s_sub_u32 s39, s39, s37
    s_sub_u32 s37, 16384, s37
    v_add_u32 v2, s37, v2
    v_add_u32 v3, s37, v3
    v_add_u32 v4, s37, v4
    v_add_u32 v5, s37, v5
    s_barrier
    ds_read_b128 v[8:11], v2
    s_waitcnt lgkmcnt(0)
    s_waitcnt vmcnt(0)
    v_dot2_f32_bf16 v48, v8, v32, v48
    v_dot2_f32_bf16 v49, v9, v33, v49
    v_dot2_f32_bf16 v48, v10, v34, v48
    v_dot2_f32_bf16 v49, v11, v35, v49
    ds_read_b128 v[8:11], v3
    s_waitcnt lgkmcnt(0)
    v_dot2_f32_bf16 v48, v8, v36, v48
    v_dot2_f32_bf16 v49, v9, v37, v49
    v_dot2_f32_bf16 v48, v10, v38, v48
    v_dot2_f32_bf16 v49, v11, v39, v49
    s_barrier
    ds_read_b128 v[8:11], v4
    s_waitcnt lgkmcnt(0)
    v_dot2_f32_bf16 v48, v8, v40, v48
    v_dot2_f32_bf16 v49, v9, v41, v49
    v_dot2_f32_bf16 v48, v10, v42, v48
    v_dot2_f32_bf16 v49, v11, v43, v49
    ds_read_b128 v[8:11], v5
    s_waitcnt lgkmcnt(0)
    v_dot2_f32_bf16 v48, v8, v44, v48
    v_dot2_f32_bf16 v49, v9, v45, v49
    v_dot2_f32_bf16 v48, v10, v46, v48
    v_dot2_f32_bf16 v49, v11, v47, v49
    s_nop 3
    v_add_f32 v48, v48, v49
    v_mov_b32 v49, v48
    s_nop 1
    v_permlane32_swap_b32 v48, v49
    s_nop 1
    v_add_f32 v6, v48, v49
    v_cvt_pk_bf16_f32 v6, v6, v6
    v_lshlrev_b32 v6, 16, v6
    v_mul_f32 v6, 0xbfb8aa3b, v6
    v_exp_f32 v6, v6
    s_nop 0
    v_add_f32 v6, 1.0, v6
    v_rcp_f32 v6, v6
    s_nop 0
    v_cvt_pk_bf16_f32 v6, v6, v6
    v_lshlrev_b32 v6, 16, v6
    v_and_b32 v7, 31, v0
    s_lshl_b32 s24, s41, 7
    s_lshl_b32 s25, s20, 5
    s_add_u32 s24, s24, s25
    v_add_u32 v7, s24, v7
    v_lshlrev_b32 v7, 2, v7
    v_add_u32 v7, 16777216, v7
    s_mov_b32 exec_hi, 0
    buffer_store_dword v6, v7, s[16:19], 0 offen sc1
    s_mov_b64 exec, -1
    s_load_dwordx2 s[90:91], s[0:1], 80
    v_mov_b32 v120, 0
    s_mov_b32 s89, 0x40000
    s_waitcnt lgkmcnt(0)
a1g_nl:
    global_load_dword v121, v120, s[90:91] sc1
    s_waitcnt vmcnt(0)
    v_readfirstlane_b32 s95, v121
    s_cmp_lg_u32 s95, 0
    s_cbranch_scc1 a1g_nd
    s_sleep 1
    s_sub_u32 s89, s89, 1
    s_cmp_lg_u32 s89, 0
    s_cbranch_scc1 a1g_nl
a1g_nd:
    s_lshl_b32 s24, s40, 4
    s_add_u32 s24, s24, s41
    s_lshl_b32 s24, s24, 7
    s_lshl_b32 s25, s20, 2
    s_add_u32 s24, s24, s25
    s_add_u32 s24, s24, 34603008
    v_mov_b32 v120, 0
    v_mov_b32 v121, s95
    s_mov_b64 exec, 1
    buffer_store_dword v121, v120, s[16:19], s24 offen sc1
    s_mov_b64 exec, -1
a1_done:
    s_mov_b32 s94, s20
    s_load_dwordx2 s[4:5], s[0:1], 88
    s_mov_b32 s12, s94
    s_setprio 3
    s_and_b32 s24, s2, 7
    s_lshr_b32 s25, s2, 3
    s_lshr_b32 s26, s25, 3
    s_lshl_b32 s13, s24, 2
    s_add_u32 s13, s13, s26
    s_and_b32 s37, s25, 7
    s_mov_b32 s25, s37
    s_lshr_b32 s34, s12, 2
    s_and_b32 s28, s12, 3
    s_lshl_b32 s14, s25, 2
    s_add_u32 s14, s14, s28
    s_lshl_b32 s14, s14, 1
    v_lshlrev_b32 v2, 4, v0
    v_and_b32 v121, 31, v0
    v_lshrrev_b32 v122, 5, v0
    v_lshlrev_b32 v6, 3, v121
    v_mul_u32_u24 v7, 320, v122
    v_lshl_add_u32 v7, v121, 4, v7
    s_mov_b32 s20, 0x000FFFFF
    s_mov_b32 s21, 0x000FFFFF
    s_mov_b32 s22, -1
    s_mov_b32 s23, 0
    s_mul_i32 s27, s13, 81920
    s_waitcnt lgkmcnt(0)
    s_mov_b32 s8, s4
    s_and_b32 s9, s5, 0xffff
    s_mov_b32 s10, 50331648
    s_mov_b32 s11, 0x20000
    s_and_b32 s24, s28, 1
    s_mul_i32 s24, s24, 2560
    s_cmp_ge_u32 s28, 2
    s_cselect_b32 s25, 2621440, 0
    s_add_u32 s25, s25, 2621440
    s_add_u32 s15, s24, s25
    s_add_u32 s15, s15, s27
    s_mul_i32 s24, s34, 40960
    s_add_u32 s15, s15, s24
    s_mov_b32 s35, s37
    s_mul_i32 s24, s35, 5120
    s_add_u32 s15, s15, s24
    s_mul_i32 s16, s12, 2560
    s_load_dwordx2 s[90:91], s[0:1], 80
    v_mov_b32 v122, 0
    s_mov_b32 s89, 0x40000
    s_waitcnt lgkmcnt(0)
atn_nl:
    global_load_dword v123, v122, s[90:91] sc1
    s_waitcnt vmcnt(0)
    v_readfirstlane_b32 s95, v123
    s_cmp_lg_u32 s95, 0
    s_cbranch_scc1 atn_nd
    s_sleep 1
    s_sub_u32 s89, s89, 1
    s_cmp_lg_u32 s89, 0
    s_cbranch_scc1 atn_nl
atn_nd:
    s_cmp_lg_u32 s12, 0
    s_cbranch_scc1 at_pd
    s_mul_i32 s24, s13, 20
    s_add_u32 s25, s24, 19
    s_lshr_b32 s24, s24, 7
    s_lshr_b32 s25, s25, 7
    s_sub_u32 s26, s25, s24
    v_lshrrev_b32 v122, 4, v0
    v_and_b32 v123, 1, v122
    v_mul_u32_u24 v123, s26, v123
    v_lshrrev_b32 v122, 1, v122
    v_mul_u32_u24 v122, 5, v122
    v_add3_u32 v122, v122, v123, 5
    v_add_u32 v122, s24, v122
    v_and_b32 v123, 15, v0
    v_lshl_add_u32 v122, v122, 4, v123
    v_lshlrev_b32 v122, 7, v122
    v_add_u32 v122, 34603008, v122
    s_mov_b32 s32, s37
    v_min_u32 v100, 29, v0
    v_cmp_le_u32 vcc, 12, v100
    s_nop 1
    v_mov_b32 v102, 1
    v_cndmask_b32 v101, 0, v102, vcc
    v_mul_u32_u24 v102, 12, v101
    v_sub_u32 v102, v100, v102
    v_lshrrev_b32 v103, 2, v102
    v_and_b32 v102, 3, v102
    v_add_u32 v103, s32, v103
    v_and_b32 v103, 7, v103
    v_lshl_add_u32 v103, v101, 3, v103
    v_and_b32 v104, 1, v102
    v_mul_u32_u24 v104, s26, v104
    v_lshrrev_b32 v102, 1, v102
    v_mul_u32_u24 v102, 5, v102
    v_add3_u32 v102, v102, v104, 5
    v_add_u32 v102, s24, v102
    v_lshl_add_u32 v102, v102, 4, v103
    v_subrev_u32 v103, 24, v100
    v_and_b32 v104, 1, v103
    s_lshl_b32 s33, s32, 1
    v_add_u32 v104, s33, v104
    v_lshrrev_b32 v103, 1, v103
    v_mul_u32_u24 v105, s26, v103
    v_add_u32 v105, s24, v105
    v_cmp_eq_u32 vcc, 2, v103
    v_mov_b32 v106, 15
    s_nop 0
    v_cndmask_b32 v105, v105, v106, vcc
    v_lshl_add_u32 v105, v105, 4, v104
    v_cmp_le_u32 vcc, 24, v100
    s_nop 1
    v_cndmask_b32 v125, v102, v105, vcc
    v_lshlrev_b32 v125, 7, v125
    s_mov_b32 s24, 34603008
    s_mov_b32 s32, 0x40000
at_pl:
    buffer_load_dwordx4 v[100:103], v125, s[8:11], s24 offen sc1
    s_waitcnt vmcnt(0)
    v_xor_b32 v100, s95, v100
    v_xor_b32 v101, s95, v101
    v_xor_b32 v102, s95, v102
    v_xor_b32 v103, s95, v103
    v_or3_b32 v100, v100, v101, v102
    v_or_b32 v100, v100, v103
    v_cmp_ne_u32 vcc, 0, v100
    s_nop 4
    s_cbranch_vccz at_pd
    s_sleep 2
    s_sub_u32 s32, s32, 1
    s_cmp_lg_u32 s32, 0
    s_cbranch_scc1 at_pl
at_pd:
    v_mov_b32 v125, v122
    s_barrier
    s_mov_b32 m0, s16
    s_nop 0
    buffer_load_dwordx4 v2, s[8:11], s15 offen offset:0 sc1 lds
    buffer_load_dwordx4 v2, s[8:11], s15 offen offset:1024 sc1 lds
    s_mov_b64 exec, s[22:23]
    buffer_load_dwordx4 v2, s[8:11], s15 offen offset:2048 sc1 lds
    s_mov_b64 exec, -1
    s_add_u32 s15, s15, 5120
    s_add_u32 s35, s35, 1
    s_cmp_eq_u32 s35, 8
    s_cselect_b32 s35, 0, s35
    s_cselect_b32 s24, 40960, 0
    s_sub_u32 s15, s15, s24
    s_add_u32 s16, s16, 20480
    s_cmp_ge_u32 s16, 81920
    s_cselect_b32 s24, 81920, 0
    s_sub_u32 s16, s16, s24
    s_mul_i32 s25, s14, 1280
    s_add_u32 s25, s25, s27
    v_mov_b32 v16, 0
    v_mov_b32 v17, 0
    v_mov_b32 v18, 0
    v_mov_b32 v19, 0
    buffer_load_dwordx4 v[8:11], v2, s[8:11], s25 offen sc1
    buffer_load_dwordx4 v[12:15], v2, s[8:11], s25 offen offset:1280 sc1
    s_mov_b64 exec, s[22:23]
    buffer_load_dwordx2 v[16:17], v6, s[8:11], s25 offen offset:1024 sc1
    buffer_load_dwordx2 v[18:19], v6, s[8:11], s25 offen offset:2304 sc1
    s_mov_b64 exec, -1
    s_lshl_b32 s39, s14, 7
    s_add_u32 s39, s39, 16777216
    v_lshrrev_b32 v127, 1, v6
    s_mul_i32 s24, s34, 10240
    v_add_u32 v120, s24, v2
    s_add_u32 s25, s24, 1024
    v_add_u32 v6, s25, v6
    s_add_u32 s25, s24, 5120
    v_add_u32 v7, s25, v7
    v_mov_b32 v56, 0
    v_mov_b32 v57, 0
    v_mov_b32 v58, 0
    v_mov_b32 v59, 0
    v_mov_b32 v60, 0
    v_mov_b32 v61, 0
    v_mov_b32 v62, 0
    v_mov_b32 v63, 0
    v_mov_b32 v64, 0
    v_mov_b32 v65, 0
    v_mov_b32 v66, 0
    v_mov_b32 v67, 0
    v_mov_b32 v68, 0
    v_mov_b32 v69, 0
    v_mov_b32 v70, 0
    v_mov_b32 v71, 0
    v_mov_b32 v72, 0
    v_mov_b32 v73, 0
    v_mov_b32 v74, 0
    v_mov_b32 v75, 0
    v_mov_b32 v76, 0
    v_mov_b32 v77, 0
    v_mov_b32 v78, 0
    v_mov_b32 v79, 0
    v_mov_b32 v80, 0
    v_mov_b32 v81, 0
    v_mov_b32 v82, 0
    v_mov_b32 v83, 0
    v_mov_b32 v84, 0
    v_mov_b32 v85, 0
    v_mov_b32 v86, 0
    v_mov_b32 v87, 0
    v_mov_b32 v52, 0
    v_mov_b32 v53, 0
    v_mov_b32 v54, 0
    v_mov_b32 v55, 0
    v_cmp_eq_u32 vcc, 20, v121
    v_mov_b32 v122, 0x3f803f80
    s_nop 0
    v_cndmask_b32 v32, 0, v122, vcc
    v_cndmask_b32 v33, 0, v122, vcc
    v_cndmask_b32 v34, 0, v122, vcc
    v_cndmask_b32 v35, 0, v122, vcc
    v_cndmask_b32 v36, 0, v122, vcc
    v_cndmask_b32 v37, 0, v122, vcc
    v_cndmask_b32 v38, 0, v122, vcc
    v_cndmask_b32 v39, 0, v122, vcc
    v_cndmask_b32 v40, 0, v122, vcc
    v_cndmask_b32 v41, 0, v122, vcc
    v_cndmask_b32 v42, 0, v122, vcc
    v_cndmask_b32 v43, 0, v122, vcc
    v_cndmask_b32 v44, 0, v122, vcc
    v_cndmask_b32 v45, 0, v122, vcc
    v_cndmask_b32 v46, 0, v122, vcc
    v_cndmask_b32 v47, 0, v122, vcc
    s_mov_b32 s18, 0
    s_mov_b32 s19, 0
    s_mov_b32 s17, 0
    v_mov_b32 v3, v120
    v_mov_b32 v4, v6
    v_mov_b32 v5, v7
    s_mov_b32 m0, s16
    s_nop 0
    buffer_load_dwordx4 v2, s[8:11], s15 offen offset:0 sc1 lds
    buffer_load_dwordx4 v2, s[8:11], s15 offen offset:1024 sc1 lds
    s_mov_b64 exec, s[22:23]
    buffer_load_dwordx4 v2, s[8:11], s15 offen offset:2048 sc1 lds
    s_mov_b64 exec, -1
    s_add_u32 s15, s15, 5120
    s_add_u32 s35, s35, 1
    s_cmp_eq_u32 s35, 8
    s_cselect_b32 s35, 0, s35
    s_cselect_b32 s24, 40960, 0
    s_sub_u32 s15, s15, s24
    s_add_u32 s16, s16, 20480
    s_cmp_ge_u32 s16, 81920
    s_cselect_b32 s24, 81920, 0
    s_sub_u32 s16, s16, s24
    s_waitcnt vmcnt(3)
    s_barrier
    ds_read_b128 v[20:23], v3 offset:0
    ds_read_b64 v[24:25], v4 offset:0
    ds_read_b128 v[26:29], v3 offset:1280
    ds_read_b64 v[30:31], v4 offset:1280
    s_mov_b64 exec, s[20:21]
    ds_read_b128 v[32:35], v5 offset:0
    ds_read_b128 v[36:39], v5 offset:640
    s_mov_b64 exec, -1
    buffer_load_dword v126, v127, s[8:11], s39 offen sc1
    buffer_load_dword v127, v127, s[8:11], s39 offen offset:128 sc1
    s_mov_b32 m0, s16
    s_nop 0
    buffer_load_dwordx4 v2, s[8:11], s15 offen offset:0 sc1 lds
    buffer_load_dwordx4 v2, s[8:11], s15 offen offset:1024 sc1 lds
    s_mov_b64 exec, s[22:23]
    buffer_load_dwordx4 v2, s[8:11], s15 offen offset:2048 sc1 lds
    s_mov_b64 exec, -1
    s_add_u32 s15, s15, 5120
    s_add_u32 s35, s35, 1
    s_cmp_eq_u32 s35, 8
    s_cselect_b32 s35, 0, s35
    s_cselect_b32 s24, 40960, 0
    s_sub_u32 s15, s15, s24
    s_add_u32 s16, s16, 20480
    s_cmp_ge_u32 s16, 81920
    s_cselect_b32 s24, 81920, 0
    s_sub_u32 s16, s16, s24
    s_cmp_lg_u32 s12, 0
    s_cbranch_scc1 at_nf
    buffer_load_dword v121, v125, s[8:11], 0 offen offset:0 sc1
    buffer_load_dword v122, v125, s[8:11], 0 offen offset:4 sc1
    buffer_load_dword v123, v125, s[8:11], 0 offen offset:8 sc1
    buffer_load_dword v124, v125, s[8:11], 0 offen offset:12 sc1
at_nf:
    s_waitcnt lgkmcnt(0)
    v_mfma_f32_32x32x16_bf16 v[88:103], v[20:23], v[8:11], 0
    v_mfma_f32_32x32x8_bf16 v[88:103], v[24:25], v[16:17], v[88:103]
    s_nop 7
    s_nop 3
    s_setprio 2
    s_mov_b32 s64, s15
    s_add_u32 s15, s15, 5120
    s_add_u32 s35, s35, 1
    s_cmp_eq_u32 s35, 8
    s_cselect_b32 s35, 0, s35
    s_cselect_b32 s24, 40960, 0
    s_sub_u32 s15, s15, s24
    s_mov_b32 s65, s15
    s_add_u32 s15, s15, 5120
    s_add_u32 s35, s35, 1
    s_cmp_eq_u32 s35, 8
    s_cselect_b32 s35, 0, s35
    s_cselect_b32 s24, 40960, 0
    s_sub_u32 s15, s15, s24
    s_mov_b32 s66, s15
    s_add_u32 s15, s15, 5120
    s_add_u32 s35, s35, 1
    s_cmp_eq_u32 s35, 8
    s_cselect_b32 s35, 0, s35
    s_cselect_b32 s24, 40960, 0
    s_sub_u32 s15, s15, s24
    s_mov_b32 s67, s15
    s_add_u32 s15, s15, 5120
    s_add_u32 s35, s35, 1
    s_cmp_eq_u32 s35, 8
    s_cselect_b32 s35, 0, s35
    s_cselect_b32 s24, 40960, 0
    s_sub_u32 s15, s15, s24
    s_mov_b32 s68, s15
    s_mul_i32 s69, s12, 2560
    v_add_u32 v1, 61440, v5
    s_cmp_eq_u32 s34, 1
    s_cbranch_scc1 at_g1
    .p2align 6
at_g0:
    s_waitcnt lgkmcnt(0)
    v_exp_f32 v88, v88
    v_exp_f32 v89, v89
    v_mfma_f32_32x32x16_bf16 v[72:87], v[44:47], v[52:55], v[72:87]
    s_mov_b64 exec, s[20:21]
    ds_read_b128 v[40:43], v5 offset:1280
    ds_read_b128 v[44:47], v5 offset:1920
    s_mov_b64 exec, -1
    v_exp_f32 v90, v90
    v_exp_f32 v91, v91
    v_exp_f32 v92, v92
    v_exp_f32 v93, v93
    v_mfma_f32_32x32x16_bf16 v[104:119], v[20:23], v[12:15], 0
    v_exp_f32 v94, v94
    v_exp_f32 v95, v95
    v_cvt_pk_bf16_f32 v48, v88, v89
    v_cvt_pk_bf16_f32 v49, v90, v91
    v_cvt_pk_bf16_f32 v50, v92, v93
    v_cvt_pk_bf16_f32 v51, v94, v95
    v_mfma_f32_32x32x8_bf16 v[104:119], v[24:25], v[18:19], v[104:119]
    ds_read_b128 v[20:23], v3 offset:2560
    ds_read_b64 v[24:25], v4 offset:2560
    v_exp_f32 v96, v96
    v_exp_f32 v97, v97
    v_exp_f32 v98, v98
    v_exp_f32 v99, v99
    v_mfma_f32_32x32x16_bf16 v[56:71], v[32:35], v[48:51], v[56:71]
    v_exp_f32 v100, v100
    v_exp_f32 v101, v101
    v_exp_f32 v102, v102
    v_exp_f32 v103, v103
    v_cvt_pk_bf16_f32 v52, v96, v97
    v_cvt_pk_bf16_f32 v53, v98, v99
    v_cvt_pk_bf16_f32 v54, v100, v101
    v_cvt_pk_bf16_f32 v55, v102, v103
    v_exp_f32 v104, v104
    v_exp_f32 v105, v105
    v_mfma_f32_32x32x16_bf16 v[56:71], v[36:39], v[52:55], v[56:71]
    v_exp_f32 v106, v106
    v_exp_f32 v107, v107
    v_exp_f32 v108, v108
    v_exp_f32 v109, v109
    v_mfma_f32_32x32x16_bf16 v[88:103], v[26:29], v[8:11], 0
    v_exp_f32 v110, v110
    v_exp_f32 v111, v111
    v_cvt_pk_bf16_f32 v48, v104, v105
    v_cvt_pk_bf16_f32 v49, v106, v107
    v_cvt_pk_bf16_f32 v50, v108, v109
    v_cvt_pk_bf16_f32 v51, v110, v111
    v_mfma_f32_32x32x8_bf16 v[88:103], v[30:31], v[16:17], v[88:103]
    v_exp_f32 v112, v112
    v_exp_f32 v113, v113
    v_exp_f32 v114, v114
    v_exp_f32 v115, v115
    v_mfma_f32_32x32x16_bf16 v[72:87], v[32:35], v[48:51], v[72:87]
    v_exp_f32 v116, v116
    v_exp_f32 v117, v117
    v_exp_f32 v118, v118
    v_exp_f32 v119, v119
    v_cvt_pk_bf16_f32 v52, v112, v113
    v_cvt_pk_bf16_f32 v53, v114, v115
    v_cvt_pk_bf16_f32 v54, v116, v117
    v_cvt_pk_bf16_f32 v55, v118, v119
    s_waitcnt lgkmcnt(0)
    v_exp_f32 v88, v88
    v_exp_f32 v89, v89
    v_mfma_f32_32x32x16_bf16 v[72:87], v[36:39], v[52:55], v[72:87]
    s_mov_b64 exec, s[20:21]
    ds_read_b128 v[32:35], v5 offset:2560
    ds_read_b128 v[36:39], v5 offset:3200
    s_mov_b64 exec, -1
    v_exp_f32 v90, v90
    v_exp_f32 v91, v91
    v_exp_f32 v92, v92
    v_exp_f32 v93, v93
    v_mfma_f32_32x32x16_bf16 v[104:119], v[26:29], v[12:15], 0
    v_exp_f32 v94, v94
    v_exp_f32 v95, v95
    v_cvt_pk_bf16_f32 v48, v88, v89
    v_cvt_pk_bf16_f32 v49, v90, v91
    v_cvt_pk_bf16_f32 v50, v92, v93
    v_cvt_pk_bf16_f32 v51, v94, v95
    v_mfma_f32_32x32x8_bf16 v[104:119], v[30:31], v[18:19], v[104:119]
    ds_read_b128 v[26:29], v3 offset:3840
    ds_read_b64 v[30:31], v4 offset:3840
    v_exp_f32 v96, v96
    v_exp_f32 v97, v97
    v_exp_f32 v98, v98
    v_exp_f32 v99, v99
    v_mfma_f32_32x32x16_bf16 v[56:71], v[40:43], v[48:51], v[56:71]
    v_exp_f32 v100, v100
    v_exp_f32 v101, v101
    v_exp_f32 v102, v102
    v_exp_f32 v103, v103
    v_cvt_pk_bf16_f32 v52, v96, v97
    v_cvt_pk_bf16_f32 v53, v98, v99
    v_cvt_pk_bf16_f32 v54, v100, v101
    v_cvt_pk_bf16_f32 v55, v102, v103
    v_exp_f32 v104, v104
    v_exp_f32 v105, v105
    v_mfma_f32_32x32x16_bf16 v[56:71], v[44:47], v[52:55], v[56:71]
    v_exp_f32 v106, v106
    v_exp_f32 v107, v107
    v_exp_f32 v108, v108
    v_exp_f32 v109, v109
    v_mfma_f32_32x32x16_bf16 v[88:103], v[20:23], v[8:11], 0
    v_exp_f32 v110, v110
    v_exp_f32 v111, v111
    v_cvt_pk_bf16_f32 v48, v104, v105
    v_cvt_pk_bf16_f32 v49, v106, v107
    v_cvt_pk_bf16_f32 v50, v108, v109
    v_cvt_pk_bf16_f32 v51, v110, v111
    v_mfma_f32_32x32x8_bf16 v[88:103], v[24:25], v[16:17], v[88:103]
    v_exp_f32 v112, v112
    v_exp_f32 v113, v113
    v_exp_f32 v114, v114
    v_exp_f32 v115, v115
    v_mfma_f32_32x32x16_bf16 v[72:87], v[40:43], v[48:51], v[72:87]
    v_exp_f32 v116, v116
    v_exp_f32 v117, v117
    v_exp_f32 v118, v118
    v_exp_f32 v119, v119
    v_cvt_pk_bf16_f32 v52, v112, v113
    v_cvt_pk_bf16_f32 v53, v114, v115
    v_cvt_pk_bf16_f32 v54, v116, v117
    v_cvt_pk_bf16_f32 v55, v118, v119
    s_waitcnt lgkmcnt(0)
    s_or_b32 s24, s17, s12
    s_cmp_lg_u32 s24, 0
    s_cbranch_scc1 atg0_fc
    s_mov_b32 s32, 0x40000
atg0_fl:
    s_waitcnt vmcnt(0)
    v_xor_b32 v121, s95, v121
    v_xor_b32 v122, s95, v122
    v_xor_b32 v123, s95, v123
    v_xor_b32 v124, s95, v124
    v_or3_b32 v121, v121, v122, v123
    v_or_b32 v121, v121, v124
    v_cmp_ne_u32 vcc, 0, v121
    s_nop 4
    s_cbranch_vccz atg0_fc
    s_sleep 1
    buffer_load_dword v121, v125, s[8:11], 0 offen offset:0 sc1
    buffer_load_dword v122, v125, s[8:11], 0 offen offset:4 sc1
    buffer_load_dword v123, v125, s[8:11], 0 offen offset:8 sc1
    buffer_load_dword v124, v125, s[8:11], 0 offen offset:12 sc1
    s_sub_u32 s32, s32, 1
    s_cmp_lg_u32 s32, 0
    s_cbranch_scc1 atg0_fl
atg0_fc:
    s_waitcnt vmcnt(3)
    s_barrier
    v_exp_f32 v88, v88
    v_exp_f32 v89, v89
    v_mfma_f32_32x32x16_bf16 v[72:87], v[44:47], v[52:55], v[72:87]
    s_mov_b64 exec, s[20:21]
    ds_read_b128 v[40:43], v5 offset:3840
    ds_read_b128 v[44:47], v5 offset:4480
    s_mov_b64 exec, -1
    v_exp_f32 v90, v90
    v_exp_f32 v91, v91
    v_exp_f32 v92, v92
    v_exp_f32 v93, v93
    v_mfma_f32_32x32x16_bf16 v[104:119], v[20:23], v[12:15], 0
    v_exp_f32 v94, v94
    v_exp_f32 v95, v95
    v_cvt_pk_bf16_f32 v48, v88, v89
    v_cvt_pk_bf16_f32 v49, v90, v91
    v_cvt_pk_bf16_f32 v50, v92, v93
    v_cvt_pk_bf16_f32 v51, v94, v95
    v_mfma_f32_32x32x8_bf16 v[104:119], v[24:25], v[18:19], v[104:119]
    ds_read_b128 v[20:23], v3 offset:20480
    ds_read_b64 v[24:25], v4 offset:20480
    s_add_u32 m0, s69, 61440
    v_exp_f32 v96, v96
    v_exp_f32 v97, v97
    v_exp_f32 v98, v98
    v_exp_f32 v99, v99
    v_mfma_f32_32x32x16_bf16 v[56:71], v[32:35], v[48:51], v[56:71]
    buffer_load_dwordx4 v2, s[8:11], s64 offen offset:0 sc1 lds
    v_exp_f32 v100, v100
    v_exp_f32 v101, v101
    v_exp_f32 v102, v102
    v_exp_f32 v103, v103
    v_cvt_pk_bf16_f32 v52, v96, v97
    v_cvt_pk_bf16_f32 v53, v98, v99
    v_cvt_pk_bf16_f32 v54, v100, v101
    v_cvt_pk_bf16_f32 v55, v102, v103
    v_exp_f32 v104, v104
    v_exp_f32 v105, v105
    v_mfma_f32_32x32x16_bf16 v[56:71], v[36:39], v[52:55], v[56:71]
    v_exp_f32 v106, v106
    v_exp_f32 v107, v107
    v_exp_f32 v108, v108
    v_exp_f32 v109, v109
    v_mfma_f32_32x32x16_bf16 v[88:103], v[26:29], v[8:11], 0
    v_exp_f32 v110, v110
    v_exp_f32 v111, v111
    v_cvt_pk_bf16_f32 v48, v104, v105
    v_cvt_pk_bf16_f32 v49, v106, v107
    v_cvt_pk_bf16_f32 v50, v108, v109
    v_cvt_pk_bf16_f32 v51, v110, v111
    v_mfma_f32_32x32x8_bf16 v[88:103], v[30:31], v[16:17], v[88:103]
    v_exp_f32 v112, v112
    v_exp_f32 v113, v113
    v_exp_f32 v114, v114
    v_exp_f32 v115, v115
    v_mfma_f32_32x32x16_bf16 v[72:87], v[32:35], v[48:51], v[72:87]
    buffer_load_dwordx4 v2, s[8:11], s64 offen offset:1024 sc1 lds
    v_exp_f32 v116, v116
    v_exp_f32 v117, v117
    v_exp_f32 v118, v118
    v_exp_f32 v119, v119
    v_cvt_pk_bf16_f32 v52, v112, v113
    v_cvt_pk_bf16_f32 v53, v114, v115
    v_cvt_pk_bf16_f32 v54, v116, v117
    v_cvt_pk_bf16_f32 v55, v118, v119
    s_waitcnt lgkmcnt(0)
    v_exp_f32 v88, v88
    v_exp_f32 v89, v89
    v_mfma_f32_32x32x16_bf16 v[72:87], v[36:39], v[52:55], v[72:87]
    s_mov_b64 exec, s[20:21]
    ds_read_b128 v[32:35], v5 offset:20480
    ds_read_b128 v[36:39], v5 offset:21120
    s_mov_b64 exec, -1
    v_exp_f32 v90, v90
    v_exp_f32 v91, v91
    v_exp_f32 v92, v92
    v_exp_f32 v93, v93
    v_mfma_f32_32x32x16_bf16 v[104:119], v[26:29], v[12:15], 0
    v_exp_f32 v94, v94
    v_exp_f32 v95, v95
    v_cvt_pk_bf16_f32 v48, v88, v89
    v_cvt_pk_bf16_f32 v49, v90, v91
    v_cvt_pk_bf16_f32 v50, v92, v93
    v_cvt_pk_bf16_f32 v51, v94, v95
    v_mfma_f32_32x32x8_bf16 v[104:119], v[30:31], v[18:19], v[104:119]
    ds_read_b128 v[26:29], v3 offset:21760
    ds_read_b64 v[30:31], v4 offset:21760
    v_exp_f32 v96, v96
    v_exp_f32 v97, v97
    v_exp_f32 v98, v98
    v_exp_f32 v99, v99
    v_mfma_f32_32x32x16_bf16 v[56:71], v[40:43], v[48:51], v[56:71]
    s_mov_b64 exec, s[22:23]
    buffer_load_dwordx4 v2, s[8:11], s64 offen offset:2048 sc1 lds
    s_mov_b64 exec, -1
    v_exp_f32 v100, v100
    v_exp_f32 v101, v101
    v_exp_f32 v102, v102
    v_exp_f32 v103, v103
    v_cvt_pk_bf16_f32 v52, v96, v97
    v_cvt_pk_bf16_f32 v53, v98, v99
    v_cvt_pk_bf16_f32 v54, v100, v101
    v_cvt_pk_bf16_f32 v55, v102, v103
    v_exp_f32 v104, v104
    v_exp_f32 v105, v105
    v_mfma_f32_32x32x16_bf16 v[56:71], v[44:47], v[52:55], v[56:71]
    v_exp_f32 v106, v106
    v_exp_f32 v107, v107
    v_exp_f32 v108, v108
    v_exp_f32 v109, v109
    v_mfma_f32_32x32x16_bf16 v[88:103], v[20:23], v[8:11], 0
    v_exp_f32 v110, v110
    v_exp_f32 v111, v111
    v_cvt_pk_bf16_f32 v48, v104, v105
    v_cvt_pk_bf16_f32 v49, v106, v107
    v_cvt_pk_bf16_f32 v50, v108, v109
    v_cvt_pk_bf16_f32 v51, v110, v111
    v_mfma_f32_32x32x8_bf16 v[88:103], v[24:25], v[16:17], v[88:103]
    v_exp_f32 v112, v112
    v_exp_f32 v113, v113
    v_exp_f32 v114, v114
    v_exp_f32 v115, v115
    v_mfma_f32_32x32x16_bf16 v[72:87], v[40:43], v[48:51], v[72:87]
    v_exp_f32 v116, v116
    v_exp_f32 v117, v117
    v_exp_f32 v118, v118
    v_exp_f32 v119, v119
    v_cvt_pk_bf16_f32 v52, v112, v113
    v_cvt_pk_bf16_f32 v53, v114, v115
    v_cvt_pk_bf16_f32 v54, v116, v117
    v_cvt_pk_bf16_f32 v55, v118, v119
    s_waitcnt lgkmcnt(0)
    v_exp_f32 v88, v88
    v_exp_f32 v89, v89
    v_mfma_f32_32x32x16_bf16 v[72:87], v[44:47], v[52:55], v[72:87]
    s_mov_b64 exec, s[20:21]
    ds_read_b128 v[40:43], v5 offset:21760
    ds_read_b128 v[44:47], v5 offset:22400
    s_mov_b64 exec, -1
    v_exp_f32 v90, v90
    v_exp_f32 v91, v91
    v_exp_f32 v92, v92
    v_exp_f32 v93, v93
    v_mfma_f32_32x32x16_bf16 v[104:119], v[20:23], v[12:15], 0
    v_exp_f32 v94, v94
    v_exp_f32 v95, v95
    v_cvt_pk_bf16_f32 v48, v88, v89
    v_cvt_pk_bf16_f32 v49, v90, v91
    v_cvt_pk_bf16_f32 v50, v92, v93
    v_cvt_pk_bf16_f32 v51, v94, v95
    v_mfma_f32_32x32x8_bf16 v[104:119], v[24:25], v[18:19], v[104:119]
    ds_read_b128 v[20:23], v3 offset:23040
    ds_read_b64 v[24:25], v4 offset:23040
    v_exp_f32 v96, v96
    v_exp_f32 v97, v97
    v_exp_f32 v98, v98
    v_exp_f32 v99, v99
    v_mfma_f32_32x32x16_bf16 v[56:71], v[32:35], v[48:51], v[56:71]
    v_exp_f32 v100, v100
    v_exp_f32 v101, v101
    v_exp_f32 v102, v102
    v_exp_f32 v103, v103
    v_cvt_pk_bf16_f32 v52, v96, v97
    v_cvt_pk_bf16_f32 v53, v98, v99
    v_cvt_pk_bf16_f32 v54, v100, v101
    v_cvt_pk_bf16_f32 v55, v102, v103
    v_exp_f32 v104, v104
    v_exp_f32 v105, v105
    v_mfma_f32_32x32x16_bf16 v[56:71], v[36:39], v[52:55], v[56:71]
    v_exp_f32 v106, v106
    v_exp_f32 v107, v107
    v_exp_f32 v108, v108
    v_exp_f32 v109, v109
    v_mfma_f32_32x32x16_bf16 v[88:103], v[26:29], v[8:11], 0
    v_exp_f32 v110, v110
    v_exp_f32 v111, v111
    v_cvt_pk_bf16_f32 v48, v104, v105
    v_cvt_pk_bf16_f32 v49, v106, v107
    v_cvt_pk_bf16_f32 v50, v108, v109
    v_cvt_pk_bf16_f32 v51, v110, v111
    v_mfma_f32_32x32x8_bf16 v[88:103], v[30:31], v[16:17], v[88:103]
    v_exp_f32 v112, v112
    v_exp_f32 v113, v113
    v_exp_f32 v114, v114
    v_exp_f32 v115, v115
    v_mfma_f32_32x32x16_bf16 v[72:87], v[32:35], v[48:51], v[72:87]
    v_exp_f32 v116, v116
    v_exp_f32 v117, v117
    v_exp_f32 v118, v118
    v_exp_f32 v119, v119
    v_cvt_pk_bf16_f32 v52, v112, v113
    v_cvt_pk_bf16_f32 v53, v114, v115
    v_cvt_pk_bf16_f32 v54, v116, v117
    v_cvt_pk_bf16_f32 v55, v118, v119
    s_waitcnt lgkmcnt(0)
    v_exp_f32 v88, v88
    v_exp_f32 v89, v89
    v_mfma_f32_32x32x16_bf16 v[72:87], v[36:39], v[52:55], v[72:87]
    s_mov_b64 exec, s[20:21]
    ds_read_b128 v[32:35], v5 offset:23040
    ds_read_b128 v[36:39], v5 offset:23680
    s_mov_b64 exec, -1
    v_exp_f32 v90, v90
    v_exp_f32 v91, v91
    v_exp_f32 v92, v92
    v_exp_f32 v93, v93
    v_mfma_f32_32x32x16_bf16 v[104:119], v[26:29], v[12:15], 0
    v_exp_f32 v94, v94
    v_exp_f32 v95, v95
    v_cvt_pk_bf16_f32 v48, v88, v89
    v_cvt_pk_bf16_f32 v49, v90, v91
    v_cvt_pk_bf16_f32 v50, v92, v93
    v_cvt_pk_bf16_f32 v51, v94, v95
    v_mfma_f32_32x32x8_bf16 v[104:119], v[30:31], v[18:19], v[104:119]
    ds_read_b128 v[26:29], v3 offset:24320
    ds_read_b64 v[30:31], v4 offset:24320
    v_exp_f32 v96, v96
    v_exp_f32 v97, v97
    v_exp_f32 v98, v98
    v_exp_f32 v99, v99
    v_mfma_f32_32x32x16_bf16 v[56:71], v[40:43], v[48:51], v[56:71]
    v_exp_f32 v100, v100
    v_exp_f32 v101, v101
    v_exp_f32 v102, v102
    v_exp_f32 v103, v103
    v_cvt_pk_bf16_f32 v52, v96, v97
    v_cvt_pk_bf16_f32 v53, v98, v99
    v_cvt_pk_bf16_f32 v54, v100, v101
    v_cvt_pk_bf16_f32 v55, v102, v103
    v_exp_f32 v104, v104
    v_exp_f32 v105, v105
    v_mfma_f32_32x32x16_bf16 v[56:71], v[44:47], v[52:55], v[56:71]
    v_exp_f32 v106, v106
    v_exp_f32 v107, v107
    v_exp_f32 v108, v108
    v_exp_f32 v109, v109
    v_mfma_f32_32x32x16_bf16 v[88:103], v[20:23], v[8:11], 0
    v_exp_f32 v110, v110
    v_exp_f32 v111, v111
    v_cvt_pk_bf16_f32 v48, v104, v105
    v_cvt_pk_bf16_f32 v49, v106, v107
    v_cvt_pk_bf16_f32 v50, v108, v109
    v_cvt_pk_bf16_f32 v51, v110, v111
    v_mfma_f32_32x32x8_bf16 v[88:103], v[24:25], v[16:17], v[88:103]
    v_exp_f32 v112, v112
    v_exp_f32 v113, v113
    v_exp_f32 v114, v114
    v_exp_f32 v115, v115
    v_mfma_f32_32x32x16_bf16 v[72:87], v[40:43], v[48:51], v[72:87]
    v_exp_f32 v116, v116
    v_exp_f32 v117, v117
    v_exp_f32 v118, v118
    v_exp_f32 v119, v119
    v_cvt_pk_bf16_f32 v52, v112, v113
    v_cvt_pk_bf16_f32 v53, v114, v115
    v_cvt_pk_bf16_f32 v54, v116, v117
    v_cvt_pk_bf16_f32 v55, v118, v119
    s_waitcnt lgkmcnt(0)
    s_waitcnt vmcnt(3)
    s_barrier
    v_exp_f32 v88, v88
    v_exp_f32 v89, v89
    v_mfma_f32_32x32x16_bf16 v[72:87], v[44:47], v[52:55], v[72:87]
    s_mov_b64 exec, s[20:21]
    ds_read_b128 v[40:43], v5 offset:24320
    ds_read_b128 v[44:47], v5 offset:24960
    s_mov_b64 exec, -1
    v_exp_f32 v90, v90
    v_exp_f32 v91, v91
    v_exp_f32 v92, v92
    v_exp_f32 v93, v93
    v_mfma_f32_32x32x16_bf16 v[104:119], v[20:23], v[12:15], 0
    v_exp_f32 v94, v94
    v_exp_f32 v95, v95
    v_cvt_pk_bf16_f32 v48, v88, v89
    v_cvt_pk_bf16_f32 v49, v90, v91
    v_cvt_pk_bf16_f32 v50, v92, v93
    v_cvt_pk_bf16_f32 v51, v94, v95
    v_mfma_f32_32x32x8_bf16 v[104:119], v[24:25], v[18:19], v[104:119]
    ds_read_b128 v[20:23], v3 offset:40960
    ds_read_b64 v[24:25], v4 offset:40960
    s_add_u32 m0, s69, 0
    v_exp_f32 v96, v96
    v_exp_f32 v97, v97
    v_exp_f32 v98, v98
    v_exp_f32 v99, v99
    v_mfma_f32_32x32x16_bf16 v[56:71], v[32:35], v[48:51], v[56:71]
    buffer_load_dwordx4 v2, s[8:11], s65 offen offset:0 sc1 lds
    v_exp_f32 v100, v100
    v_exp_f32 v101, v101
    v_exp_f32 v102, v102
    v_exp_f32 v103, v103
    v_cvt_pk_bf16_f32 v52, v96, v97
    v_cvt_pk_bf16_f32 v53, v98, v99
    v_cvt_pk_bf16_f32 v54, v100, v101
    v_cvt_pk_bf16_f32 v55, v102, v103
    v_exp_f32 v104, v104
    v_exp_f32 v105, v105
    v_mfma_f32_32x32x16_bf16 v[56:71], v[36:39], v[52:55], v[56:71]
    v_exp_f32 v106, v106
    v_exp_f32 v107, v107
    v_exp_f32 v108, v108
    v_exp_f32 v109, v109
    v_mfma_f32_32x32x16_bf16 v[88:103], v[26:29], v[8:11], 0
    v_exp_f32 v110, v110
    v_exp_f32 v111, v111
    v_cvt_pk_bf16_f32 v48, v104, v105
    v_cvt_pk_bf16_f32 v49, v106, v107
    v_cvt_pk_bf16_f32 v50, v108, v109
    v_cvt_pk_bf16_f32 v51, v110, v111
    v_mfma_f32_32x32x8_bf16 v[88:103], v[30:31], v[16:17], v[88:103]
    v_exp_f32 v112, v112
    v_exp_f32 v113, v113
    v_exp_f32 v114, v114
    v_exp_f32 v115, v115
    v_mfma_f32_32x32x16_bf16 v[72:87], v[32:35], v[48:51], v[72:87]
    buffer_load_dwordx4 v2, s[8:11], s65 offen offset:1024 sc1 lds
    v_exp_f32 v116, v116
    v_exp_f32 v117, v117
    v_exp_f32 v118, v118
    v_exp_f32 v119, v119
    v_cvt_pk_bf16_f32 v52, v112, v113
    v_cvt_pk_bf16_f32 v53, v114, v115
    v_cvt_pk_bf16_f32 v54, v116, v117
    v_cvt_pk_bf16_f32 v55, v118, v119
    s_waitcnt lgkmcnt(0)
    v_exp_f32 v88, v88
    v_exp_f32 v89, v89
    v_mfma_f32_32x32x16_bf16 v[72:87], v[36:39], v[52:55], v[72:87]
    s_mov_b64 exec, s[20:21]
    ds_read_b128 v[32:35], v5 offset:40960
    ds_read_b128 v[36:39], v5 offset:41600
    s_mov_b64 exec, -1
    v_exp_f32 v90, v90
    v_exp_f32 v91, v91
    v_exp_f32 v92, v92
    v_exp_f32 v93, v93
    v_mfma_f32_32x32x16_bf16 v[104:119], v[26:29], v[12:15], 0
    v_exp_f32 v94, v94
    v_exp_f32 v95, v95
    v_cvt_pk_bf16_f32 v48, v88, v89
    v_cvt_pk_bf16_f32 v49, v90, v91
    v_cvt_pk_bf16_f32 v50, v92, v93
    v_cvt_pk_bf16_f32 v51, v94, v95
    v_mfma_f32_32x32x8_bf16 v[104:119], v[30:31], v[18:19], v[104:119]
    ds_read_b128 v[26:29], v3 offset:42240
    ds_read_b64 v[30:31], v4 offset:42240
    v_exp_f32 v96, v96
    v_exp_f32 v97, v97
    v_exp_f32 v98, v98
    v_exp_f32 v99, v99
    v_mfma_f32_32x32x16_bf16 v[56:71], v[40:43], v[48:51], v[56:71]
    s_mov_b64 exec, s[22:23]
    buffer_load_dwordx4 v2, s[8:11], s65 offen offset:2048 sc1 lds
    s_mov_b64 exec, -1
    v_exp_f32 v100, v100
    v_exp_f32 v101, v101
    v_exp_f32 v102, v102
    v_exp_f32 v103, v103
    v_cvt_pk_bf16_f32 v52, v96, v97
    v_cvt_pk_bf16_f32 v53, v98, v99
    v_cvt_pk_bf16_f32 v54, v100, v101
    v_cvt_pk_bf16_f32 v55, v102, v103
    v_exp_f32 v104, v104
    v_exp_f32 v105, v105
    v_mfma_f32_32x32x16_bf16 v[56:71], v[44:47], v[52:55], v[56:71]
    v_exp_f32 v106, v106
    v_exp_f32 v107, v107
    v_exp_f32 v108, v108
    v_exp_f32 v109, v109
    v_mfma_f32_32x32x16_bf16 v[88:103], v[20:23], v[8:11], 0
    v_exp_f32 v110, v110
    v_exp_f32 v111, v111
    v_cvt_pk_bf16_f32 v48, v104, v105
    v_cvt_pk_bf16_f32 v49, v106, v107
    v_cvt_pk_bf16_f32 v50, v108, v109
    v_cvt_pk_bf16_f32 v51, v110, v111
    v_mfma_f32_32x32x8_bf16 v[88:103], v[24:25], v[16:17], v[88:103]
    v_exp_f32 v112, v112
    v_exp_f32 v113, v113
    v_exp_f32 v114, v114
    v_exp_f32 v115, v115
    v_mfma_f32_32x32x16_bf16 v[72:87], v[40:43], v[48:51], v[72:87]
    v_exp_f32 v116, v116
    v_exp_f32 v117, v117
    v_exp_f32 v118, v118
    v_exp_f32 v119, v119
    v_cvt_pk_bf16_f32 v52, v112, v113
    v_cvt_pk_bf16_f32 v53, v114, v115
    v_cvt_pk_bf16_f32 v54, v116, v117
    v_cvt_pk_bf16_f32 v55, v118, v119
    s_waitcnt lgkmcnt(0)
    v_exp_f32 v88, v88
    v_exp_f32 v89, v89
    v_mfma_f32_32x32x16_bf16 v[72:87], v[44:47], v[52:55], v[72:87]
    s_mov_b64 exec, s[20:21]
    ds_read_b128 v[40:43], v5 offset:42240
    ds_read_b128 v[44:47], v5 offset:42880
    s_mov_b64 exec, -1
    v_exp_f32 v90, v90
    v_exp_f32 v91, v91
    v_exp_f32 v92, v92
    v_exp_f32 v93, v93
    v_mfma_f32_32x32x16_bf16 v[104:119], v[20:23], v[12:15], 0
    v_exp_f32 v94, v94
    v_exp_f32 v95, v95
    v_cvt_pk_bf16_f32 v48, v88, v89
    v_cvt_pk_bf16_f32 v49, v90, v91
    v_cvt_pk_bf16_f32 v50, v92, v93
    v_cvt_pk_bf16_f32 v51, v94, v95
    v_mfma_f32_32x32x8_bf16 v[104:119], v[24:25], v[18:19], v[104:119]
    ds_read_b128 v[20:23], v3 offset:43520
    ds_read_b64 v[24:25], v4 offset:43520
    v_exp_f32 v96, v96
    v_exp_f32 v97, v97
    v_exp_f32 v98, v98
    v_exp_f32 v99, v99
    v_mfma_f32_32x32x16_bf16 v[56:71], v[32:35], v[48:51], v[56:71]
    v_exp_f32 v100, v100
    v_exp_f32 v101, v101
    v_exp_f32 v102, v102
    v_exp_f32 v103, v103
    v_cvt_pk_bf16_f32 v52, v96, v97
    v_cvt_pk_bf16_f32 v53, v98, v99
    v_cvt_pk_bf16_f32 v54, v100, v101
    v_cvt_pk_bf16_f32 v55, v102, v103
    v_exp_f32 v104, v104
    v_exp_f32 v105, v105
    v_mfma_f32_32x32x16_bf16 v[56:71], v[36:39], v[52:55], v[56:71]
    v_exp_f32 v106, v106
    v_exp_f32 v107, v107
    v_exp_f32 v108, v108
    v_exp_f32 v109, v109
    v_mfma_f32_32x32x16_bf16 v[88:103], v[26:29], v[8:11], 0
    v_exp_f32 v110, v110
    v_exp_f32 v111, v111
    v_cvt_pk_bf16_f32 v48, v104, v105
    v_cvt_pk_bf16_f32 v49, v106, v107
    v_cvt_pk_bf16_f32 v50, v108, v109
    v_cvt_pk_bf16_f32 v51, v110, v111
    v_mfma_f32_32x32x8_bf16 v[88:103], v[30:31], v[16:17], v[88:103]
    v_exp_f32 v112, v112
    v_exp_f32 v113, v113
    v_exp_f32 v114, v114
    v_exp_f32 v115, v115
    v_mfma_f32_32x32x16_bf16 v[72:87], v[32:35], v[48:51], v[72:87]
    v_exp_f32 v116, v116
    v_exp_f32 v117, v117
    v_exp_f32 v118, v118
    v_exp_f32 v119, v119
    v_cvt_pk_bf16_f32 v52, v112, v113
    v_cvt_pk_bf16_f32 v53, v114, v115
    v_cvt_pk_bf16_f32 v54, v116, v117
    v_cvt_pk_bf16_f32 v55, v118, v119
    s_waitcnt lgkmcnt(0)
    v_exp_f32 v88, v88
    v_exp_f32 v89, v89
    v_mfma_f32_32x32x16_bf16 v[72:87], v[36:39], v[52:55], v[72:87]
    s_mov_b64 exec, s[20:21]
    ds_read_b128 v[32:35], v5 offset:43520
    ds_read_b128 v[36:39], v5 offset:44160
    s_mov_b64 exec, -1
    v_exp_f32 v90, v90
    v_exp_f32 v91, v91
    v_exp_f32 v92, v92
    v_exp_f32 v93, v93
    v_mfma_f32_32x32x16_bf16 v[104:119], v[26:29], v[12:15], 0
    v_exp_f32 v94, v94
    v_exp_f32 v95, v95
    v_cvt_pk_bf16_f32 v48, v88, v89
    v_cvt_pk_bf16_f32 v49, v90, v91
    v_cvt_pk_bf16_f32 v50, v92, v93
    v_cvt_pk_bf16_f32 v51, v94, v95
    v_mfma_f32_32x32x8_bf16 v[104:119], v[30:31], v[18:19], v[104:119]
    ds_read_b128 v[26:29], v3 offset:44800
    ds_read_b64 v[30:31], v4 offset:44800
    v_exp_f32 v96, v96
    v_exp_f32 v97, v97
    v_exp_f32 v98, v98
    v_exp_f32 v99, v99
    v_mfma_f32_32x32x16_bf16 v[56:71], v[40:43], v[48:51], v[56:71]
    v_exp_f32 v100, v100
    v_exp_f32 v101, v101
    v_exp_f32 v102, v102
    v_exp_f32 v103, v103
    v_cvt_pk_bf16_f32 v52, v96, v97
    v_cvt_pk_bf16_f32 v53, v98, v99
    v_cvt_pk_bf16_f32 v54, v100, v101
    v_cvt_pk_bf16_f32 v55, v102, v103
    v_exp_f32 v104, v104
    v_exp_f32 v105, v105
    v_mfma_f32_32x32x16_bf16 v[56:71], v[44:47], v[52:55], v[56:71]
    v_exp_f32 v106, v106
    v_exp_f32 v107, v107
    v_exp_f32 v108, v108
    v_exp_f32 v109, v109
    v_mfma_f32_32x32x16_bf16 v[88:103], v[20:23], v[8:11], 0
    v_exp_f32 v110, v110
    v_exp_f32 v111, v111
    v_cvt_pk_bf16_f32 v48, v104, v105
    v_cvt_pk_bf16_f32 v49, v106, v107
    v_cvt_pk_bf16_f32 v50, v108, v109
    v_cvt_pk_bf16_f32 v51, v110, v111
    v_mfma_f32_32x32x8_bf16 v[88:103], v[24:25], v[16:17], v[88:103]
    v_exp_f32 v112, v112
    v_exp_f32 v113, v113
    v_exp_f32 v114, v114
    v_exp_f32 v115, v115
    v_mfma_f32_32x32x16_bf16 v[72:87], v[40:43], v[48:51], v[72:87]
    v_exp_f32 v116, v116
    v_exp_f32 v117, v117
    v_exp_f32 v118, v118
    v_exp_f32 v119, v119
    v_cvt_pk_bf16_f32 v52, v112, v113
    v_cvt_pk_bf16_f32 v53, v114, v115
    v_cvt_pk_bf16_f32 v54, v116, v117
    v_cvt_pk_bf16_f32 v55, v118, v119
    s_waitcnt lgkmcnt(0)
    s_waitcnt vmcnt(3)
    s_barrier
    v_exp_f32 v88, v88
    v_exp_f32 v89, v89
    v_mfma_f32_32x32x16_bf16 v[72:87], v[44:47], v[52:55], v[72:87]
    s_mov_b64 exec, s[20:21]
    ds_read_b128 v[40:43], v5 offset:44800
    ds_read_b128 v[44:47], v5 offset:45440
    s_mov_b64 exec, -1
    v_exp_f32 v90, v90
    v_exp_f32 v91, v91
    v_exp_f32 v92, v92
    v_exp_f32 v93, v93
    v_mfma_f32_32x32x16_bf16 v[104:119], v[20:23], v[12:15], 0
    v_exp_f32 v94, v94
    v_exp_f32 v95, v95
    v_cvt_pk_bf16_f32 v48, v88, v89
    v_cvt_pk_bf16_f32 v49, v90, v91
    v_cvt_pk_bf16_f32 v50, v92, v93
    v_cvt_pk_bf16_f32 v51, v94, v95
    v_mfma_f32_32x32x8_bf16 v[104:119], v[24:25], v[18:19], v[104:119]
    ds_read_b128 v[20:23], v3 offset:61440
    ds_read_b64 v[24:25], v4 offset:61440
    s_add_u32 m0, s69, 20480
    v_exp_f32 v96, v96
    v_exp_f32 v97, v97
    v_exp_f32 v98, v98
    v_exp_f32 v99, v99
    v_mfma_f32_32x32x16_bf16 v[56:71], v[32:35], v[48:51], v[56:71]
    buffer_load_dwordx4 v2, s[8:11], s66 offen offset:0 sc1 lds
    v_exp_f32 v100, v100
    v_exp_f32 v101, v101
    v_exp_f32 v102, v102
    v_exp_f32 v103, v103
    v_cvt_pk_bf16_f32 v52, v96, v97
    v_cvt_pk_bf16_f32 v53, v98, v99
    v_cvt_pk_bf16_f32 v54, v100, v101
    v_cvt_pk_bf16_f32 v55, v102, v103
    v_exp_f32 v104, v104
    v_exp_f32 v105, v105
    v_mfma_f32_32x32x16_bf16 v[56:71], v[36:39], v[52:55], v[56:71]
    v_exp_f32 v106, v106
    v_exp_f32 v107, v107
    v_exp_f32 v108, v108
    v_exp_f32 v109, v109
    v_mfma_f32_32x32x16_bf16 v[88:103], v[26:29], v[8:11], 0
    v_exp_f32 v110, v110
    v_exp_f32 v111, v111
    v_cvt_pk_bf16_f32 v48, v104, v105
    v_cvt_pk_bf16_f32 v49, v106, v107
    v_cvt_pk_bf16_f32 v50, v108, v109
    v_cvt_pk_bf16_f32 v51, v110, v111
    v_mfma_f32_32x32x8_bf16 v[88:103], v[30:31], v[16:17], v[88:103]
    v_exp_f32 v112, v112
    v_exp_f32 v113, v113
    v_exp_f32 v114, v114
    v_exp_f32 v115, v115
    v_mfma_f32_32x32x16_bf16 v[72:87], v[32:35], v[48:51], v[72:87]
    buffer_load_dwordx4 v2, s[8:11], s66 offen offset:1024 sc1 lds
    v_exp_f32 v116, v116
    v_exp_f32 v117, v117
    v_exp_f32 v118, v118
    v_exp_f32 v119, v119
    v_cvt_pk_bf16_f32 v52, v112, v113
    v_cvt_pk_bf16_f32 v53, v114, v115
    v_cvt_pk_bf16_f32 v54, v116, v117
    v_cvt_pk_bf16_f32 v55, v118, v119
    s_waitcnt lgkmcnt(0)
    v_exp_f32 v88, v88
    v_exp_f32 v89, v89
    v_mfma_f32_32x32x16_bf16 v[72:87], v[36:39], v[52:55], v[72:87]
    s_mov_b64 exec, s[20:21]
    ds_read_b128 v[32:35], v1 offset:0
    ds_read_b128 v[36:39], v1 offset:640
    s_mov_b64 exec, -1
    v_exp_f32 v90, v90
    v_exp_f32 v91, v91
    v_exp_f32 v92, v92
    v_exp_f32 v93, v93
    v_mfma_f32_32x32x16_bf16 v[104:119], v[26:29], v[12:15], 0
    v_exp_f32 v94, v94
    v_exp_f32 v95, v95
    v_cvt_pk_bf16_f32 v48, v88, v89
    v_cvt_pk_bf16_f32 v49, v90, v91
    v_cvt_pk_bf16_f32 v50, v92, v93
    v_cvt_pk_bf16_f32 v51, v94, v95
    v_mfma_f32_32x32x8_bf16 v[104:119], v[30:31], v[18:19], v[104:119]
    ds_read_b128 v[26:29], v3 offset:62720
    ds_read_b64 v[30:31], v4 offset:62720
    v_exp_f32 v96, v96
    v_exp_f32 v97, v97
    v_exp_f32 v98, v98
    v_exp_f32 v99, v99
    v_mfma_f32_32x32x16_bf16 v[56:71], v[40:43], v[48:51], v[56:71]
    s_mov_b64 exec, s[22:23]
    buffer_load_dwordx4 v2, s[8:11], s66 offen offset:2048 sc1 lds
    s_mov_b64 exec, -1
    v_exp_f32 v100, v100
    v_exp_f32 v101, v101
    v_exp_f32 v102, v102
    v_exp_f32 v103, v103
    v_cvt_pk_bf16_f32 v52, v96, v97
    v_cvt_pk_bf16_f32 v53, v98, v99
    v_cvt_pk_bf16_f32 v54, v100, v101
    v_cvt_pk_bf16_f32 v55, v102, v103
    v_exp_f32 v104, v104
    v_exp_f32 v105, v105
    v_mfma_f32_32x32x16_bf16 v[56:71], v[44:47], v[52:55], v[56:71]
    v_exp_f32 v106, v106
    v_exp_f32 v107, v107
    v_exp_f32 v108, v108
    v_exp_f32 v109, v109
    v_mfma_f32_32x32x16_bf16 v[88:103], v[20:23], v[8:11], 0
    v_exp_f32 v110, v110
    v_exp_f32 v111, v111
    v_cvt_pk_bf16_f32 v48, v104, v105
    v_cvt_pk_bf16_f32 v49, v106, v107
    v_cvt_pk_bf16_f32 v50, v108, v109
    v_cvt_pk_bf16_f32 v51, v110, v111
    v_mfma_f32_32x32x8_bf16 v[88:103], v[24:25], v[16:17], v[88:103]
    v_exp_f32 v112, v112
    v_exp_f32 v113, v113
    v_exp_f32 v114, v114
    v_exp_f32 v115, v115
    v_mfma_f32_32x32x16_bf16 v[72:87], v[40:43], v[48:51], v[72:87]
    v_exp_f32 v116, v116
    v_exp_f32 v117, v117
    v_exp_f32 v118, v118
    v_exp_f32 v119, v119
    v_cvt_pk_bf16_f32 v52, v112, v113
    v_cvt_pk_bf16_f32 v53, v114, v115
    v_cvt_pk_bf16_f32 v54, v116, v117
    v_cvt_pk_bf16_f32 v55, v118, v119
    s_waitcnt lgkmcnt(0)
    v_exp_f32 v88, v88
    v_exp_f32 v89, v89
    v_mfma_f32_32x32x16_bf16 v[72:87], v[44:47], v[52:55], v[72:87]
    s_mov_b64 exec, s[20:21]
    ds_read_b128 v[40:43], v1 offset:1280
    ds_read_b128 v[44:47], v1 offset:1920
    s_mov_b64 exec, -1
    v_exp_f32 v90, v90
    v_exp_f32 v91, v91
    v_exp_f32 v92, v92
    v_exp_f32 v93, v93
    v_mfma_f32_32x32x16_bf16 v[104:119], v[20:23], v[12:15], 0
    v_exp_f32 v94, v94
    v_exp_f32 v95, v95
    v_cvt_pk_bf16_f32 v48, v88, v89
    v_cvt_pk_bf16_f32 v49, v90, v91
    v_cvt_pk_bf16_f32 v50, v92, v93
    v_cvt_pk_bf16_f32 v51, v94, v95
    v_mfma_f32_32x32x8_bf16 v[104:119], v[24:25], v[18:19], v[104:119]
    ds_read_b128 v[20:23], v3 offset:64000
    ds_read_b64 v[24:25], v4 offset:64000
    v_exp_f32 v96, v96
    v_exp_f32 v97, v97
    v_exp_f32 v98, v98
    v_exp_f32 v99, v99
    v_mfma_f32_32x32x16_bf16 v[56:71], v[32:35], v[48:51], v[56:71]
    v_exp_f32 v100, v100
    v_exp_f32 v101, v101
    v_exp_f32 v102, v102
    v_exp_f32 v103, v103
    v_cvt_pk_bf16_f32 v52, v96, v97
    v_cvt_pk_bf16_f32 v53, v98, v99
    v_cvt_pk_bf16_f32 v54, v100, v101
    v_cvt_pk_bf16_f32 v55, v102, v103
    v_exp_f32 v104, v104
    v_exp_f32 v105, v105
    v_mfma_f32_32x32x16_bf16 v[56:71], v[36:39], v[52:55], v[56:71]
    v_exp_f32 v106, v106
    v_exp_f32 v107, v107
    v_exp_f32 v108, v108
    v_exp_f32 v109, v109
    v_mfma_f32_32x32x16_bf16 v[88:103], v[26:29], v[8:11], 0
    v_exp_f32 v110, v110
    v_exp_f32 v111, v111
    v_cvt_pk_bf16_f32 v48, v104, v105
    v_cvt_pk_bf16_f32 v49, v106, v107
    v_cvt_pk_bf16_f32 v50, v108, v109
    v_cvt_pk_bf16_f32 v51, v110, v111
    v_mfma_f32_32x32x8_bf16 v[88:103], v[30:31], v[16:17], v[88:103]
    v_exp_f32 v112, v112
    v_exp_f32 v113, v113
    v_exp_f32 v114, v114
    v_exp_f32 v115, v115
    v_mfma_f32_32x32x16_bf16 v[72:87], v[32:35], v[48:51], v[72:87]
    v_exp_f32 v116, v116
    v_exp_f32 v117, v117
    v_exp_f32 v118, v118
    v_exp_f32 v119, v119
    v_cvt_pk_bf16_f32 v52, v112, v113
    v_cvt_pk_bf16_f32 v53, v114, v115
    v_cvt_pk_bf16_f32 v54, v116, v117
    v_cvt_pk_bf16_f32 v55, v118, v119
    s_waitcnt lgkmcnt(0)
    v_exp_f32 v88, v88
    v_exp_f32 v89, v89
    v_mfma_f32_32x32x16_bf16 v[72:87], v[36:39], v[52:55], v[72:87]
    s_mov_b64 exec, s[20:21]
    ds_read_b128 v[32:35], v1 offset:2560
    ds_read_b128 v[36:39], v1 offset:3200
    s_mov_b64 exec, -1
    v_exp_f32 v90, v90
    v_exp_f32 v91, v91
    v_exp_f32 v92, v92
    v_exp_f32 v93, v93
    v_mfma_f32_32x32x16_bf16 v[104:119], v[26:29], v[12:15], 0
    v_exp_f32 v94, v94
    v_exp_f32 v95, v95
    v_cvt_pk_bf16_f32 v48, v88, v89
    v_cvt_pk_bf16_f32 v49, v90, v91
    v_cvt_pk_bf16_f32 v50, v92, v93
    v_cvt_pk_bf16_f32 v51, v94, v95
    v_mfma_f32_32x32x8_bf16 v[104:119], v[30:31], v[18:19], v[104:119]
    ds_read_b128 v[26:29], v3 offset:65280
    ds_read_b64 v[30:31], v4 offset:65280
    v_exp_f32 v96, v96
    v_exp_f32 v97, v97
    v_exp_f32 v98, v98
    v_exp_f32 v99, v99
    v_mfma_f32_32x32x16_bf16 v[56:71], v[40:43], v[48:51], v[56:71]
    v_exp_f32 v100, v100
    v_exp_f32 v101, v101
    v_exp_f32 v102, v102
    v_exp_f32 v103, v103
    v_cvt_pk_bf16_f32 v52, v96, v97
    v_cvt_pk_bf16_f32 v53, v98, v99
    v_cvt_pk_bf16_f32 v54, v100, v101
    v_cvt_pk_bf16_f32 v55, v102, v103
    v_exp_f32 v104, v104
    v_exp_f32 v105, v105
    v_mfma_f32_32x32x16_bf16 v[56:71], v[44:47], v[52:55], v[56:71]
    v_exp_f32 v106, v106
    v_exp_f32 v107, v107
    v_exp_f32 v108, v108
    v_exp_f32 v109, v109
    v_mfma_f32_32x32x16_bf16 v[88:103], v[20:23], v[8:11], 0
    v_exp_f32 v110, v110
    v_exp_f32 v111, v111
    v_cvt_pk_bf16_f32 v48, v104, v105
    v_cvt_pk_bf16_f32 v49, v106, v107
    v_cvt_pk_bf16_f32 v50, v108, v109
    v_cvt_pk_bf16_f32 v51, v110, v111
    v_mfma_f32_32x32x8_bf16 v[88:103], v[24:25], v[16:17], v[88:103]
    v_exp_f32 v112, v112
    v_exp_f32 v113, v113
    v_exp_f32 v114, v114
    v_exp_f32 v115, v115
    v_mfma_f32_32x32x16_bf16 v[72:87], v[40:43], v[48:51], v[72:87]
    v_exp_f32 v116, v116
    v_exp_f32 v117, v117
    v_exp_f32 v118, v118
    v_exp_f32 v119, v119
    v_cvt_pk_bf16_f32 v52, v112, v113
    v_cvt_pk_bf16_f32 v53, v114, v115
    v_cvt_pk_bf16_f32 v54, v116, v117
    v_cvt_pk_bf16_f32 v55, v118, v119
    s_waitcnt lgkmcnt(0)
    s_waitcnt vmcnt(3)
    s_barrier
    v_exp_f32 v88, v88
    v_exp_f32 v89, v89
    v_mfma_f32_32x32x16_bf16 v[72:87], v[44:47], v[52:55], v[72:87]
    s_mov_b64 exec, s[20:21]
    ds_read_b128 v[40:43], v1 offset:3840
    ds_read_b128 v[44:47], v1 offset:4480
    s_mov_b64 exec, -1
    v_exp_f32 v90, v90
    v_exp_f32 v91, v91
    v_exp_f32 v92, v92
    v_exp_f32 v93, v93
    v_mfma_f32_32x32x16_bf16 v[104:119], v[20:23], v[12:15], 0
    v_exp_f32 v94, v94
    v_exp_f32 v95, v95
    v_cvt_pk_bf16_f32 v48, v88, v89
    v_cvt_pk_bf16_f32 v49, v90, v91
    v_cvt_pk_bf16_f32 v50, v92, v93
    v_cvt_pk_bf16_f32 v51, v94, v95
    v_mfma_f32_32x32x8_bf16 v[104:119], v[24:25], v[18:19], v[104:119]
    ds_read_b128 v[20:23], v3 offset:0
    ds_read_b64 v[24:25], v4 offset:0
    s_add_u32 m0, s69, 40960
    v_exp_f32 v96, v96
    v_exp_f32 v97, v97
    v_exp_f32 v98, v98
    v_exp_f32 v99, v99
    v_mfma_f32_32x32x16_bf16 v[56:71], v[32:35], v[48:51], v[56:71]
    buffer_load_dwordx4 v2, s[8:11], s67 offen offset:0 sc1 lds
    v_exp_f32 v100, v100
    v_exp_f32 v101, v101
    v_exp_f32 v102, v102
    v_exp_f32 v103, v103
    v_cvt_pk_bf16_f32 v52, v96, v97
    v_cvt_pk_bf16_f32 v53, v98, v99
    v_cvt_pk_bf16_f32 v54, v100, v101
    v_cvt_pk_bf16_f32 v55, v102, v103
    v_exp_f32 v104, v104
    v_exp_f32 v105, v105
    v_mfma_f32_32x32x16_bf16 v[56:71], v[36:39], v[52:55], v[56:71]
    v_exp_f32 v106, v106
    v_exp_f32 v107, v107
    v_exp_f32 v108, v108
    v_exp_f32 v109, v109
    v_mfma_f32_32x32x16_bf16 v[88:103], v[26:29], v[8:11], 0
    v_exp_f32 v110, v110
    v_exp_f32 v111, v111
    v_cvt_pk_bf16_f32 v48, v104, v105
    v_cvt_pk_bf16_f32 v49, v106, v107
    v_cvt_pk_bf16_f32 v50, v108, v109
    v_cvt_pk_bf16_f32 v51, v110, v111
    v_mfma_f32_32x32x8_bf16 v[88:103], v[30:31], v[16:17], v[88:103]
    v_exp_f32 v112, v112
    v_exp_f32 v113, v113
    v_exp_f32 v114, v114
    v_exp_f32 v115, v115
    v_mfma_f32_32x32x16_bf16 v[72:87], v[32:35], v[48:51], v[72:87]
    buffer_load_dwordx4 v2, s[8:11], s67 offen offset:1024 sc1 lds
    v_exp_f32 v116, v116
    v_exp_f32 v117, v117
    v_exp_f32 v118, v118
    v_exp_f32 v119, v119
    v_cvt_pk_bf16_f32 v52, v112, v113
    v_cvt_pk_bf16_f32 v53, v114, v115
    v_cvt_pk_bf16_f32 v54, v116, v117
    v_cvt_pk_bf16_f32 v55, v118, v119
    s_waitcnt lgkmcnt(0)
    v_exp_f32 v88, v88
    v_exp_f32 v89, v89
    v_mfma_f32_32x32x16_bf16 v[72:87], v[36:39], v[52:55], v[72:87]
    s_mov_b64 exec, s[20:21]
    ds_read_b128 v[32:35], v5 offset:0
    ds_read_b128 v[36:39], v5 offset:640
    s_mov_b64 exec, -1
    v_exp_f32 v90, v90
    v_exp_f32 v91, v91
    v_exp_f32 v92, v92
    v_exp_f32 v93, v93
    v_mfma_f32_32x32x16_bf16 v[104:119], v[26:29], v[12:15], 0
    v_exp_f32 v94, v94
    v_exp_f32 v95, v95
    v_cvt_pk_bf16_f32 v48, v88, v89
    v_cvt_pk_bf16_f32 v49, v90, v91
    v_cvt_pk_bf16_f32 v50, v92, v93
    v_cvt_pk_bf16_f32 v51, v94, v95
    v_mfma_f32_32x32x8_bf16 v[104:119], v[30:31], v[18:19], v[104:119]
    ds_read_b128 v[26:29], v3 offset:1280
    ds_read_b64 v[30:31], v4 offset:1280
    v_exp_f32 v96, v96
    v_exp_f32 v97, v97
    v_exp_f32 v98, v98
    v_exp_f32 v99, v99
    v_mfma_f32_32x32x16_bf16 v[56:71], v[40:43], v[48:51], v[56:71]
    s_mov_b64 exec, s[22:23]
    buffer_load_dwordx4 v2, s[8:11], s67 offen offset:2048 sc1 lds
    s_mov_b64 exec, -1
    v_exp_f32 v100, v100
    v_exp_f32 v101, v101
    v_exp_f32 v102, v102
    v_exp_f32 v103, v103
    v_cvt_pk_bf16_f32 v52, v96, v97
    v_cvt_pk_bf16_f32 v53, v98, v99
    v_cvt_pk_bf16_f32 v54, v100, v101
    v_cvt_pk_bf16_f32 v55, v102, v103
    v_exp_f32 v104, v104
    v_exp_f32 v105, v105
    v_mfma_f32_32x32x16_bf16 v[56:71], v[44:47], v[52:55], v[56:71]
    v_exp_f32 v106, v106
    v_exp_f32 v107, v107
    v_exp_f32 v108, v108
    v_exp_f32 v109, v109
    v_mfma_f32_32x32x16_bf16 v[88:103], v[20:23], v[8:11], 0
    v_exp_f32 v110, v110
    v_exp_f32 v111, v111
    v_cvt_pk_bf16_f32 v48, v104, v105
    v_cvt_pk_bf16_f32 v49, v106, v107
    v_cvt_pk_bf16_f32 v50, v108, v109
    v_cvt_pk_bf16_f32 v51, v110, v111
    v_mfma_f32_32x32x8_bf16 v[88:103], v[24:25], v[16:17], v[88:103]
    v_exp_f32 v112, v112
    v_exp_f32 v113, v113
    v_exp_f32 v114, v114
    v_exp_f32 v115, v115
    v_mfma_f32_32x32x16_bf16 v[72:87], v[40:43], v[48:51], v[72:87]
    v_exp_f32 v116, v116
    v_exp_f32 v117, v117
    v_exp_f32 v118, v118
    v_exp_f32 v119, v119
    v_cvt_pk_bf16_f32 v52, v112, v113
    v_cvt_pk_bf16_f32 v53, v114, v115
    v_cvt_pk_bf16_f32 v54, v116, v117
    v_cvt_pk_bf16_f32 v55, v118, v119
    s_waitcnt lgkmcnt(0)
    v_exp_f32 v88, v88
    v_exp_f32 v89, v89
    v_mfma_f32_32x32x16_bf16 v[72:87], v[44:47], v[52:55], v[72:87]
    s_mov_b64 exec, s[20:21]
    ds_read_b128 v[40:43], v5 offset:1280
    ds_read_b128 v[44:47], v5 offset:1920
    s_mov_b64 exec, -1
    v_exp_f32 v90, v90
    v_exp_f32 v91, v91
    v_exp_f32 v92, v92
    v_exp_f32 v93, v93
    v_mfma_f32_32x32x16_bf16 v[104:119], v[20:23], v[12:15], 0
    v_exp_f32 v94, v94
    v_exp_f32 v95, v95
    v_cvt_pk_bf16_f32 v48, v88, v89
    v_cvt_pk_bf16_f32 v49, v90, v91
    v_cvt_pk_bf16_f32 v50, v92, v93
    v_cvt_pk_bf16_f32 v51, v94, v95
    v_mfma_f32_32x32x8_bf16 v[104:119], v[24:25], v[18:19], v[104:119]
    ds_read_b128 v[20:23], v3 offset:2560
    ds_read_b64 v[24:25], v4 offset:2560
    v_exp_f32 v96, v96
    v_exp_f32 v97, v97
    v_exp_f32 v98, v98
    v_exp_f32 v99, v99
    v_mfma_f32_32x32x16_bf16 v[56:71], v[32:35], v[48:51], v[56:71]
    v_exp_f32 v100, v100
    v_exp_f32 v101, v101
    v_exp_f32 v102, v102
    v_exp_f32 v103, v103
    v_cvt_pk_bf16_f32 v52, v96, v97
    v_cvt_pk_bf16_f32 v53, v98, v99
    v_cvt_pk_bf16_f32 v54, v100, v101
    v_cvt_pk_bf16_f32 v55, v102, v103
    v_exp_f32 v104, v104
    v_exp_f32 v105, v105
    v_mfma_f32_32x32x16_bf16 v[56:71], v[36:39], v[52:55], v[56:71]
    v_exp_f32 v106, v106
    v_exp_f32 v107, v107
    v_exp_f32 v108, v108
    v_exp_f32 v109, v109
    v_mfma_f32_32x32x16_bf16 v[88:103], v[26:29], v[8:11], 0
    v_exp_f32 v110, v110
    v_exp_f32 v111, v111
    v_cvt_pk_bf16_f32 v48, v104, v105
    v_cvt_pk_bf16_f32 v49, v106, v107
    v_cvt_pk_bf16_f32 v50, v108, v109
    v_cvt_pk_bf16_f32 v51, v110, v111
    v_mfma_f32_32x32x8_bf16 v[88:103], v[30:31], v[16:17], v[88:103]
    v_exp_f32 v112, v112
    v_exp_f32 v113, v113
    v_exp_f32 v114, v114
    v_exp_f32 v115, v115
    v_mfma_f32_32x32x16_bf16 v[72:87], v[32:35], v[48:51], v[72:87]
    v_exp_f32 v116, v116
    v_exp_f32 v117, v117
    v_exp_f32 v118, v118
    v_exp_f32 v119, v119
    v_cvt_pk_bf16_f32 v52, v112, v113
    v_cvt_pk_bf16_f32 v53, v114, v115
    v_cvt_pk_bf16_f32 v54, v116, v117
    v_cvt_pk_bf16_f32 v55, v118, v119
    s_waitcnt lgkmcnt(0)
    v_exp_f32 v88, v88
    v_exp_f32 v89, v89
    v_mfma_f32_32x32x16_bf16 v[72:87], v[36:39], v[52:55], v[72:87]
    s_mov_b64 exec, s[20:21]
    ds_read_b128 v[32:35], v5 offset:2560
    ds_read_b128 v[36:39], v5 offset:3200
    s_mov_b64 exec, -1
    v_exp_f32 v90, v90
    v_exp_f32 v91, v91
    v_exp_f32 v92, v92
    v_exp_f32 v93, v93
    v_mfma_f32_32x32x16_bf16 v[104:119], v[26:29], v[12:15], 0
    v_exp_f32 v94, v94
    v_exp_f32 v95, v95
    v_cvt_pk_bf16_f32 v48, v88, v89
    v_cvt_pk_bf16_f32 v49, v90, v91
    v_cvt_pk_bf16_f32 v50, v92, v93
    v_cvt_pk_bf16_f32 v51, v94, v95
    v_mfma_f32_32x32x8_bf16 v[104:119], v[30:31], v[18:19], v[104:119]
    ds_read_b128 v[26:29], v3 offset:3840
    ds_read_b64 v[30:31], v4 offset:3840
    v_exp_f32 v96, v96
    v_exp_f32 v97, v97
    v_exp_f32 v98, v98
    v_exp_f32 v99, v99
    v_mfma_f32_32x32x16_bf16 v[56:71], v[40:43], v[48:51], v[56:71]
    v_exp_f32 v100, v100
    v_exp_f32 v101, v101
    v_exp_f32 v102, v102
    v_exp_f32 v103, v103
    v_cvt_pk_bf16_f32 v52, v96, v97
    v_cvt_pk_bf16_f32 v53, v98, v99
    v_cvt_pk_bf16_f32 v54, v100, v101
    v_cvt_pk_bf16_f32 v55, v102, v103
    v_exp_f32 v104, v104
    v_exp_f32 v105, v105
    v_mfma_f32_32x32x16_bf16 v[56:71], v[44:47], v[52:55], v[56:71]
    v_exp_f32 v106, v106
    v_exp_f32 v107, v107
    v_exp_f32 v108, v108
    v_exp_f32 v109, v109
    v_mfma_f32_32x32x16_bf16 v[88:103], v[20:23], v[8:11], 0
    v_exp_f32 v110, v110
    v_exp_f32 v111, v111
    v_cvt_pk_bf16_f32 v48, v104, v105
    v_cvt_pk_bf16_f32 v49, v106, v107
    v_cvt_pk_bf16_f32 v50, v108, v109
    v_cvt_pk_bf16_f32 v51, v110, v111
    v_mfma_f32_32x32x8_bf16 v[88:103], v[24:25], v[16:17], v[88:103]
    v_exp_f32 v112, v112
    v_exp_f32 v113, v113
    v_exp_f32 v114, v114
    v_exp_f32 v115, v115
    v_mfma_f32_32x32x16_bf16 v[72:87], v[40:43], v[48:51], v[72:87]
    v_exp_f32 v116, v116
    v_exp_f32 v117, v117
    v_exp_f32 v118, v118
    v_exp_f32 v119, v119
    v_cvt_pk_bf16_f32 v52, v112, v113
    v_cvt_pk_bf16_f32 v53, v114, v115
    v_cvt_pk_bf16_f32 v54, v116, v117
    v_cvt_pk_bf16_f32 v55, v118, v119
    s_waitcnt lgkmcnt(0)
    s_waitcnt vmcnt(3)
    s_barrier
    v_exp_f32 v88, v88
    v_exp_f32 v89, v89
    v_mfma_f32_32x32x16_bf16 v[72:87], v[44:47], v[52:55], v[72:87]
    s_mov_b64 exec, s[20:21]
    ds_read_b128 v[40:43], v5 offset:3840
    ds_read_b128 v[44:47], v5 offset:4480
    s_mov_b64 exec, -1
    v_exp_f32 v90, v90
    v_exp_f32 v91, v91
    v_exp_f32 v92, v92
    v_exp_f32 v93, v93
    v_mfma_f32_32x32x16_bf16 v[104:119], v[20:23], v[12:15], 0
    v_exp_f32 v94, v94
    v_exp_f32 v95, v95
    v_cvt_pk_bf16_f32 v48, v88, v89
    v_cvt_pk_bf16_f32 v49, v90, v91
    v_cvt_pk_bf16_f32 v50, v92, v93
    v_cvt_pk_bf16_f32 v51, v94, v95
    v_mfma_f32_32x32x8_bf16 v[104:119], v[24:25], v[18:19], v[104:119]
    ds_read_b128 v[20:23], v3 offset:20480
    ds_read_b64 v[24:25], v4 offset:20480
    s_add_u32 m0, s69, 61440
    v_exp_f32 v96, v96
    v_exp_f32 v97, v97
    v_exp_f32 v98, v98
    v_exp_f32 v99, v99
    v_mfma_f32_32x32x16_bf16 v[56:71], v[32:35], v[48:51], v[56:71]
    buffer_load_dwordx4 v2, s[8:11], s68 offen offset:0 sc1 lds
    v_exp_f32 v100, v100
    v_exp_f32 v101, v101
    v_exp_f32 v102, v102
    v_exp_f32 v103, v103
    v_cvt_pk_bf16_f32 v52, v96, v97
    v_cvt_pk_bf16_f32 v53, v98, v99
    v_cvt_pk_bf16_f32 v54, v100, v101
    v_cvt_pk_bf16_f32 v55, v102, v103
    v_exp_f32 v104, v104
    v_exp_f32 v105, v105
    v_mfma_f32_32x32x16_bf16 v[56:71], v[36:39], v[52:55], v[56:71]
    v_exp_f32 v106, v106
    v_exp_f32 v107, v107
    v_exp_f32 v108, v108
    v_exp_f32 v109, v109
    v_mfma_f32_32x32x16_bf16 v[88:103], v[26:29], v[8:11], 0
    v_exp_f32 v110, v110
    v_exp_f32 v111, v111
    v_cvt_pk_bf16_f32 v48, v104, v105
    v_cvt_pk_bf16_f32 v49, v106, v107
    v_cvt_pk_bf16_f32 v50, v108, v109
    v_cvt_pk_bf16_f32 v51, v110, v111
    v_mfma_f32_32x32x8_bf16 v[88:103], v[30:31], v[16:17], v[88:103]
    v_exp_f32 v112, v112
    v_exp_f32 v113, v113
    v_exp_f32 v114, v114
    v_exp_f32 v115, v115
    v_mfma_f32_32x32x16_bf16 v[72:87], v[32:35], v[48:51], v[72:87]
    buffer_load_dwordx4 v2, s[8:11], s68 offen offset:1024 sc1 lds
    v_exp_f32 v116, v116
    v_exp_f32 v117, v117
    v_exp_f32 v118, v118
    v_exp_f32 v119, v119
    v_cvt_pk_bf16_f32 v52, v112, v113
    v_cvt_pk_bf16_f32 v53, v114, v115
    v_cvt_pk_bf16_f32 v54, v116, v117
    v_cvt_pk_bf16_f32 v55, v118, v119
    s_waitcnt lgkmcnt(0)
    v_exp_f32 v88, v88
    v_exp_f32 v89, v89
    v_mfma_f32_32x32x16_bf16 v[72:87], v[36:39], v[52:55], v[72:87]
    s_mov_b64 exec, s[20:21]
    ds_read_b128 v[32:35], v5 offset:20480
    ds_read_b128 v[36:39], v5 offset:21120
    s_mov_b64 exec, -1
    v_exp_f32 v90, v90
    v_exp_f32 v91, v91
    v_exp_f32 v92, v92
    v_exp_f32 v93, v93
    v_mfma_f32_32x32x16_bf16 v[104:119], v[26:29], v[12:15], 0
    v_exp_f32 v94, v94
    v_exp_f32 v95, v95
    v_cvt_pk_bf16_f32 v48, v88, v89
    v_cvt_pk_bf16_f32 v49, v90, v91
    v_cvt_pk_bf16_f32 v50, v92, v93
    v_cvt_pk_bf16_f32 v51, v94, v95
    v_mfma_f32_32x32x8_bf16 v[104:119], v[30:31], v[18:19], v[104:119]
    ds_read_b128 v[26:29], v3 offset:21760
    ds_read_b64 v[30:31], v4 offset:21760
    v_exp_f32 v96, v96
    v_exp_f32 v97, v97
    v_exp_f32 v98, v98
    v_exp_f32 v99, v99
    v_mfma_f32_32x32x16_bf16 v[56:71], v[40:43], v[48:51], v[56:71]
    s_mov_b64 exec, s[22:23]
    buffer_load_dwordx4 v2, s[8:11], s68 offen offset:2048 sc1 lds
    s_mov_b64 exec, -1
    v_exp_f32 v100, v100
    v_exp_f32 v101, v101
    v_exp_f32 v102, v102
    v_exp_f32 v103, v103
    v_cvt_pk_bf16_f32 v52, v96, v97
    v_cvt_pk_bf16_f32 v53, v98, v99
    v_cvt_pk_bf16_f32 v54, v100, v101
    v_cvt_pk_bf16_f32 v55, v102, v103
    v_exp_f32 v104, v104
    v_exp_f32 v105, v105
    v_mfma_f32_32x32x16_bf16 v[56:71], v[44:47], v[52:55], v[56:71]
    v_exp_f32 v106, v106
    v_exp_f32 v107, v107
    v_exp_f32 v108, v108
    v_exp_f32 v109, v109
    v_mfma_f32_32x32x16_bf16 v[88:103], v[20:23], v[8:11], 0
    v_exp_f32 v110, v110
    v_exp_f32 v111, v111
    v_cvt_pk_bf16_f32 v48, v104, v105
    v_cvt_pk_bf16_f32 v49, v106, v107
    v_cvt_pk_bf16_f32 v50, v108, v109
    v_cvt_pk_bf16_f32 v51, v110, v111
    v_mfma_f32_32x32x8_bf16 v[88:103], v[24:25], v[16:17], v[88:103]
    v_exp_f32 v112, v112
    v_exp_f32 v113, v113
    v_exp_f32 v114, v114
    v_exp_f32 v115, v115
    v_mfma_f32_32x32x16_bf16 v[72:87], v[40:43], v[48:51], v[72:87]
    v_exp_f32 v116, v116
    v_exp_f32 v117, v117
    v_exp_f32 v118, v118
    v_exp_f32 v119, v119
    v_cvt_pk_bf16_f32 v52, v112, v113
    v_cvt_pk_bf16_f32 v53, v114, v115
    v_cvt_pk_bf16_f32 v54, v116, v117
    v_cvt_pk_bf16_f32 v55, v118, v119
    s_waitcnt lgkmcnt(0)
    v_exp_f32 v88, v88
    v_exp_f32 v89, v89
    v_mfma_f32_32x32x16_bf16 v[72:87], v[44:47], v[52:55], v[72:87]
    s_mov_b64 exec, s[20:21]
    ds_read_b128 v[40:43], v5 offset:21760
    ds_read_b128 v[44:47], v5 offset:22400
    s_mov_b64 exec, -1
    v_exp_f32 v90, v90
    v_exp_f32 v91, v91
    v_exp_f32 v92, v92
    v_exp_f32 v93, v93
    v_mfma_f32_32x32x16_bf16 v[104:119], v[20:23], v[12:15], 0
    v_exp_f32 v94, v94
    v_exp_f32 v95, v95
    v_cvt_pk_bf16_f32 v48, v88, v89
    v_cvt_pk_bf16_f32 v49, v90, v91
    v_cvt_pk_bf16_f32 v50, v92, v93
    v_cvt_pk_bf16_f32 v51, v94, v95
    v_mfma_f32_32x32x8_bf16 v[104:119], v[24:25], v[18:19], v[104:119]
    ds_read_b128 v[20:23], v3 offset:23040
    ds_read_b64 v[24:25], v4 offset:23040
    v_exp_f32 v96, v96
    v_exp_f32 v97, v97
    v_exp_f32 v98, v98
    v_exp_f32 v99, v99
    v_mfma_f32_32x32x16_bf16 v[56:71], v[32:35], v[48:51], v[56:71]
    v_exp_f32 v100, v100
    v_exp_f32 v101, v101
    v_exp_f32 v102, v102
    v_exp_f32 v103, v103
    v_cvt_pk_bf16_f32 v52, v96, v97
    v_cvt_pk_bf16_f32 v53, v98, v99
    v_cvt_pk_bf16_f32 v54, v100, v101
    v_cvt_pk_bf16_f32 v55, v102, v103
    v_exp_f32 v104, v104
    v_exp_f32 v105, v105
    v_mfma_f32_32x32x16_bf16 v[56:71], v[36:39], v[52:55], v[56:71]
    v_exp_f32 v106, v106
    v_exp_f32 v107, v107
    v_exp_f32 v108, v108
    v_exp_f32 v109, v109
    v_mfma_f32_32x32x16_bf16 v[88:103], v[26:29], v[8:11], 0
    v_exp_f32 v110, v110
    v_exp_f32 v111, v111
    v_cvt_pk_bf16_f32 v48, v104, v105
    v_cvt_pk_bf16_f32 v49, v106, v107
    v_cvt_pk_bf16_f32 v50, v108, v109
    v_cvt_pk_bf16_f32 v51, v110, v111
    v_mfma_f32_32x32x8_bf16 v[88:103], v[30:31], v[16:17], v[88:103]
    v_exp_f32 v112, v112
    v_exp_f32 v113, v113
    v_exp_f32 v114, v114
    v_exp_f32 v115, v115
    v_mfma_f32_32x32x16_bf16 v[72:87], v[32:35], v[48:51], v[72:87]
    v_exp_f32 v116, v116
    v_exp_f32 v117, v117
    v_exp_f32 v118, v118
    v_exp_f32 v119, v119
    v_cvt_pk_bf16_f32 v52, v112, v113
    v_cvt_pk_bf16_f32 v53, v114, v115
    v_cvt_pk_bf16_f32 v54, v116, v117
    v_cvt_pk_bf16_f32 v55, v118, v119
    s_waitcnt lgkmcnt(0)
    v_exp_f32 v88, v88
    v_exp_f32 v89, v89
    v_mfma_f32_32x32x16_bf16 v[72:87], v[36:39], v[52:55], v[72:87]
    s_mov_b64 exec, s[20:21]
    ds_read_b128 v[32:35], v5 offset:23040
    ds_read_b128 v[36:39], v5 offset:23680
    s_mov_b64 exec, -1
    v_exp_f32 v90, v90
    v_exp_f32 v91, v91
    v_exp_f32 v92, v92
    v_exp_f32 v93, v93
    v_mfma_f32_32x32x16_bf16 v[104:119], v[26:29], v[12:15], 0
    v_exp_f32 v94, v94
    v_exp_f32 v95, v95
    v_cvt_pk_bf16_f32 v48, v88, v89
    v_cvt_pk_bf16_f32 v49, v90, v91
    v_cvt_pk_bf16_f32 v50, v92, v93
    v_cvt_pk_bf16_f32 v51, v94, v95
    v_mfma_f32_32x32x8_bf16 v[104:119], v[30:31], v[18:19], v[104:119]
    ds_read_b128 v[26:29], v3 offset:24320
    ds_read_b64 v[30:31], v4 offset:24320
    v_exp_f32 v96, v96
    v_exp_f32 v97, v97
    v_exp_f32 v98, v98
    v_exp_f32 v99, v99
    v_mfma_f32_32x32x16_bf16 v[56:71], v[40:43], v[48:51], v[56:71]
    v_exp_f32 v100, v100
    v_exp_f32 v101, v101
    v_exp_f32 v102, v102
    v_exp_f32 v103, v103
    v_cvt_pk_bf16_f32 v52, v96, v97
    v_cvt_pk_bf16_f32 v53, v98, v99
    v_cvt_pk_bf16_f32 v54, v100, v101
    v_cvt_pk_bf16_f32 v55, v102, v103
    v_exp_f32 v104, v104
    v_exp_f32 v105, v105
    v_mfma_f32_32x32x16_bf16 v[56:71], v[44:47], v[52:55], v[56:71]
    v_exp_f32 v106, v106
    v_exp_f32 v107, v107
    v_exp_f32 v108, v108
    v_exp_f32 v109, v109
    v_mfma_f32_32x32x16_bf16 v[88:103], v[20:23], v[8:11], 0
    v_exp_f32 v110, v110
    v_exp_f32 v111, v111
    v_cvt_pk_bf16_f32 v48, v104, v105
    v_cvt_pk_bf16_f32 v49, v106, v107
    v_cvt_pk_bf16_f32 v50, v108, v109
    v_cvt_pk_bf16_f32 v51, v110, v111
    v_mfma_f32_32x32x8_bf16 v[88:103], v[24:25], v[16:17], v[88:103]
    v_exp_f32 v112, v112
    v_exp_f32 v113, v113
    v_exp_f32 v114, v114
    v_exp_f32 v115, v115
    v_mfma_f32_32x32x16_bf16 v[72:87], v[40:43], v[48:51], v[72:87]
    v_exp_f32 v116, v116
    v_exp_f32 v117, v117
    v_exp_f32 v118, v118
    v_exp_f32 v119, v119
    v_cvt_pk_bf16_f32 v52, v112, v113
    v_cvt_pk_bf16_f32 v53, v114, v115
    v_cvt_pk_bf16_f32 v54, v116, v117
    v_cvt_pk_bf16_f32 v55, v118, v119
    s_waitcnt lgkmcnt(0)
    s_waitcnt vmcnt(3)
    s_barrier
    v_exp_f32 v88, v88
    v_exp_f32 v89, v89
    v_mfma_f32_32x32x16_bf16 v[72:87], v[44:47], v[52:55], v[72:87]
    s_mov_b64 exec, s[20:21]
    ds_read_b128 v[40:43], v5 offset:24320
    ds_read_b128 v[44:47], v5 offset:24960
    s_mov_b64 exec, -1
    v_exp_f32 v90, v90
    v_exp_f32 v91, v91
    v_exp_f32 v92, v92
    v_exp_f32 v93, v93
    v_mfma_f32_32x32x16_bf16 v[104:119], v[20:23], v[12:15], 0
    v_exp_f32 v94, v94
    v_exp_f32 v95, v95
    v_cvt_pk_bf16_f32 v48, v88, v89
    v_cvt_pk_bf16_f32 v49, v90, v91
    v_cvt_pk_bf16_f32 v50, v92, v93
    v_cvt_pk_bf16_f32 v51, v94, v95
    v_mfma_f32_32x32x8_bf16 v[104:119], v[24:25], v[18:19], v[104:119]
    ds_read_b128 v[20:23], v3 offset:40960
    ds_read_b64 v[24:25], v4 offset:40960
    v_exp_f32 v96, v96
    v_exp_f32 v97, v97
    v_exp_f32 v98, v98
    v_exp_f32 v99, v99
    v_mfma_f32_32x32x16_bf16 v[56:71], v[32:35], v[48:51], v[56:71]
    v_exp_f32 v100, v100
    v_exp_f32 v101, v101
    v_exp_f32 v102, v102
    v_exp_f32 v103, v103
    v_cvt_pk_bf16_f32 v52, v96, v97
    v_cvt_pk_bf16_f32 v53, v98, v99
    v_cvt_pk_bf16_f32 v54, v100, v101
    v_cvt_pk_bf16_f32 v55, v102, v103
    v_exp_f32 v104, v104
    v_exp_f32 v105, v105
    v_mfma_f32_32x32x16_bf16 v[56:71], v[36:39], v[52:55], v[56:71]
    v_exp_f32 v106, v106
    v_exp_f32 v107, v107
    v_exp_f32 v108, v108
    v_exp_f32 v109, v109
    v_mfma_f32_32x32x16_bf16 v[88:103], v[26:29], v[8:11], 0
    v_exp_f32 v110, v110
    v_exp_f32 v111, v111
    v_cvt_pk_bf16_f32 v48, v104, v105
    v_cvt_pk_bf16_f32 v49, v106, v107
    v_cvt_pk_bf16_f32 v50, v108, v109
    v_cvt_pk_bf16_f32 v51, v110, v111
    v_mfma_f32_32x32x8_bf16 v[88:103], v[30:31], v[16:17], v[88:103]
    v_exp_f32 v112, v112
    v_exp_f32 v113, v113
    v_exp_f32 v114, v114
    v_exp_f32 v115, v115
    v_mfma_f32_32x32x16_bf16 v[72:87], v[32:35], v[48:51], v[72:87]
    v_exp_f32 v116, v116
    v_exp_f32 v117, v117
    v_exp_f32 v118, v118
    v_exp_f32 v119, v119
    v_cvt_pk_bf16_f32 v52, v112, v113
    v_cvt_pk_bf16_f32 v53, v114, v115
    v_cvt_pk_bf16_f32 v54, v116, v117
    v_cvt_pk_bf16_f32 v55, v118, v119
    s_waitcnt lgkmcnt(0)
    v_exp_f32 v88, v88
    v_exp_f32 v89, v89
    v_mfma_f32_32x32x16_bf16 v[72:87], v[36:39], v[52:55], v[72:87]
    s_mov_b64 exec, s[20:21]
    ds_read_b128 v[32:35], v5 offset:40960
    ds_read_b128 v[36:39], v5 offset:41600
    s_mov_b64 exec, -1
    v_exp_f32 v90, v90
    v_exp_f32 v91, v91
    v_exp_f32 v92, v92
    v_exp_f32 v93, v93
    v_mfma_f32_32x32x16_bf16 v[104:119], v[26:29], v[12:15], 0
    v_exp_f32 v94, v94
    v_exp_f32 v95, v95
    v_cvt_pk_bf16_f32 v48, v88, v89
    v_cvt_pk_bf16_f32 v49, v90, v91
    v_cvt_pk_bf16_f32 v50, v92, v93
    v_cvt_pk_bf16_f32 v51, v94, v95
    v_mfma_f32_32x32x8_bf16 v[104:119], v[30:31], v[18:19], v[104:119]
    ds_read_b128 v[26:29], v3 offset:42240
    ds_read_b64 v[30:31], v4 offset:42240
    v_exp_f32 v96, v96
    v_exp_f32 v97, v97
    v_exp_f32 v98, v98
    v_exp_f32 v99, v99
    v_mfma_f32_32x32x16_bf16 v[56:71], v[40:43], v[48:51], v[56:71]
    v_exp_f32 v100, v100
    v_exp_f32 v101, v101
    v_exp_f32 v102, v102
    v_exp_f32 v103, v103
    v_cvt_pk_bf16_f32 v52, v96, v97
    v_cvt_pk_bf16_f32 v53, v98, v99
    v_cvt_pk_bf16_f32 v54, v100, v101
    v_cvt_pk_bf16_f32 v55, v102, v103
    v_exp_f32 v104, v104
    v_exp_f32 v105, v105
    v_mfma_f32_32x32x16_bf16 v[56:71], v[44:47], v[52:55], v[56:71]
    v_exp_f32 v106, v106
    v_exp_f32 v107, v107
    v_exp_f32 v108, v108
    v_exp_f32 v109, v109
    v_mfma_f32_32x32x16_bf16 v[88:103], v[20:23], v[8:11], 0
    v_exp_f32 v110, v110
    v_exp_f32 v111, v111
    v_cvt_pk_bf16_f32 v48, v104, v105
    v_cvt_pk_bf16_f32 v49, v106, v107
    v_cvt_pk_bf16_f32 v50, v108, v109
    v_cvt_pk_bf16_f32 v51, v110, v111
    v_mfma_f32_32x32x8_bf16 v[88:103], v[24:25], v[16:17], v[88:103]
    v_exp_f32 v112, v112
    v_exp_f32 v113, v113
    v_exp_f32 v114, v114
    v_exp_f32 v115, v115
    v_mfma_f32_32x32x16_bf16 v[72:87], v[40:43], v[48:51], v[72:87]
    v_exp_f32 v116, v116
    v_exp_f32 v117, v117
    v_exp_f32 v118, v118
    v_exp_f32 v119, v119
    v_cvt_pk_bf16_f32 v52, v112, v113
    v_cvt_pk_bf16_f32 v53, v114, v115
    v_cvt_pk_bf16_f32 v54, v116, v117
    v_cvt_pk_bf16_f32 v55, v118, v119
    s_waitcnt lgkmcnt(0)
    v_exp_f32 v88, v88
    v_exp_f32 v89, v89
    v_mfma_f32_32x32x16_bf16 v[72:87], v[44:47], v[52:55], v[72:87]
    s_mov_b64 exec, s[20:21]
    ds_read_b128 v[40:43], v5 offset:42240
    ds_read_b128 v[44:47], v5 offset:42880
    s_mov_b64 exec, -1
    v_exp_f32 v90, v90
    v_exp_f32 v91, v91
    v_exp_f32 v92, v92
    v_exp_f32 v93, v93
    v_mfma_f32_32x32x16_bf16 v[104:119], v[20:23], v[12:15], 0
    v_exp_f32 v94, v94
    v_exp_f32 v95, v95
    v_cvt_pk_bf16_f32 v48, v88, v89
    v_cvt_pk_bf16_f32 v49, v90, v91
    v_cvt_pk_bf16_f32 v50, v92, v93
    v_cvt_pk_bf16_f32 v51, v94, v95
    v_mfma_f32_32x32x8_bf16 v[104:119], v[24:25], v[18:19], v[104:119]
    ds_read_b128 v[20:23], v3 offset:43520
    ds_read_b64 v[24:25], v4 offset:43520
    v_exp_f32 v96, v96
    v_exp_f32 v97, v97
    v_exp_f32 v98, v98
    v_exp_f32 v99, v99
    v_mfma_f32_32x32x16_bf16 v[56:71], v[32:35], v[48:51], v[56:71]
    v_exp_f32 v100, v100
    v_exp_f32 v101, v101
    v_exp_f32 v102, v102
    v_exp_f32 v103, v103
    v_cvt_pk_bf16_f32 v52, v96, v97
    v_cvt_pk_bf16_f32 v53, v98, v99
    v_cvt_pk_bf16_f32 v54, v100, v101
    v_cvt_pk_bf16_f32 v55, v102, v103
    v_exp_f32 v104, v104
    v_exp_f32 v105, v105
    v_mfma_f32_32x32x16_bf16 v[56:71], v[36:39], v[52:55], v[56:71]
    v_exp_f32 v106, v106
    v_exp_f32 v107, v107
    v_exp_f32 v108, v108
    v_exp_f32 v109, v109
    v_mfma_f32_32x32x16_bf16 v[88:103], v[26:29], v[8:11], 0
    v_exp_f32 v110, v110
    v_exp_f32 v111, v111
    v_cvt_pk_bf16_f32 v48, v104, v105
    v_cvt_pk_bf16_f32 v49, v106, v107
    v_cvt_pk_bf16_f32 v50, v108, v109
    v_cvt_pk_bf16_f32 v51, v110, v111
    v_mfma_f32_32x32x8_bf16 v[88:103], v[30:31], v[16:17], v[88:103]
    v_exp_f32 v112, v112
    v_exp_f32 v113, v113
    v_exp_f32 v114, v114
    v_exp_f32 v115, v115
    v_mfma_f32_32x32x16_bf16 v[72:87], v[32:35], v[48:51], v[72:87]
    v_exp_f32 v116, v116
    v_exp_f32 v117, v117
    v_exp_f32 v118, v118
    v_exp_f32 v119, v119
    v_cvt_pk_bf16_f32 v52, v112, v113
    v_cvt_pk_bf16_f32 v53, v114, v115
    v_cvt_pk_bf16_f32 v54, v116, v117
    v_cvt_pk_bf16_f32 v55, v118, v119
    s_waitcnt lgkmcnt(0)
    v_exp_f32 v88, v88
    v_exp_f32 v89, v89
    v_mfma_f32_32x32x16_bf16 v[72:87], v[36:39], v[52:55], v[72:87]
    s_mov_b64 exec, s[20:21]
    ds_read_b128 v[32:35], v5 offset:43520
    ds_read_b128 v[36:39], v5 offset:44160
    s_mov_b64 exec, -1
    v_exp_f32 v90, v90
    v_exp_f32 v91, v91
    v_exp_f32 v92, v92
    v_exp_f32 v93, v93
    v_mfma_f32_32x32x16_bf16 v[104:119], v[26:29], v[12:15], 0
    v_exp_f32 v94, v94
    v_exp_f32 v95, v95
    v_cvt_pk_bf16_f32 v48, v88, v89
    v_cvt_pk_bf16_f32 v49, v90, v91
    v_cvt_pk_bf16_f32 v50, v92, v93
    v_cvt_pk_bf16_f32 v51, v94, v95
    v_mfma_f32_32x32x8_bf16 v[104:119], v[30:31], v[18:19], v[104:119]
    ds_read_b128 v[26:29], v3 offset:44800
    ds_read_b64 v[30:31], v4 offset:44800
    v_exp_f32 v96, v96
    v_exp_f32 v97, v97
    v_exp_f32 v98, v98
    v_exp_f32 v99, v99
    v_mfma_f32_32x32x16_bf16 v[56:71], v[40:43], v[48:51], v[56:71]
    v_exp_f32 v100, v100
    v_exp_f32 v101, v101
    v_exp_f32 v102, v102
    v_exp_f32 v103, v103
    v_cvt_pk_bf16_f32 v52, v96, v97
    v_cvt_pk_bf16_f32 v53, v98, v99
    v_cvt_pk_bf16_f32 v54, v100, v101
    v_cvt_pk_bf16_f32 v55, v102, v103
    v_exp_f32 v104, v104
    v_exp_f32 v105, v105
    v_mfma_f32_32x32x16_bf16 v[56:71], v[44:47], v[52:55], v[56:71]
    v_exp_f32 v106, v106
    v_exp_f32 v107, v107
    v_exp_f32 v108, v108
    v_exp_f32 v109, v109
    v_mfma_f32_32x32x16_bf16 v[88:103], v[20:23], v[8:11], 0
    v_exp_f32 v110, v110
    v_exp_f32 v111, v111
    v_cvt_pk_bf16_f32 v48, v104, v105
    v_cvt_pk_bf16_f32 v49, v106, v107
    v_cvt_pk_bf16_f32 v50, v108, v109
    v_cvt_pk_bf16_f32 v51, v110, v111
    v_mfma_f32_32x32x8_bf16 v[88:103], v[24:25], v[16:17], v[88:103]
    v_exp_f32 v112, v112
    v_exp_f32 v113, v113
    v_exp_f32 v114, v114
    v_exp_f32 v115, v115
    v_mfma_f32_32x32x16_bf16 v[72:87], v[40:43], v[48:51], v[72:87]
    v_exp_f32 v116, v116
    v_exp_f32 v117, v117
    v_exp_f32 v118, v118
    v_exp_f32 v119, v119
    v_cvt_pk_bf16_f32 v52, v112, v113
    v_cvt_pk_bf16_f32 v53, v114, v115
    v_cvt_pk_bf16_f32 v54, v116, v117
    v_cvt_pk_bf16_f32 v55, v118, v119
    s_waitcnt lgkmcnt(0)
    s_waitcnt vmcnt(0)
    s_barrier
    v_exp_f32 v88, v88
    v_exp_f32 v89, v89
    v_mfma_f32_32x32x16_bf16 v[72:87], v[44:47], v[52:55], v[72:87]
    s_mov_b64 exec, s[20:21]
    ds_read_b128 v[40:43], v5 offset:44800
    ds_read_b128 v[44:47], v5 offset:45440
    s_mov_b64 exec, -1
    v_exp_f32 v90, v90
    v_exp_f32 v91, v91
    v_exp_f32 v92, v92
    v_exp_f32 v93, v93
    v_mfma_f32_32x32x16_bf16 v[104:119], v[20:23], v[12:15], 0
    v_exp_f32 v94, v94
    v_exp_f32 v95, v95
    v_cvt_pk_bf16_f32 v48, v88, v89
    v_cvt_pk_bf16_f32 v49, v90, v91
    v_cvt_pk_bf16_f32 v50, v92, v93
    v_cvt_pk_bf16_f32 v51, v94, v95
    v_mfma_f32_32x32x8_bf16 v[104:119], v[24:25], v[18:19], v[104:119]
    ds_read_b128 v[20:23], v3 offset:61440
    ds_read_b64 v[24:25], v4 offset:61440
    v_exp_f32 v96, v96
    v_exp_f32 v97, v97
    v_exp_f32 v98, v98
    v_exp_f32 v99, v99
    v_mfma_f32_32x32x16_bf16 v[56:71], v[32:35], v[48:51], v[56:71]
    v_exp_f32 v100, v100
    v_exp_f32 v101, v101
    v_exp_f32 v102, v102
    v_exp_f32 v103, v103
    v_cvt_pk_bf16_f32 v52, v96, v97
    v_cvt_pk_bf16_f32 v53, v98, v99
    v_cvt_pk_bf16_f32 v54, v100, v101
    v_cvt_pk_bf16_f32 v55, v102, v103
    v_exp_f32 v104, v104
    v_exp_f32 v105, v105
    v_mfma_f32_32x32x16_bf16 v[56:71], v[36:39], v[52:55], v[56:71]
    v_exp_f32 v106, v106
    v_exp_f32 v107, v107
    v_exp_f32 v108, v108
    v_exp_f32 v109, v109
    v_mfma_f32_32x32x16_bf16 v[88:103], v[26:29], v[8:11], 0
    v_exp_f32 v110, v110
    v_exp_f32 v111, v111
    v_cvt_pk_bf16_f32 v48, v104, v105
    v_cvt_pk_bf16_f32 v49, v106, v107
    v_cvt_pk_bf16_f32 v50, v108, v109
    v_cvt_pk_bf16_f32 v51, v110, v111
    v_mfma_f32_32x32x8_bf16 v[88:103], v[30:31], v[16:17], v[88:103]
    v_exp_f32 v112, v112
    v_exp_f32 v113, v113
    v_exp_f32 v114, v114
    v_exp_f32 v115, v115
    v_mfma_f32_32x32x16_bf16 v[72:87], v[32:35], v[48:51], v[72:87]
    v_exp_f32 v116, v116
    v_exp_f32 v117, v117
    v_exp_f32 v118, v118
    v_exp_f32 v119, v119
    v_cvt_pk_bf16_f32 v52, v112, v113
    v_cvt_pk_bf16_f32 v53, v114, v115
    v_cvt_pk_bf16_f32 v54, v116, v117
    v_cvt_pk_bf16_f32 v55, v118, v119
    s_waitcnt lgkmcnt(0)
    v_exp_f32 v88, v88
    v_exp_f32 v89, v89
    v_mfma_f32_32x32x16_bf16 v[72:87], v[36:39], v[52:55], v[72:87]
    s_mov_b64 exec, s[20:21]
    ds_read_b128 v[32:35], v1 offset:0
    ds_read_b128 v[36:39], v1 offset:640
    s_mov_b64 exec, -1
    v_exp_f32 v90, v90
    v_exp_f32 v91, v91
    v_exp_f32 v92, v92
    v_exp_f32 v93, v93
    v_mfma_f32_32x32x16_bf16 v[104:119], v[26:29], v[12:15], 0
    v_exp_f32 v94, v94
    v_exp_f32 v95, v95
    v_cvt_pk_bf16_f32 v48, v88, v89
    v_cvt_pk_bf16_f32 v49, v90, v91
    v_cvt_pk_bf16_f32 v50, v92, v93
    v_cvt_pk_bf16_f32 v51, v94, v95
    v_mfma_f32_32x32x8_bf16 v[104:119], v[30:31], v[18:19], v[104:119]
    ds_read_b128 v[26:29], v3 offset:62720
    ds_read_b64 v[30:31], v4 offset:62720
    v_exp_f32 v96, v96
    v_exp_f32 v97, v97
    v_exp_f32 v98, v98
    v_exp_f32 v99, v99
    v_mfma_f32_32x32x16_bf16 v[56:71], v[40:43], v[48:51], v[56:71]
    v_exp_f32 v100, v100
    v_exp_f32 v101, v101
    v_exp_f32 v102, v102
    v_exp_f32 v103, v103
    v_cvt_pk_bf16_f32 v52, v96, v97
    v_cvt_pk_bf16_f32 v53, v98, v99
    v_cvt_pk_bf16_f32 v54, v100, v101
    v_cvt_pk_bf16_f32 v55, v102, v103
    v_exp_f32 v104, v104
    v_exp_f32 v105, v105
    v_mfma_f32_32x32x16_bf16 v[56:71], v[44:47], v[52:55], v[56:71]
    v_exp_f32 v106, v106
    v_exp_f32 v107, v107
    v_exp_f32 v108, v108
    v_exp_f32 v109, v109
    v_mfma_f32_32x32x16_bf16 v[88:103], v[20:23], v[8:11], 0
    v_exp_f32 v110, v110
    v_exp_f32 v111, v111
    v_cvt_pk_bf16_f32 v48, v104, v105
    v_cvt_pk_bf16_f32 v49, v106, v107
    v_cvt_pk_bf16_f32 v50, v108, v109
    v_cvt_pk_bf16_f32 v51, v110, v111
    v_mfma_f32_32x32x8_bf16 v[88:103], v[24:25], v[16:17], v[88:103]
    v_exp_f32 v112, v112
    v_exp_f32 v113, v113
    v_exp_f32 v114, v114
    v_exp_f32 v115, v115
    v_mfma_f32_32x32x16_bf16 v[72:87], v[40:43], v[48:51], v[72:87]
    v_exp_f32 v116, v116
    v_exp_f32 v117, v117
    v_exp_f32 v118, v118
    v_exp_f32 v119, v119
    v_cvt_pk_bf16_f32 v52, v112, v113
    v_cvt_pk_bf16_f32 v53, v114, v115
    v_cvt_pk_bf16_f32 v54, v116, v117
    v_cvt_pk_bf16_f32 v55, v118, v119
    s_waitcnt lgkmcnt(0)
    v_exp_f32 v88, v88
    v_exp_f32 v89, v89
    v_mfma_f32_32x32x16_bf16 v[72:87], v[44:47], v[52:55], v[72:87]
    s_mov_b64 exec, s[20:21]
    ds_read_b128 v[40:43], v1 offset:1280
    ds_read_b128 v[44:47], v1 offset:1920
    s_mov_b64 exec, -1
    v_exp_f32 v90, v90
    v_exp_f32 v91, v91
    v_exp_f32 v92, v92
    v_exp_f32 v93, v93
    v_mfma_f32_32x32x16_bf16 v[104:119], v[20:23], v[12:15], 0
    v_exp_f32 v94, v94
    v_exp_f32 v95, v95
    v_cvt_pk_bf16_f32 v48, v88, v89
    v_cvt_pk_bf16_f32 v49, v90, v91
    v_cvt_pk_bf16_f32 v50, v92, v93
    v_cvt_pk_bf16_f32 v51, v94, v95
    v_mfma_f32_32x32x8_bf16 v[104:119], v[24:25], v[18:19], v[104:119]
    ds_read_b128 v[20:23], v3 offset:64000
    ds_read_b64 v[24:25], v4 offset:64000
    v_exp_f32 v96, v96
    v_exp_f32 v97, v97
    v_exp_f32 v98, v98
    v_exp_f32 v99, v99
    v_mfma_f32_32x32x16_bf16 v[56:71], v[32:35], v[48:51], v[56:71]
    v_exp_f32 v100, v100
    v_exp_f32 v101, v101
    v_exp_f32 v102, v102
    v_exp_f32 v103, v103
    v_cvt_pk_bf16_f32 v52, v96, v97
    v_cvt_pk_bf16_f32 v53, v98, v99
    v_cvt_pk_bf16_f32 v54, v100, v101
    v_cvt_pk_bf16_f32 v55, v102, v103
    v_exp_f32 v104, v104
    v_exp_f32 v105, v105
    v_mfma_f32_32x32x16_bf16 v[56:71], v[36:39], v[52:55], v[56:71]
    v_exp_f32 v106, v106
    v_exp_f32 v107, v107
    v_exp_f32 v108, v108
    v_exp_f32 v109, v109
    v_mfma_f32_32x32x16_bf16 v[88:103], v[26:29], v[8:11], 0
    v_exp_f32 v110, v110
    v_exp_f32 v111, v111
    v_cvt_pk_bf16_f32 v48, v104, v105
    v_cvt_pk_bf16_f32 v49, v106, v107
    v_cvt_pk_bf16_f32 v50, v108, v109
    v_cvt_pk_bf16_f32 v51, v110, v111
    v_mfma_f32_32x32x8_bf16 v[88:103], v[30:31], v[16:17], v[88:103]
    v_exp_f32 v112, v112
    v_exp_f32 v113, v113
    v_exp_f32 v114, v114
    v_exp_f32 v115, v115
    v_mfma_f32_32x32x16_bf16 v[72:87], v[32:35], v[48:51], v[72:87]
    v_exp_f32 v116, v116
    v_exp_f32 v117, v117
    v_exp_f32 v118, v118
    v_exp_f32 v119, v119
    v_cvt_pk_bf16_f32 v52, v112, v113
    v_cvt_pk_bf16_f32 v53, v114, v115
    v_cvt_pk_bf16_f32 v54, v116, v117
    v_cvt_pk_bf16_f32 v55, v118, v119
    s_waitcnt lgkmcnt(0)
    v_exp_f32 v88, v88
    v_exp_f32 v89, v89
    v_mfma_f32_32x32x16_bf16 v[72:87], v[36:39], v[52:55], v[72:87]
    s_mov_b64 exec, s[20:21]
    ds_read_b128 v[32:35], v1 offset:2560
    ds_read_b128 v[36:39], v1 offset:3200
    s_mov_b64 exec, -1
    v_exp_f32 v90, v90
    v_exp_f32 v91, v91
    v_exp_f32 v92, v92
    v_exp_f32 v93, v93
    v_mfma_f32_32x32x16_bf16 v[104:119], v[26:29], v[12:15], 0
    v_exp_f32 v94, v94
    v_exp_f32 v95, v95
    v_cvt_pk_bf16_f32 v48, v88, v89
    v_cvt_pk_bf16_f32 v49, v90, v91
    v_cvt_pk_bf16_f32 v50, v92, v93
    v_cvt_pk_bf16_f32 v51, v94, v95
    v_mfma_f32_32x32x8_bf16 v[104:119], v[30:31], v[18:19], v[104:119]
    ds_read_b128 v[26:29], v3 offset:65280
    ds_read_b64 v[30:31], v4 offset:65280
    v_exp_f32 v96, v96
    v_exp_f32 v97, v97
    v_exp_f32 v98, v98
    v_exp_f32 v99, v99
    v_mfma_f32_32x32x16_bf16 v[56:71], v[40:43], v[48:51], v[56:71]
    v_exp_f32 v100, v100
    v_exp_f32 v101, v101
    v_exp_f32 v102, v102
    v_exp_f32 v103, v103
    v_cvt_pk_bf16_f32 v52, v96, v97
    v_cvt_pk_bf16_f32 v53, v98, v99
    v_cvt_pk_bf16_f32 v54, v100, v101
    v_cvt_pk_bf16_f32 v55, v102, v103
    v_exp_f32 v104, v104
    v_exp_f32 v105, v105
    v_mfma_f32_32x32x16_bf16 v[56:71], v[44:47], v[52:55], v[56:71]
    v_exp_f32 v106, v106
    v_exp_f32 v107, v107
    v_exp_f32 v108, v108
    v_exp_f32 v109, v109
    v_mfma_f32_32x32x16_bf16 v[88:103], v[20:23], v[8:11], 0
    v_exp_f32 v110, v110
    v_exp_f32 v111, v111
    v_cvt_pk_bf16_f32 v48, v104, v105
    v_cvt_pk_bf16_f32 v49, v106, v107
    v_cvt_pk_bf16_f32 v50, v108, v109
    v_cvt_pk_bf16_f32 v51, v110, v111
    v_mfma_f32_32x32x8_bf16 v[88:103], v[24:25], v[16:17], v[88:103]
    v_exp_f32 v112, v112
    v_exp_f32 v113, v113
    v_exp_f32 v114, v114
    v_exp_f32 v115, v115
    v_mfma_f32_32x32x16_bf16 v[72:87], v[40:43], v[48:51], v[72:87]
    v_exp_f32 v116, v116
    v_exp_f32 v117, v117
    v_exp_f32 v118, v118
    v_exp_f32 v119, v119
    v_cvt_pk_bf16_f32 v52, v112, v113
    v_cvt_pk_bf16_f32 v53, v114, v115
    v_cvt_pk_bf16_f32 v54, v116, v117
    v_cvt_pk_bf16_f32 v55, v118, v119
    s_waitcnt lgkmcnt(0)
    v_exp_f32 v88, v88
    v_exp_f32 v89, v89
    v_mfma_f32_32x32x16_bf16 v[72:87], v[44:47], v[52:55], v[72:87]
    s_mov_b64 exec, s[20:21]
    ds_read_b128 v[40:43], v1 offset:3840
    ds_read_b128 v[44:47], v1 offset:4480
    s_mov_b64 exec, -1
    v_exp_f32 v90, v90
    v_exp_f32 v91, v91
    v_exp_f32 v92, v92
    v_exp_f32 v93, v93
    v_mfma_f32_32x32x16_bf16 v[104:119], v[20:23], v[12:15], 0
    v_exp_f32 v94, v94
    v_exp_f32 v95, v95
    v_cvt_pk_bf16_f32 v48, v88, v89
    v_cvt_pk_bf16_f32 v49, v90, v91
    v_cvt_pk_bf16_f32 v50, v92, v93
    v_cvt_pk_bf16_f32 v51, v94, v95
    v_mfma_f32_32x32x8_bf16 v[104:119], v[24:25], v[18:19], v[104:119]
    v_exp_f32 v96, v96
    v_exp_f32 v97, v97
    v_exp_f32 v98, v98
    v_exp_f32 v99, v99
    v_mfma_f32_32x32x16_bf16 v[56:71], v[32:35], v[48:51], v[56:71]
    v_exp_f32 v100, v100
    v_exp_f32 v101, v101
    v_exp_f32 v102, v102
    v_exp_f32 v103, v103
    v_cvt_pk_bf16_f32 v52, v96, v97
    v_cvt_pk_bf16_f32 v53, v98, v99
    v_cvt_pk_bf16_f32 v54, v100, v101
    v_cvt_pk_bf16_f32 v55, v102, v103
    v_exp_f32 v104, v104
    v_exp_f32 v105, v105
    v_mfma_f32_32x32x16_bf16 v[56:71], v[36:39], v[52:55], v[56:71]
    v_exp_f32 v106, v106
    v_exp_f32 v107, v107
    v_exp_f32 v108, v108
    v_exp_f32 v109, v109
    v_mfma_f32_32x32x16_bf16 v[88:103], v[26:29], v[8:11], 0
    v_exp_f32 v110, v110
    v_exp_f32 v111, v111
    v_cvt_pk_bf16_f32 v48, v104, v105
    v_cvt_pk_bf16_f32 v49, v106, v107
    v_cvt_pk_bf16_f32 v50, v108, v109
    v_cvt_pk_bf16_f32 v51, v110, v111
    v_mfma_f32_32x32x8_bf16 v[88:103], v[30:31], v[16:17], v[88:103]
    v_exp_f32 v112, v112
    v_exp_f32 v113, v113
    v_exp_f32 v114, v114
    v_exp_f32 v115, v115
    v_mfma_f32_32x32x16_bf16 v[72:87], v[32:35], v[48:51], v[72:87]
    v_exp_f32 v116, v116
    v_exp_f32 v117, v117
    v_exp_f32 v118, v118
    v_exp_f32 v119, v119
    v_cvt_pk_bf16_f32 v52, v112, v113
    v_cvt_pk_bf16_f32 v53, v114, v115
    v_cvt_pk_bf16_f32 v54, v116, v117
    v_cvt_pk_bf16_f32 v55, v118, v119
    s_waitcnt lgkmcnt(0)
    v_exp_f32 v88, v88
    v_exp_f32 v89, v89
    v_mfma_f32_32x32x16_bf16 v[72:87], v[36:39], v[52:55], v[72:87]
    v_exp_f32 v90, v90
    v_exp_f32 v91, v91
    v_exp_f32 v92, v92
    v_exp_f32 v93, v93
    v_mfma_f32_32x32x16_bf16 v[104:119], v[26:29], v[12:15], 0
    v_exp_f32 v94, v94
    v_exp_f32 v95, v95
    v_cvt_pk_bf16_f32 v48, v88, v89
    v_cvt_pk_bf16_f32 v49, v90, v91
    v_cvt_pk_bf16_f32 v50, v92, v93
    v_cvt_pk_bf16_f32 v51, v94, v95
    v_mfma_f32_32x32x8_bf16 v[104:119], v[30:31], v[18:19], v[104:119]
    v_exp_f32 v96, v96
    v_exp_f32 v97, v97
    v_exp_f32 v98, v98
    v_exp_f32 v99, v99
    v_mfma_f32_32x32x16_bf16 v[56:71], v[40:43], v[48:51], v[56:71]
    v_exp_f32 v100, v100
    v_exp_f32 v101, v101
    v_exp_f32 v102, v102
    v_exp_f32 v103, v103
    v_cvt_pk_bf16_f32 v52, v96, v97
    v_cvt_pk_bf16_f32 v53, v98, v99
    v_cvt_pk_bf16_f32 v54, v100, v101
    v_cvt_pk_bf16_f32 v55, v102, v103
    v_exp_f32 v104, v104
    v_exp_f32 v105, v105
    v_mfma_f32_32x32x16_bf16 v[56:71], v[44:47], v[52:55], v[56:71]
    v_exp_f32 v106, v106
    v_exp_f32 v107, v107
    v_exp_f32 v108, v108
    v_exp_f32 v109, v109
    v_exp_f32 v110, v110
    v_exp_f32 v111, v111
    v_cvt_pk_bf16_f32 v48, v104, v105
    v_cvt_pk_bf16_f32 v49, v106, v107
    v_cvt_pk_bf16_f32 v50, v108, v109
    v_cvt_pk_bf16_f32 v51, v110, v111
    v_exp_f32 v112, v112
    v_exp_f32 v113, v113
    v_exp_f32 v114, v114
    v_exp_f32 v115, v115
    v_mfma_f32_32x32x16_bf16 v[72:87], v[40:43], v[48:51], v[72:87]
    v_exp_f32 v116, v116
    v_exp_f32 v117, v117
    v_exp_f32 v118, v118
    v_exp_f32 v119, v119
    v_cvt_pk_bf16_f32 v52, v112, v113
    v_cvt_pk_bf16_f32 v53, v114, v115
    v_cvt_pk_bf16_f32 v54, v116, v117
    v_cvt_pk_bf16_f32 v55, v118, v119
    s_branch at_done
    .p2align 6
at_g1:
    s_waitcnt lgkmcnt(0)
    v_exp_f32 v88, v88
    v_exp_f32 v89, v89
    v_mfma_f32_32x32x16_bf16 v[72:87], v[44:47], v[52:55], v[72:87]
    s_mov_b64 exec, s[20:21]
    ds_read_b128 v[40:43], v5 offset:1280
    ds_read_b128 v[44:47], v5 offset:1920
    s_mov_b64 exec, -1
    v_exp_f32 v90, v90
    v_exp_f32 v91, v91
    v_exp_f32 v92, v92
    v_exp_f32 v93, v93
    v_mfma_f32_32x32x16_bf16 v[104:119], v[20:23], v[12:15], 0
    v_exp_f32 v94, v94
    v_exp_f32 v95, v95
    v_cvt_pk_bf16_f32 v48, v88, v89
    v_cvt_pk_bf16_f32 v49, v90, v91
    v_cvt_pk_bf16_f32 v50, v92, v93
    v_cvt_pk_bf16_f32 v51, v94, v95
    v_mfma_f32_32x32x8_bf16 v[104:119], v[24:25], v[18:19], v[104:119]
    ds_read_b128 v[20:23], v3 offset:2560
    ds_read_b64 v[24:25], v4 offset:2560
    v_exp_f32 v96, v96
    v_exp_f32 v97, v97
    v_exp_f32 v98, v98
    v_exp_f32 v99, v99
    v_mfma_f32_32x32x16_bf16 v[56:71], v[32:35], v[48:51], v[56:71]
    v_exp_f32 v100, v100
    v_exp_f32 v101, v101
    v_exp_f32 v102, v102
    v_exp_f32 v103, v103
    v_cvt_pk_bf16_f32 v52, v96, v97
    v_cvt_pk_bf16_f32 v53, v98, v99
    v_cvt_pk_bf16_f32 v54, v100, v101
    v_cvt_pk_bf16_f32 v55, v102, v103
    v_exp_f32 v104, v104
    v_exp_f32 v105, v105
    v_mfma_f32_32x32x16_bf16 v[56:71], v[36:39], v[52:55], v[56:71]
    v_exp_f32 v106, v106
    v_exp_f32 v107, v107
    v_exp_f32 v108, v108
    v_exp_f32 v109, v109
    v_mfma_f32_32x32x16_bf16 v[88:103], v[26:29], v[8:11], 0
    v_exp_f32 v110, v110
    v_exp_f32 v111, v111
    v_cvt_pk_bf16_f32 v48, v104, v105
    v_cvt_pk_bf16_f32 v49, v106, v107
    v_cvt_pk_bf16_f32 v50, v108, v109
    v_cvt_pk_bf16_f32 v51, v110, v111
    v_mfma_f32_32x32x8_bf16 v[88:103], v[30:31], v[16:17], v[88:103]
    v_exp_f32 v112, v112
    v_exp_f32 v113, v113
    v_exp_f32 v114, v114
    v_exp_f32 v115, v115
    v_mfma_f32_32x32x16_bf16 v[72:87], v[32:35], v[48:51], v[72:87]
    v_exp_f32 v116, v116
    v_exp_f32 v117, v117
    v_exp_f32 v118, v118
    v_exp_f32 v119, v119
    v_cvt_pk_bf16_f32 v52, v112, v113
    v_cvt_pk_bf16_f32 v53, v114, v115
    v_cvt_pk_bf16_f32 v54, v116, v117
    v_cvt_pk_bf16_f32 v55, v118, v119
    s_waitcnt lgkmcnt(0)
    v_exp_f32 v88, v88
    v_exp_f32 v89, v89
    v_mfma_f32_32x32x16_bf16 v[72:87], v[36:39], v[52:55], v[72:87]
    s_mov_b64 exec, s[20:21]
    ds_read_b128 v[32:35], v5 offset:2560
    ds_read_b128 v[36:39], v5 offset:3200
    s_mov_b64 exec, -1
    v_exp_f32 v90, v90
    v_exp_f32 v91, v91
    v_exp_f32 v92, v92
    v_exp_f32 v93, v93
    v_mfma_f32_32x32x16_bf16 v[104:119], v[26:29], v[12:15], 0
    v_exp_f32 v94, v94
    v_exp_f32 v95, v95
    v_cvt_pk_bf16_f32 v48, v88, v89
    v_cvt_pk_bf16_f32 v49, v90, v91
    v_cvt_pk_bf16_f32 v50, v92, v93
    v_cvt_pk_bf16_f32 v51, v94, v95
    v_mfma_f32_32x32x8_bf16 v[104:119], v[30:31], v[18:19], v[104:119]
    ds_read_b128 v[26:29], v3 offset:3840
    ds_read_b64 v[30:31], v4 offset:3840
    v_exp_f32 v96, v96
    v_exp_f32 v97, v97
    v_exp_f32 v98, v98
    v_exp_f32 v99, v99
    v_mfma_f32_32x32x16_bf16 v[56:71], v[40:43], v[48:51], v[56:71]
    v_exp_f32 v100, v100
    v_exp_f32 v101, v101
    v_exp_f32 v102, v102
    v_exp_f32 v103, v103
    v_cvt_pk_bf16_f32 v52, v96, v97
    v_cvt_pk_bf16_f32 v53, v98, v99
    v_cvt_pk_bf16_f32 v54, v100, v101
    v_cvt_pk_bf16_f32 v55, v102, v103
    s_waitcnt vmcnt(3)
    s_barrier
    v_exp_f32 v104, v104
    v_exp_f32 v105, v105
    v_mfma_f32_32x32x16_bf16 v[56:71], v[44:47], v[52:55], v[56:71]
    v_exp_f32 v106, v106
    v_exp_f32 v107, v107
    v_exp_f32 v108, v108
    v_exp_f32 v109, v109
    v_mfma_f32_32x32x16_bf16 v[88:103], v[20:23], v[8:11], 0
    v_exp_f32 v110, v110
    v_exp_f32 v111, v111
    v_cvt_pk_bf16_f32 v48, v104, v105
    v_cvt_pk_bf16_f32 v49, v106, v107
    v_cvt_pk_bf16_f32 v50, v108, v109
    v_cvt_pk_bf16_f32 v51, v110, v111
    v_mfma_f32_32x32x8_bf16 v[88:103], v[24:25], v[16:17], v[88:103]
    s_add_u32 m0, s69, 61440
    v_exp_f32 v112, v112
    v_exp_f32 v113, v113
    v_exp_f32 v114, v114
    v_exp_f32 v115, v115
    v_mfma_f32_32x32x16_bf16 v[72:87], v[40:43], v[48:51], v[72:87]
    buffer_load_dwordx4 v2, s[8:11], s64 offen offset:0 sc1 lds
    v_exp_f32 v116, v116
    v_exp_f32 v117, v117
    v_exp_f32 v118, v118
    v_exp_f32 v119, v119
    v_cvt_pk_bf16_f32 v52, v112, v113
    v_cvt_pk_bf16_f32 v53, v114, v115
    v_cvt_pk_bf16_f32 v54, v116, v117
    v_cvt_pk_bf16_f32 v55, v118, v119
    s_waitcnt lgkmcnt(0)
    v_exp_f32 v88, v88
    v_exp_f32 v89, v89
    v_mfma_f32_32x32x16_bf16 v[72:87], v[44:47], v[52:55], v[72:87]
    s_mov_b64 exec, s[20:21]
    ds_read_b128 v[40:43], v5 offset:3840
    ds_read_b128 v[44:47], v5 offset:4480
    s_mov_b64 exec, -1
    v_exp_f32 v90, v90
    v_exp_f32 v91, v91
    v_exp_f32 v92, v92
    v_exp_f32 v93, v93
    v_mfma_f32_32x32x16_bf16 v[104:119], v[20:23], v[12:15], 0
    v_exp_f32 v94, v94
    v_exp_f32 v95, v95
    v_cvt_pk_bf16_f32 v48, v88, v89
    v_cvt_pk_bf16_f32 v49, v90, v91
    v_cvt_pk_bf16_f32 v50, v92, v93
    v_cvt_pk_bf16_f32 v51, v94, v95
    v_mfma_f32_32x32x8_bf16 v[104:119], v[24:25], v[18:19], v[104:119]
    ds_read_b128 v[20:23], v3 offset:20480
    ds_read_b64 v[24:25], v4 offset:20480
    v_exp_f32 v96, v96
    v_exp_f32 v97, v97
    v_exp_f32 v98, v98
    v_exp_f32 v99, v99
    v_mfma_f32_32x32x16_bf16 v[56:71], v[32:35], v[48:51], v[56:71]
    buffer_load_dwordx4 v2, s[8:11], s64 offen offset:1024 sc1 lds
    v_exp_f32 v100, v100
    v_exp_f32 v101, v101
    v_exp_f32 v102, v102
    v_exp_f32 v103, v103
    v_cvt_pk_bf16_f32 v52, v96, v97
    v_cvt_pk_bf16_f32 v53, v98, v99
    v_cvt_pk_bf16_f32 v54, v100, v101
    v_cvt_pk_bf16_f32 v55, v102, v103
    v_exp_f32 v104, v104
    v_exp_f32 v105, v105
    v_mfma_f32_32x32x16_bf16 v[56:71], v[36:39], v[52:55], v[56:71]
    v_exp_f32 v106, v106
    v_exp_f32 v107, v107
    v_exp_f32 v108, v108
    v_exp_f32 v109, v109
    v_mfma_f32_32x32x16_bf16 v[88:103], v[26:29], v[8:11], 0
    v_exp_f32 v110, v110
    v_exp_f32 v111, v111
    v_cvt_pk_bf16_f32 v48, v104, v105
    v_cvt_pk_bf16_f32 v49, v106, v107
    v_cvt_pk_bf16_f32 v50, v108, v109
    v_cvt_pk_bf16_f32 v51, v110, v111
    v_mfma_f32_32x32x8_bf16 v[88:103], v[30:31], v[16:17], v[88:103]
    v_exp_f32 v112, v112
    v_exp_f32 v113, v113
    v_exp_f32 v114, v114
    v_exp_f32 v115, v115
    v_mfma_f32_32x32x16_bf16 v[72:87], v[32:35], v[48:51], v[72:87]
    s_mov_b64 exec, s[22:23]
    buffer_load_dwordx4 v2, s[8:11], s64 offen offset:2048 sc1 lds
    s_mov_b64 exec, -1
    v_exp_f32 v116, v116
    v_exp_f32 v117, v117
    v_exp_f32 v118, v118
    v_exp_f32 v119, v119
    v_cvt_pk_bf16_f32 v52, v112, v113
    v_cvt_pk_bf16_f32 v53, v114, v115
    v_cvt_pk_bf16_f32 v54, v116, v117
    v_cvt_pk_bf16_f32 v55, v118, v119
    s_waitcnt lgkmcnt(0)
    v_exp_f32 v88, v88
    v_exp_f32 v89, v89
    v_mfma_f32_32x32x16_bf16 v[72:87], v[36:39], v[52:55], v[72:87]
    s_mov_b64 exec, s[20:21]
    ds_read_b128 v[32:35], v5 offset:20480
    ds_read_b128 v[36:39], v5 offset:21120
    s_mov_b64 exec, -1
    v_exp_f32 v90, v90
    v_exp_f32 v91, v91
    v_exp_f32 v92, v92
    v_exp_f32 v93, v93
    v_mfma_f32_32x32x16_bf16 v[104:119], v[26:29], v[12:15], 0
    v_exp_f32 v94, v94
    v_exp_f32 v95, v95
    v_cvt_pk_bf16_f32 v48, v88, v89
    v_cvt_pk_bf16_f32 v49, v90, v91
    v_cvt_pk_bf16_f32 v50, v92, v93
    v_cvt_pk_bf16_f32 v51, v94, v95
    v_mfma_f32_32x32x8_bf16 v[104:119], v[30:31], v[18:19], v[104:119]
    ds_read_b128 v[26:29], v3 offset:21760
    ds_read_b64 v[30:31], v4 offset:21760
    v_exp_f32 v96, v96
    v_exp_f32 v97, v97
    v_exp_f32 v98, v98
    v_exp_f32 v99, v99
    v_mfma_f32_32x32x16_bf16 v[56:71], v[40:43], v[48:51], v[56:71]
    v_exp_f32 v100, v100
    v_exp_f32 v101, v101
    v_exp_f32 v102, v102
    v_exp_f32 v103, v103
    v_cvt_pk_bf16_f32 v52, v96, v97
    v_cvt_pk_bf16_f32 v53, v98, v99
    v_cvt_pk_bf16_f32 v54, v100, v101
    v_cvt_pk_bf16_f32 v55, v102, v103
    v_exp_f32 v104, v104
    v_exp_f32 v105, v105
    v_mfma_f32_32x32x16_bf16 v[56:71], v[44:47], v[52:55], v[56:71]
    v_exp_f32 v106, v106
    v_exp_f32 v107, v107
    v_exp_f32 v108, v108
    v_exp_f32 v109, v109
    v_mfma_f32_32x32x16_bf16 v[88:103], v[20:23], v[8:11], 0
    v_exp_f32 v110, v110
    v_exp_f32 v111, v111
    v_cvt_pk_bf16_f32 v48, v104, v105
    v_cvt_pk_bf16_f32 v49, v106, v107
    v_cvt_pk_bf16_f32 v50, v108, v109
    v_cvt_pk_bf16_f32 v51, v110, v111
    v_mfma_f32_32x32x8_bf16 v[88:103], v[24:25], v[16:17], v[88:103]
    v_exp_f32 v112, v112
    v_exp_f32 v113, v113
    v_exp_f32 v114, v114
    v_exp_f32 v115, v115
    v_mfma_f32_32x32x16_bf16 v[72:87], v[40:43], v[48:51], v[72:87]
    v_exp_f32 v116, v116
    v_exp_f32 v117, v117
    v_exp_f32 v118, v118
    v_exp_f32 v119, v119
    v_cvt_pk_bf16_f32 v52, v112, v113
    v_cvt_pk_bf16_f32 v53, v114, v115
    v_cvt_pk_bf16_f32 v54, v116, v117
    v_cvt_pk_bf16_f32 v55, v118, v119
    s_waitcnt lgkmcnt(0)
    v_exp_f32 v88, v88
    v_exp_f32 v89, v89
    v_mfma_f32_32x32x16_bf16 v[72:87], v[44:47], v[52:55], v[72:87]
    s_mov_b64 exec, s[20:21]
    ds_read_b128 v[40:43], v5 offset:21760
    ds_read_b128 v[44:47], v5 offset:22400
    s_mov_b64 exec, -1
    v_exp_f32 v90, v90
    v_exp_f32 v91, v91
    v_exp_f32 v92, v92
    v_exp_f32 v93, v93
    v_mfma_f32_32x32x16_bf16 v[104:119], v[20:23], v[12:15], 0
    v_exp_f32 v94, v94
    v_exp_f32 v95, v95
    v_cvt_pk_bf16_f32 v48, v88, v89
    v_cvt_pk_bf16_f32 v49, v90, v91
    v_cvt_pk_bf16_f32 v50, v92, v93
    v_cvt_pk_bf16_f32 v51, v94, v95
    v_mfma_f32_32x32x8_bf16 v[104:119], v[24:25], v[18:19], v[104:119]
    ds_read_b128 v[20:23], v3 offset:23040
    ds_read_b64 v[24:25], v4 offset:23040
    v_exp_f32 v96, v96
    v_exp_f32 v97, v97
    v_exp_f32 v98, v98
    v_exp_f32 v99, v99
    v_mfma_f32_32x32x16_bf16 v[56:71], v[32:35], v[48:51], v[56:71]
    v_exp_f32 v100, v100
    v_exp_f32 v101, v101
    v_exp_f32 v102, v102
    v_exp_f32 v103, v103
    v_cvt_pk_bf16_f32 v52, v96, v97
    v_cvt_pk_bf16_f32 v53, v98, v99
    v_cvt_pk_bf16_f32 v54, v100, v101
    v_cvt_pk_bf16_f32 v55, v102, v103
    v_exp_f32 v104, v104
    v_exp_f32 v105, v105
    v_mfma_f32_32x32x16_bf16 v[56:71], v[36:39], v[52:55], v[56:71]
    v_exp_f32 v106, v106
    v_exp_f32 v107, v107
    v_exp_f32 v108, v108
    v_exp_f32 v109, v109
    v_mfma_f32_32x32x16_bf16 v[88:103], v[26:29], v[8:11], 0
    v_exp_f32 v110, v110
    v_exp_f32 v111, v111
    v_cvt_pk_bf16_f32 v48, v104, v105
    v_cvt_pk_bf16_f32 v49, v106, v107
    v_cvt_pk_bf16_f32 v50, v108, v109
    v_cvt_pk_bf16_f32 v51, v110, v111
    v_mfma_f32_32x32x8_bf16 v[88:103], v[30:31], v[16:17], v[88:103]
    v_exp_f32 v112, v112
    v_exp_f32 v113, v113
    v_exp_f32 v114, v114
    v_exp_f32 v115, v115
    v_mfma_f32_32x32x16_bf16 v[72:87], v[32:35], v[48:51], v[72:87]
    v_exp_f32 v116, v116
    v_exp_f32 v117, v117
    v_exp_f32 v118, v118
    v_exp_f32 v119, v119
    v_cvt_pk_bf16_f32 v52, v112, v113
    v_cvt_pk_bf16_f32 v53, v114, v115
    v_cvt_pk_bf16_f32 v54, v116, v117
    v_cvt_pk_bf16_f32 v55, v118, v119
    s_waitcnt lgkmcnt(0)
    v_exp_f32 v88, v88
    v_exp_f32 v89, v89
    v_mfma_f32_32x32x16_bf16 v[72:87], v[36:39], v[52:55], v[72:87]
    s_mov_b64 exec, s[20:21]
    ds_read_b128 v[32:35], v5 offset:23040
    ds_read_b128 v[36:39], v5 offset:23680
    s_mov_b64 exec, -1
    v_exp_f32 v90, v90
    v_exp_f32 v91, v91
    v_exp_f32 v92, v92
    v_exp_f32 v93, v93
    v_mfma_f32_32x32x16_bf16 v[104:119], v[26:29], v[12:15], 0
    v_exp_f32 v94, v94
    v_exp_f32 v95, v95
    v_cvt_pk_bf16_f32 v48, v88, v89
    v_cvt_pk_bf16_f32 v49, v90, v91
    v_cvt_pk_bf16_f32 v50, v92, v93
    v_cvt_pk_bf16_f32 v51, v94, v95
    v_mfma_f32_32x32x8_bf16 v[104:119], v[30:31], v[18:19], v[104:119]
    ds_read_b128 v[26:29], v3 offset:24320
    ds_read_b64 v[30:31], v4 offset:24320
    v_exp_f32 v96, v96
    v_exp_f32 v97, v97
    v_exp_f32 v98, v98
    v_exp_f32 v99, v99
    v_mfma_f32_32x32x16_bf16 v[56:71], v[40:43], v[48:51], v[56:71]
    v_exp_f32 v100, v100
    v_exp_f32 v101, v101
    v_exp_f32 v102, v102
    v_exp_f32 v103, v103
    v_cvt_pk_bf16_f32 v52, v96, v97
    v_cvt_pk_bf16_f32 v53, v98, v99
    v_cvt_pk_bf16_f32 v54, v100, v101
    v_cvt_pk_bf16_f32 v55, v102, v103
    s_waitcnt vmcnt(3)
    s_barrier
    v_exp_f32 v104, v104
    v_exp_f32 v105, v105
    v_mfma_f32_32x32x16_bf16 v[56:71], v[44:47], v[52:55], v[56:71]
    v_exp_f32 v106, v106
    v_exp_f32 v107, v107
    v_exp_f32 v108, v108
    v_exp_f32 v109, v109
    v_mfma_f32_32x32x16_bf16 v[88:103], v[20:23], v[8:11], 0
    v_exp_f32 v110, v110
    v_exp_f32 v111, v111
    v_cvt_pk_bf16_f32 v48, v104, v105
    v_cvt_pk_bf16_f32 v49, v106, v107
    v_cvt_pk_bf16_f32 v50, v108, v109
    v_cvt_pk_bf16_f32 v51, v110, v111
    v_mfma_f32_32x32x8_bf16 v[88:103], v[24:25], v[16:17], v[88:103]
    s_add_u32 m0, s69, 0
    v_exp_f32 v112, v112
    v_exp_f32 v113, v113
    v_exp_f32 v114, v114
    v_exp_f32 v115, v115
    v_mfma_f32_32x32x16_bf16 v[72:87], v[40:43], v[48:51], v[72:87]
    buffer_load_dwordx4 v2, s[8:11], s65 offen offset:0 sc1 lds
    v_exp_f32 v116, v116
    v_exp_f32 v117, v117
    v_exp_f32 v118, v118
    v_exp_f32 v119, v119
    v_cvt_pk_bf16_f32 v52, v112, v113
    v_cvt_pk_bf16_f32 v53, v114, v115
    v_cvt_pk_bf16_f32 v54, v116, v117
    v_cvt_pk_bf16_f32 v55, v118, v119
    s_waitcnt lgkmcnt(0)
    v_exp_f32 v88, v88
    v_exp_f32 v89, v89
    v_mfma_f32_32x32x16_bf16 v[72:87], v[44:47], v[52:55], v[72:87]
    s_mov_b64 exec, s[20:21]
    ds_read_b128 v[40:43], v5 offset:24320
    ds_read_b128 v[44:47], v5 offset:24960
    s_mov_b64 exec, -1
    v_exp_f32 v90, v90
    v_exp_f32 v91, v91
    v_exp_f32 v92, v92
    v_exp_f32 v93, v93
    v_mfma_f32_32x32x16_bf16 v[104:119], v[20:23], v[12:15], 0
    v_exp_f32 v94, v94
    v_exp_f32 v95, v95
    v_cvt_pk_bf16_f32 v48, v88, v89
    v_cvt_pk_bf16_f32 v49, v90, v91
    v_cvt_pk_bf16_f32 v50, v92, v93
    v_cvt_pk_bf16_f32 v51, v94, v95
    v_mfma_f32_32x32x8_bf16 v[104:119], v[24:25], v[18:19], v[104:119]
    ds_read_b128 v[20:23], v3 offset:40960
    ds_read_b64 v[24:25], v4 offset:40960
    v_exp_f32 v96, v96
    v_exp_f32 v97, v97
    v_exp_f32 v98, v98
    v_exp_f32 v99, v99
    v_mfma_f32_32x32x16_bf16 v[56:71], v[32:35], v[48:51], v[56:71]
    buffer_load_dwordx4 v2, s[8:11], s65 offen offset:1024 sc1 lds
    v_exp_f32 v100, v100
    v_exp_f32 v101, v101
    v_exp_f32 v102, v102
    v_exp_f32 v103, v103
    v_cvt_pk_bf16_f32 v52, v96, v97
    v_cvt_pk_bf16_f32 v53, v98, v99
    v_cvt_pk_bf16_f32 v54, v100, v101
    v_cvt_pk_bf16_f32 v55, v102, v103
    v_exp_f32 v104, v104
    v_exp_f32 v105, v105
    v_mfma_f32_32x32x16_bf16 v[56:71], v[36:39], v[52:55], v[56:71]
    v_exp_f32 v106, v106
    v_exp_f32 v107, v107
    v_exp_f32 v108, v108
    v_exp_f32 v109, v109
    v_mfma_f32_32x32x16_bf16 v[88:103], v[26:29], v[8:11], 0
    v_exp_f32 v110, v110
    v_exp_f32 v111, v111
    v_cvt_pk_bf16_f32 v48, v104, v105
    v_cvt_pk_bf16_f32 v49, v106, v107
    v_cvt_pk_bf16_f32 v50, v108, v109
    v_cvt_pk_bf16_f32 v51, v110, v111
    v_mfma_f32_32x32x8_bf16 v[88:103], v[30:31], v[16:17], v[88:103]
    v_exp_f32 v112, v112
    v_exp_f32 v113, v113
    v_exp_f32 v114, v114
    v_exp_f32 v115, v115
    v_mfma_f32_32x32x16_bf16 v[72:87], v[32:35], v[48:51], v[72:87]
    s_mov_b64 exec, s[22:23]
    buffer_load_dwordx4 v2, s[8:11], s65 offen offset:2048 sc1 lds
    s_mov_b64 exec, -1
    v_exp_f32 v116, v116
    v_exp_f32 v117, v117
    v_exp_f32 v118, v118
    v_exp_f32 v119, v119
    v_cvt_pk_bf16_f32 v52, v112, v113
    v_cvt_pk_bf16_f32 v53, v114, v115
    v_cvt_pk_bf16_f32 v54, v116, v117
    v_cvt_pk_bf16_f32 v55, v118, v119
    s_waitcnt lgkmcnt(0)
    v_exp_f32 v88, v88
    v_exp_f32 v89, v89
    v_mfma_f32_32x32x16_bf16 v[72:87], v[36:39], v[52:55], v[72:87]
    s_mov_b64 exec, s[20:21]
    ds_read_b128 v[32:35], v5 offset:40960
    ds_read_b128 v[36:39], v5 offset:41600
    s_mov_b64 exec, -1
    v_exp_f32 v90, v90
    v_exp_f32 v91, v91
    v_exp_f32 v92, v92
    v_exp_f32 v93, v93
    v_mfma_f32_32x32x16_bf16 v[104:119], v[26:29], v[12:15], 0
    v_exp_f32 v94, v94
    v_exp_f32 v95, v95
    v_cvt_pk_bf16_f32 v48, v88, v89
    v_cvt_pk_bf16_f32 v49, v90, v91
    v_cvt_pk_bf16_f32 v50, v92, v93
    v_cvt_pk_bf16_f32 v51, v94, v95
    v_mfma_f32_32x32x8_bf16 v[104:119], v[30:31], v[18:19], v[104:119]
    ds_read_b128 v[26:29], v3 offset:42240
    ds_read_b64 v[30:31], v4 offset:42240
    v_exp_f32 v96, v96
    v_exp_f32 v97, v97
    v_exp_f32 v98, v98
    v_exp_f32 v99, v99
    v_mfma_f32_32x32x16_bf16 v[56:71], v[40:43], v[48:51], v[56:71]
    v_exp_f32 v100, v100
    v_exp_f32 v101, v101
    v_exp_f32 v102, v102
    v_exp_f32 v103, v103
    v_cvt_pk_bf16_f32 v52, v96, v97
    v_cvt_pk_bf16_f32 v53, v98, v99
    v_cvt_pk_bf16_f32 v54, v100, v101
    v_cvt_pk_bf16_f32 v55, v102, v103
    v_exp_f32 v104, v104
    v_exp_f32 v105, v105
    v_mfma_f32_32x32x16_bf16 v[56:71], v[44:47], v[52:55], v[56:71]
    v_exp_f32 v106, v106
    v_exp_f32 v107, v107
    v_exp_f32 v108, v108
    v_exp_f32 v109, v109
    v_mfma_f32_32x32x16_bf16 v[88:103], v[20:23], v[8:11], 0
    v_exp_f32 v110, v110
    v_exp_f32 v111, v111
    v_cvt_pk_bf16_f32 v48, v104, v105
    v_cvt_pk_bf16_f32 v49, v106, v107
    v_cvt_pk_bf16_f32 v50, v108, v109
    v_cvt_pk_bf16_f32 v51, v110, v111
    v_mfma_f32_32x32x8_bf16 v[88:103], v[24:25], v[16:17], v[88:103]
    v_exp_f32 v112, v112
    v_exp_f32 v113, v113
    v_exp_f32 v114, v114
    v_exp_f32 v115, v115
    v_mfma_f32_32x32x16_bf16 v[72:87], v[40:43], v[48:51], v[72:87]
    v_exp_f32 v116, v116
    v_exp_f32 v117, v117
    v_exp_f32 v118, v118
    v_exp_f32 v119, v119
    v_cvt_pk_bf16_f32 v52, v112, v113
    v_cvt_pk_bf16_f32 v53, v114, v115
    v_cvt_pk_bf16_f32 v54, v116, v117
    v_cvt_pk_bf16_f32 v55, v118, v119
    s_waitcnt lgkmcnt(0)
    v_exp_f32 v88, v88
    v_exp_f32 v89, v89
    v_mfma_f32_32x32x16_bf16 v[72:87], v[44:47], v[52:55], v[72:87]
    s_mov_b64 exec, s[20:21]
    ds_read_b128 v[40:43], v5 offset:42240
    ds_read_b128 v[44:47], v5 offset:42880
    s_mov_b64 exec, -1
    v_exp_f32 v90, v90
    v_exp_f32 v91, v91
    v_exp_f32 v92, v92
    v_exp_f32 v93, v93
    v_mfma_f32_32x32x16_bf16 v[104:119], v[20:23], v[12:15], 0
    v_exp_f32 v94, v94
    v_exp_f32 v95, v95
    v_cvt_pk_bf16_f32 v48, v88, v89
    v_cvt_pk_bf16_f32 v49, v90, v91
    v_cvt_pk_bf16_f32 v50, v92, v93
    v_cvt_pk_bf16_f32 v51, v94, v95
    v_mfma_f32_32x32x8_bf16 v[104:119], v[24:25], v[18:19], v[104:119]
    ds_read_b128 v[20:23], v3 offset:43520
    ds_read_b64 v[24:25], v4 offset:43520
    v_exp_f32 v96, v96
    v_exp_f32 v97, v97
    v_exp_f32 v98, v98
    v_exp_f32 v99, v99
    v_mfma_f32_32x32x16_bf16 v[56:71], v[32:35], v[48:51], v[56:71]
    v_exp_f32 v100, v100
    v_exp_f32 v101, v101
    v_exp_f32 v102, v102
    v_exp_f32 v103, v103
    v_cvt_pk_bf16_f32 v52, v96, v97
    v_cvt_pk_bf16_f32 v53, v98, v99
    v_cvt_pk_bf16_f32 v54, v100, v101
    v_cvt_pk_bf16_f32 v55, v102, v103
    v_exp_f32 v104, v104
    v_exp_f32 v105, v105
    v_mfma_f32_32x32x16_bf16 v[56:71], v[36:39], v[52:55], v[56:71]
    v_exp_f32 v106, v106
    v_exp_f32 v107, v107
    v_exp_f32 v108, v108
    v_exp_f32 v109, v109
    v_mfma_f32_32x32x16_bf16 v[88:103], v[26:29], v[8:11], 0
    v_exp_f32 v110, v110
    v_exp_f32 v111, v111
    v_cvt_pk_bf16_f32 v48, v104, v105
    v_cvt_pk_bf16_f32 v49, v106, v107
    v_cvt_pk_bf16_f32 v50, v108, v109
    v_cvt_pk_bf16_f32 v51, v110, v111
    v_mfma_f32_32x32x8_bf16 v[88:103], v[30:31], v[16:17], v[88:103]
    v_exp_f32 v112, v112
    v_exp_f32 v113, v113
    v_exp_f32 v114, v114
    v_exp_f32 v115, v115
    v_mfma_f32_32x32x16_bf16 v[72:87], v[32:35], v[48:51], v[72:87]
    v_exp_f32 v116, v116
    v_exp_f32 v117, v117
    v_exp_f32 v118, v118
    v_exp_f32 v119, v119
    v_cvt_pk_bf16_f32 v52, v112, v113
    v_cvt_pk_bf16_f32 v53, v114, v115
    v_cvt_pk_bf16_f32 v54, v116, v117
    v_cvt_pk_bf16_f32 v55, v118, v119
    s_waitcnt lgkmcnt(0)
    v_exp_f32 v88, v88
    v_exp_f32 v89, v89
    v_mfma_f32_32x32x16_bf16 v[72:87], v[36:39], v[52:55], v[72:87]
    s_mov_b64 exec, s[20:21]
    ds_read_b128 v[32:35], v5 offset:43520
    ds_read_b128 v[36:39], v5 offset:44160
    s_mov_b64 exec, -1
    v_exp_f32 v90, v90
    v_exp_f32 v91, v91
    v_exp_f32 v92, v92
    v_exp_f32 v93, v93
    v_mfma_f32_32x32x16_bf16 v[104:119], v[26:29], v[12:15], 0
    v_exp_f32 v94, v94
    v_exp_f32 v95, v95
    v_cvt_pk_bf16_f32 v48, v88, v89
    v_cvt_pk_bf16_f32 v49, v90, v91
    v_cvt_pk_bf16_f32 v50, v92, v93
    v_cvt_pk_bf16_f32 v51, v94, v95
    v_mfma_f32_32x32x8_bf16 v[104:119], v[30:31], v[18:19], v[104:119]
    ds_read_b128 v[26:29], v3 offset:44800
    ds_read_b64 v[30:31], v4 offset:44800
    v_exp_f32 v96, v96
    v_exp_f32 v97, v97
    v_exp_f32 v98, v98
    v_exp_f32 v99, v99
    v_mfma_f32_32x32x16_bf16 v[56:71], v[40:43], v[48:51], v[56:71]
    v_exp_f32 v100, v100
    v_exp_f32 v101, v101
    v_exp_f32 v102, v102
    v_exp_f32 v103, v103
    v_cvt_pk_bf16_f32 v52, v96, v97
    v_cvt_pk_bf16_f32 v53, v98, v99
    v_cvt_pk_bf16_f32 v54, v100, v101
    v_cvt_pk_bf16_f32 v55, v102, v103
    s_waitcnt vmcnt(3)
    s_barrier
    v_exp_f32 v104, v104
    v_exp_f32 v105, v105
    v_mfma_f32_32x32x16_bf16 v[56:71], v[44:47], v[52:55], v[56:71]
    v_exp_f32 v106, v106
    v_exp_f32 v107, v107
    v_exp_f32 v108, v108
    v_exp_f32 v109, v109
    v_mfma_f32_32x32x16_bf16 v[88:103], v[20:23], v[8:11], 0
    v_exp_f32 v110, v110
    v_exp_f32 v111, v111
    v_cvt_pk_bf16_f32 v48, v104, v105
    v_cvt_pk_bf16_f32 v49, v106, v107
    v_cvt_pk_bf16_f32 v50, v108, v109
    v_cvt_pk_bf16_f32 v51, v110, v111
    v_mfma_f32_32x32x8_bf16 v[88:103], v[24:25], v[16:17], v[88:103]
    s_add_u32 m0, s69, 20480
    v_exp_f32 v112, v112
    v_exp_f32 v113, v113
    v_exp_f32 v114, v114
    v_exp_f32 v115, v115
    v_mfma_f32_32x32x16_bf16 v[72:87], v[40:43], v[48:51], v[72:87]
    buffer_load_dwordx4 v2, s[8:11], s66 offen offset:0 sc1 lds
    v_exp_f32 v116, v116
    v_exp_f32 v117, v117
    v_exp_f32 v118, v118
    v_exp_f32 v119, v119
    v_cvt_pk_bf16_f32 v52, v112, v113
    v_cvt_pk_bf16_f32 v53, v114, v115
    v_cvt_pk_bf16_f32 v54, v116, v117
    v_cvt_pk_bf16_f32 v55, v118, v119
    s_waitcnt lgkmcnt(0)
    v_exp_f32 v88, v88
    v_exp_f32 v89, v89
    v_mfma_f32_32x32x16_bf16 v[72:87], v[44:47], v[52:55], v[72:87]
    s_mov_b64 exec, s[20:21]
    ds_read_b128 v[40:43], v5 offset:44800
    ds_read_b128 v[44:47], v5 offset:45440
    s_mov_b64 exec, -1
    v_exp_f32 v90, v90
    v_exp_f32 v91, v91
    v_exp_f32 v92, v92
    v_exp_f32 v93, v93
    v_mfma_f32_32x32x16_bf16 v[104:119], v[20:23], v[12:15], 0
    v_exp_f32 v94, v94
    v_exp_f32 v95, v95
    v_cvt_pk_bf16_f32 v48, v88, v89
    v_cvt_pk_bf16_f32 v49, v90, v91
    v_cvt_pk_bf16_f32 v50, v92, v93
    v_cvt_pk_bf16_f32 v51, v94, v95
    v_mfma_f32_32x32x8_bf16 v[104:119], v[24:25], v[18:19], v[104:119]
    ds_read_b128 v[20:23], v3 offset:61440
    ds_read_b64 v[24:25], v4 offset:61440
    v_exp_f32 v96, v96
    v_exp_f32 v97, v97
    v_exp_f32 v98, v98
    v_exp_f32 v99, v99
    v_mfma_f32_32x32x16_bf16 v[56:71], v[32:35], v[48:51], v[56:71]
    buffer_load_dwordx4 v2, s[8:11], s66 offen offset:1024 sc1 lds
    v_exp_f32 v100, v100
    v_exp_f32 v101, v101
    v_exp_f32 v102, v102
    v_exp_f32 v103, v103
    v_cvt_pk_bf16_f32 v52, v96, v97
    v_cvt_pk_bf16_f32 v53, v98, v99
    v_cvt_pk_bf16_f32 v54, v100, v101
    v_cvt_pk_bf16_f32 v55, v102, v103
    v_exp_f32 v104, v104
    v_exp_f32 v105, v105
    v_mfma_f32_32x32x16_bf16 v[56:71], v[36:39], v[52:55], v[56:71]
    v_exp_f32 v106, v106
    v_exp_f32 v107, v107
    v_exp_f32 v108, v108
    v_exp_f32 v109, v109
    v_mfma_f32_32x32x16_bf16 v[88:103], v[26:29], v[8:11], 0
    v_exp_f32 v110, v110
    v_exp_f32 v111, v111
    v_cvt_pk_bf16_f32 v48, v104, v105
    v_cvt_pk_bf16_f32 v49, v106, v107
    v_cvt_pk_bf16_f32 v50, v108, v109
    v_cvt_pk_bf16_f32 v51, v110, v111
    v_mfma_f32_32x32x8_bf16 v[88:103], v[30:31], v[16:17], v[88:103]
    v_exp_f32 v112, v112
    v_exp_f32 v113, v113
    v_exp_f32 v114, v114
    v_exp_f32 v115, v115
    v_mfma_f32_32x32x16_bf16 v[72:87], v[32:35], v[48:51], v[72:87]
    s_mov_b64 exec, s[22:23]
    buffer_load_dwordx4 v2, s[8:11], s66 offen offset:2048 sc1 lds
    s_mov_b64 exec, -1
    v_exp_f32 v116, v116
    v_exp_f32 v117, v117
    v_exp_f32 v118, v118
    v_exp_f32 v119, v119
    v_cvt_pk_bf16_f32 v52, v112, v113
    v_cvt_pk_bf16_f32 v53, v114, v115
    v_cvt_pk_bf16_f32 v54, v116, v117
    v_cvt_pk_bf16_f32 v55, v118, v119
    s_waitcnt lgkmcnt(0)
    v_exp_f32 v88, v88
    v_exp_f32 v89, v89
    v_mfma_f32_32x32x16_bf16 v[72:87], v[36:39], v[52:55], v[72:87]
    s_mov_b64 exec, s[20:21]
    ds_read_b128 v[32:35], v1 offset:0
    ds_read_b128 v[36:39], v1 offset:640
    s_mov_b64 exec, -1
    v_exp_f32 v90, v90
    v_exp_f32 v91, v91
    v_exp_f32 v92, v92
    v_exp_f32 v93, v93
    v_mfma_f32_32x32x16_bf16 v[104:119], v[26:29], v[12:15], 0
    v_exp_f32 v94, v94
    v_exp_f32 v95, v95
    v_cvt_pk_bf16_f32 v48, v88, v89
    v_cvt_pk_bf16_f32 v49, v90, v91
    v_cvt_pk_bf16_f32 v50, v92, v93
    v_cvt_pk_bf16_f32 v51, v94, v95
    v_mfma_f32_32x32x8_bf16 v[104:119], v[30:31], v[18:19], v[104:119]
    ds_read_b128 v[26:29], v3 offset:62720
    ds_read_b64 v[30:31], v4 offset:62720
    v_exp_f32 v96, v96
    v_exp_f32 v97, v97
    v_exp_f32 v98, v98
    v_exp_f32 v99, v99
    v_mfma_f32_32x32x16_bf16 v[56:71], v[40:43], v[48:51], v[56:71]
    v_exp_f32 v100, v100
    v_exp_f32 v101, v101
    v_exp_f32 v102, v102
    v_exp_f32 v103, v103
    v_cvt_pk_bf16_f32 v52, v96, v97
    v_cvt_pk_bf16_f32 v53, v98, v99
    v_cvt_pk_bf16_f32 v54, v100, v101
    v_cvt_pk_bf16_f32 v55, v102, v103
    v_exp_f32 v104, v104
    v_exp_f32 v105, v105
    v_mfma_f32_32x32x16_bf16 v[56:71], v[44:47], v[52:55], v[56:71]
    v_exp_f32 v106, v106
    v_exp_f32 v107, v107
    v_exp_f32 v108, v108
    v_exp_f32 v109, v109
    v_mfma_f32_32x32x16_bf16 v[88:103], v[20:23], v[8:11], 0
    v_exp_f32 v110, v110
    v_exp_f32 v111, v111
    v_cvt_pk_bf16_f32 v48, v104, v105
    v_cvt_pk_bf16_f32 v49, v106, v107
    v_cvt_pk_bf16_f32 v50, v108, v109
    v_cvt_pk_bf16_f32 v51, v110, v111
    v_mfma_f32_32x32x8_bf16 v[88:103], v[24:25], v[16:17], v[88:103]
    v_exp_f32 v112, v112
    v_exp_f32 v113, v113
    v_exp_f32 v114, v114
    v_exp_f32 v115, v115
    v_mfma_f32_32x32x16_bf16 v[72:87], v[40:43], v[48:51], v[72:87]
    v_exp_f32 v116, v116
    v_exp_f32 v117, v117
    v_exp_f32 v118, v118
    v_exp_f32 v119, v119
    v_cvt_pk_bf16_f32 v52, v112, v113
    v_cvt_pk_bf16_f32 v53, v114, v115
    v_cvt_pk_bf16_f32 v54, v116, v117
    v_cvt_pk_bf16_f32 v55, v118, v119
    s_waitcnt lgkmcnt(0)
    v_exp_f32 v88, v88
    v_exp_f32 v89, v89
    v_mfma_f32_32x32x16_bf16 v[72:87], v[44:47], v[52:55], v[72:87]
    s_mov_b64 exec, s[20:21]
    ds_read_b128 v[40:43], v1 offset:1280
    ds_read_b128 v[44:47], v1 offset:1920
    s_mov_b64 exec, -1
    v_exp_f32 v90, v90
    v_exp_f32 v91, v91
    v_exp_f32 v92, v92
    v_exp_f32 v93, v93
    v_mfma_f32_32x32x16_bf16 v[104:119], v[20:23], v[12:15], 0
    v_exp_f32 v94, v94
    v_exp_f32 v95, v95
    v_cvt_pk_bf16_f32 v48, v88, v89
    v_cvt_pk_bf16_f32 v49, v90, v91
    v_cvt_pk_bf16_f32 v50, v92, v93
    v_cvt_pk_bf16_f32 v51, v94, v95
    v_mfma_f32_32x32x8_bf16 v[104:119], v[24:25], v[18:19], v[104:119]
    ds_read_b128 v[20:23], v3 offset:64000
    ds_read_b64 v[24:25], v4 offset:64000
    v_exp_f32 v96, v96
    v_exp_f32 v97, v97
    v_exp_f32 v98, v98
    v_exp_f32 v99, v99
    v_mfma_f32_32x32x16_bf16 v[56:71], v[32:35], v[48:51], v[56:71]
    v_exp_f32 v100, v100
    v_exp_f32 v101, v101
    v_exp_f32 v102, v102
    v_exp_f32 v103, v103
    v_cvt_pk_bf16_f32 v52, v96, v97
    v_cvt_pk_bf16_f32 v53, v98, v99
    v_cvt_pk_bf16_f32 v54, v100, v101
    v_cvt_pk_bf16_f32 v55, v102, v103
    v_exp_f32 v104, v104
    v_exp_f32 v105, v105
    v_mfma_f32_32x32x16_bf16 v[56:71], v[36:39], v[52:55], v[56:71]
    v_exp_f32 v106, v106
    v_exp_f32 v107, v107
    v_exp_f32 v108, v108
    v_exp_f32 v109, v109
    v_mfma_f32_32x32x16_bf16 v[88:103], v[26:29], v[8:11], 0
    v_exp_f32 v110, v110
    v_exp_f32 v111, v111
    v_cvt_pk_bf16_f32 v48, v104, v105
    v_cvt_pk_bf16_f32 v49, v106, v107
    v_cvt_pk_bf16_f32 v50, v108, v109
    v_cvt_pk_bf16_f32 v51, v110, v111
    v_mfma_f32_32x32x8_bf16 v[88:103], v[30:31], v[16:17], v[88:103]
    v_exp_f32 v112, v112
    v_exp_f32 v113, v113
    v_exp_f32 v114, v114
    v_exp_f32 v115, v115
    v_mfma_f32_32x32x16_bf16 v[72:87], v[32:35], v[48:51], v[72:87]
    v_exp_f32 v116, v116
    v_exp_f32 v117, v117
    v_exp_f32 v118, v118
    v_exp_f32 v119, v119
    v_cvt_pk_bf16_f32 v52, v112, v113
    v_cvt_pk_bf16_f32 v53, v114, v115
    v_cvt_pk_bf16_f32 v54, v116, v117
    v_cvt_pk_bf16_f32 v55, v118, v119
    s_waitcnt lgkmcnt(0)
    v_exp_f32 v88, v88
    v_exp_f32 v89, v89
    v_mfma_f32_32x32x16_bf16 v[72:87], v[36:39], v[52:55], v[72:87]
    s_mov_b64 exec, s[20:21]
    ds_read_b128 v[32:35], v1 offset:2560
    ds_read_b128 v[36:39], v1 offset:3200
    s_mov_b64 exec, -1
    v_exp_f32 v90, v90
    v_exp_f32 v91, v91
    v_exp_f32 v92, v92
    v_exp_f32 v93, v93
    v_mfma_f32_32x32x16_bf16 v[104:119], v[26:29], v[12:15], 0
    v_exp_f32 v94, v94
    v_exp_f32 v95, v95
    v_cvt_pk_bf16_f32 v48, v88, v89
    v_cvt_pk_bf16_f32 v49, v90, v91
    v_cvt_pk_bf16_f32 v50, v92, v93
    v_cvt_pk_bf16_f32 v51, v94, v95
    v_mfma_f32_32x32x8_bf16 v[104:119], v[30:31], v[18:19], v[104:119]
    ds_read_b128 v[26:29], v3 offset:65280
    ds_read_b64 v[30:31], v4 offset:65280
    v_exp_f32 v96, v96
    v_exp_f32 v97, v97
    v_exp_f32 v98, v98
    v_exp_f32 v99, v99
    v_mfma_f32_32x32x16_bf16 v[56:71], v[40:43], v[48:51], v[56:71]
    v_exp_f32 v100, v100
    v_exp_f32 v101, v101
    v_exp_f32 v102, v102
    v_exp_f32 v103, v103
    v_cvt_pk_bf16_f32 v52, v96, v97
    v_cvt_pk_bf16_f32 v53, v98, v99
    v_cvt_pk_bf16_f32 v54, v100, v101
    v_cvt_pk_bf16_f32 v55, v102, v103
    s_waitcnt vmcnt(3)
    s_barrier
    v_exp_f32 v104, v104
    v_exp_f32 v105, v105
    v_mfma_f32_32x32x16_bf16 v[56:71], v[44:47], v[52:55], v[56:71]
    v_exp_f32 v106, v106
    v_exp_f32 v107, v107
    v_exp_f32 v108, v108
    v_exp_f32 v109, v109
    v_mfma_f32_32x32x16_bf16 v[88:103], v[20:23], v[8:11], 0
    v_exp_f32 v110, v110
    v_exp_f32 v111, v111
    v_cvt_pk_bf16_f32 v48, v104, v105
    v_cvt_pk_bf16_f32 v49, v106, v107
    v_cvt_pk_bf16_f32 v50, v108, v109
    v_cvt_pk_bf16_f32 v51, v110, v111
    v_mfma_f32_32x32x8_bf16 v[88:103], v[24:25], v[16:17], v[88:103]
    s_add_u32 m0, s69, 40960
    v_exp_f32 v112, v112
    v_exp_f32 v113, v113
    v_exp_f32 v114, v114
    v_exp_f32 v115, v115
    v_mfma_f32_32x32x16_bf16 v[72:87], v[40:43], v[48:51], v[72:87]
    buffer_load_dwordx4 v2, s[8:11], s67 offen offset:0 sc1 lds
    v_exp_f32 v116, v116
    v_exp_f32 v117, v117
    v_exp_f32 v118, v118
    v_exp_f32 v119, v119
    v_cvt_pk_bf16_f32 v52, v112, v113
    v_cvt_pk_bf16_f32 v53, v114, v115
    v_cvt_pk_bf16_f32 v54, v116, v117
    v_cvt_pk_bf16_f32 v55, v118, v119
    s_waitcnt lgkmcnt(0)
    v_exp_f32 v88, v88
    v_exp_f32 v89, v89
    v_mfma_f32_32x32x16_bf16 v[72:87], v[44:47], v[52:55], v[72:87]
    s_mov_b64 exec, s[20:21]
    ds_read_b128 v[40:43], v1 offset:3840
    ds_read_b128 v[44:47], v1 offset:4480
    s_mov_b64 exec, -1
    v_exp_f32 v90, v90
    v_exp_f32 v91, v91
    v_exp_f32 v92, v92
    v_exp_f32 v93, v93
    v_mfma_f32_32x32x16_bf16 v[104:119], v[20:23], v[12:15], 0
    v_exp_f32 v94, v94
    v_exp_f32 v95, v95
    v_cvt_pk_bf16_f32 v48, v88, v89
    v_cvt_pk_bf16_f32 v49, v90, v91
    v_cvt_pk_bf16_f32 v50, v92, v93
    v_cvt_pk_bf16_f32 v51, v94, v95
    v_mfma_f32_32x32x8_bf16 v[104:119], v[24:25], v[18:19], v[104:119]
    ds_read_b128 v[20:23], v3 offset:0
    ds_read_b64 v[24:25], v4 offset:0
    v_exp_f32 v96, v96
    v_exp_f32 v97, v97
    v_exp_f32 v98, v98
    v_exp_f32 v99, v99
    v_mfma_f32_32x32x16_bf16 v[56:71], v[32:35], v[48:51], v[56:71]
    buffer_load_dwordx4 v2, s[8:11], s67 offen offset:1024 sc1 lds
    v_exp_f32 v100, v100
    v_exp_f32 v101, v101
    v_exp_f32 v102, v102
    v_exp_f32 v103, v103
    v_cvt_pk_bf16_f32 v52, v96, v97
    v_cvt_pk_bf16_f32 v53, v98, v99
    v_cvt_pk_bf16_f32 v54, v100, v101
    v_cvt_pk_bf16_f32 v55, v102, v103
    v_exp_f32 v104, v104
    v_exp_f32 v105, v105
    v_mfma_f32_32x32x16_bf16 v[56:71], v[36:39], v[52:55], v[56:71]
    v_exp_f32 v106, v106
    v_exp_f32 v107, v107
    v_exp_f32 v108, v108
    v_exp_f32 v109, v109
    v_mfma_f32_32x32x16_bf16 v[88:103], v[26:29], v[8:11], 0
    v_exp_f32 v110, v110
    v_exp_f32 v111, v111
    v_cvt_pk_bf16_f32 v48, v104, v105
    v_cvt_pk_bf16_f32 v49, v106, v107
    v_cvt_pk_bf16_f32 v50, v108, v109
    v_cvt_pk_bf16_f32 v51, v110, v111
    v_mfma_f32_32x32x8_bf16 v[88:103], v[30:31], v[16:17], v[88:103]
    v_exp_f32 v112, v112
    v_exp_f32 v113, v113
    v_exp_f32 v114, v114
    v_exp_f32 v115, v115
    v_mfma_f32_32x32x16_bf16 v[72:87], v[32:35], v[48:51], v[72:87]
    s_mov_b64 exec, s[22:23]
    buffer_load_dwordx4 v2, s[8:11], s67 offen offset:2048 sc1 lds
    s_mov_b64 exec, -1
    v_exp_f32 v116, v116
    v_exp_f32 v117, v117
    v_exp_f32 v118, v118
    v_exp_f32 v119, v119
    v_cvt_pk_bf16_f32 v52, v112, v113
    v_cvt_pk_bf16_f32 v53, v114, v115
    v_cvt_pk_bf16_f32 v54, v116, v117
    v_cvt_pk_bf16_f32 v55, v118, v119
    s_waitcnt lgkmcnt(0)
    v_exp_f32 v88, v88
    v_exp_f32 v89, v89
    v_mfma_f32_32x32x16_bf16 v[72:87], v[36:39], v[52:55], v[72:87]
    s_mov_b64 exec, s[20:21]
    ds_read_b128 v[32:35], v5 offset:0
    ds_read_b128 v[36:39], v5 offset:640
    s_mov_b64 exec, -1
    v_exp_f32 v90, v90
    v_exp_f32 v91, v91
    v_exp_f32 v92, v92
    v_exp_f32 v93, v93
    v_mfma_f32_32x32x16_bf16 v[104:119], v[26:29], v[12:15], 0
    v_exp_f32 v94, v94
    v_exp_f32 v95, v95
    v_cvt_pk_bf16_f32 v48, v88, v89
    v_cvt_pk_bf16_f32 v49, v90, v91
    v_cvt_pk_bf16_f32 v50, v92, v93
    v_cvt_pk_bf16_f32 v51, v94, v95
    v_mfma_f32_32x32x8_bf16 v[104:119], v[30:31], v[18:19], v[104:119]
    ds_read_b128 v[26:29], v3 offset:1280
    ds_read_b64 v[30:31], v4 offset:1280
    v_exp_f32 v96, v96
    v_exp_f32 v97, v97
    v_exp_f32 v98, v98
    v_exp_f32 v99, v99
    v_mfma_f32_32x32x16_bf16 v[56:71], v[40:43], v[48:51], v[56:71]
    v_exp_f32 v100, v100
    v_exp_f32 v101, v101
    v_exp_f32 v102, v102
    v_exp_f32 v103, v103
    v_cvt_pk_bf16_f32 v52, v96, v97
    v_cvt_pk_bf16_f32 v53, v98, v99
    v_cvt_pk_bf16_f32 v54, v100, v101
    v_cvt_pk_bf16_f32 v55, v102, v103
    v_exp_f32 v104, v104
    v_exp_f32 v105, v105
    v_mfma_f32_32x32x16_bf16 v[56:71], v[44:47], v[52:55], v[56:71]
    v_exp_f32 v106, v106
    v_exp_f32 v107, v107
    v_exp_f32 v108, v108
    v_exp_f32 v109, v109
    v_mfma_f32_32x32x16_bf16 v[88:103], v[20:23], v[8:11], 0
    v_exp_f32 v110, v110
    v_exp_f32 v111, v111
    v_cvt_pk_bf16_f32 v48, v104, v105
    v_cvt_pk_bf16_f32 v49, v106, v107
    v_cvt_pk_bf16_f32 v50, v108, v109
    v_cvt_pk_bf16_f32 v51, v110, v111
    v_mfma_f32_32x32x8_bf16 v[88:103], v[24:25], v[16:17], v[88:103]
    v_exp_f32 v112, v112
    v_exp_f32 v113, v113
    v_exp_f32 v114, v114
    v_exp_f32 v115, v115
    v_mfma_f32_32x32x16_bf16 v[72:87], v[40:43], v[48:51], v[72:87]
    v_exp_f32 v116, v116
    v_exp_f32 v117, v117
    v_exp_f32 v118, v118
    v_exp_f32 v119, v119
    v_cvt_pk_bf16_f32 v52, v112, v113
    v_cvt_pk_bf16_f32 v53, v114, v115
    v_cvt_pk_bf16_f32 v54, v116, v117
    v_cvt_pk_bf16_f32 v55, v118, v119
    s_waitcnt lgkmcnt(0)
    v_exp_f32 v88, v88
    v_exp_f32 v89, v89
    v_mfma_f32_32x32x16_bf16 v[72:87], v[44:47], v[52:55], v[72:87]
    s_mov_b64 exec, s[20:21]
    ds_read_b128 v[40:43], v5 offset:1280
    ds_read_b128 v[44:47], v5 offset:1920
    s_mov_b64 exec, -1
    v_exp_f32 v90, v90
    v_exp_f32 v91, v91
    v_exp_f32 v92, v92
    v_exp_f32 v93, v93
    v_mfma_f32_32x32x16_bf16 v[104:119], v[20:23], v[12:15], 0
    v_exp_f32 v94, v94
    v_exp_f32 v95, v95
    v_cvt_pk_bf16_f32 v48, v88, v89
    v_cvt_pk_bf16_f32 v49, v90, v91
    v_cvt_pk_bf16_f32 v50, v92, v93
    v_cvt_pk_bf16_f32 v51, v94, v95
    v_mfma_f32_32x32x8_bf16 v[104:119], v[24:25], v[18:19], v[104:119]
    ds_read_b128 v[20:23], v3 offset:2560
    ds_read_b64 v[24:25], v4 offset:2560
    v_exp_f32 v96, v96
    v_exp_f32 v97, v97
    v_exp_f32 v98, v98
    v_exp_f32 v99, v99
    v_mfma_f32_32x32x16_bf16 v[56:71], v[32:35], v[48:51], v[56:71]
    v_exp_f32 v100, v100
    v_exp_f32 v101, v101
    v_exp_f32 v102, v102
    v_exp_f32 v103, v103
    v_cvt_pk_bf16_f32 v52, v96, v97
    v_cvt_pk_bf16_f32 v53, v98, v99
    v_cvt_pk_bf16_f32 v54, v100, v101
    v_cvt_pk_bf16_f32 v55, v102, v103
    v_exp_f32 v104, v104
    v_exp_f32 v105, v105
    v_mfma_f32_32x32x16_bf16 v[56:71], v[36:39], v[52:55], v[56:71]
    v_exp_f32 v106, v106
    v_exp_f32 v107, v107
    v_exp_f32 v108, v108
    v_exp_f32 v109, v109
    v_mfma_f32_32x32x16_bf16 v[88:103], v[26:29], v[8:11], 0
    v_exp_f32 v110, v110
    v_exp_f32 v111, v111
    v_cvt_pk_bf16_f32 v48, v104, v105
    v_cvt_pk_bf16_f32 v49, v106, v107
    v_cvt_pk_bf16_f32 v50, v108, v109
    v_cvt_pk_bf16_f32 v51, v110, v111
    v_mfma_f32_32x32x8_bf16 v[88:103], v[30:31], v[16:17], v[88:103]
    v_exp_f32 v112, v112
    v_exp_f32 v113, v113
    v_exp_f32 v114, v114
    v_exp_f32 v115, v115
    v_mfma_f32_32x32x16_bf16 v[72:87], v[32:35], v[48:51], v[72:87]
    v_exp_f32 v116, v116
    v_exp_f32 v117, v117
    v_exp_f32 v118, v118
    v_exp_f32 v119, v119
    v_cvt_pk_bf16_f32 v52, v112, v113
    v_cvt_pk_bf16_f32 v53, v114, v115
    v_cvt_pk_bf16_f32 v54, v116, v117
    v_cvt_pk_bf16_f32 v55, v118, v119
    s_waitcnt lgkmcnt(0)
    v_exp_f32 v88, v88
    v_exp_f32 v89, v89
    v_mfma_f32_32x32x16_bf16 v[72:87], v[36:39], v[52:55], v[72:87]
    s_mov_b64 exec, s[20:21]
    ds_read_b128 v[32:35], v5 offset:2560
    ds_read_b128 v[36:39], v5 offset:3200
    s_mov_b64 exec, -1
    v_exp_f32 v90, v90
    v_exp_f32 v91, v91
    v_exp_f32 v92, v92
    v_exp_f32 v93, v93
    v_mfma_f32_32x32x16_bf16 v[104:119], v[26:29], v[12:15], 0
    v_exp_f32 v94, v94
    v_exp_f32 v95, v95
    v_cvt_pk_bf16_f32 v48, v88, v89
    v_cvt_pk_bf16_f32 v49, v90, v91
    v_cvt_pk_bf16_f32 v50, v92, v93
    v_cvt_pk_bf16_f32 v51, v94, v95
    v_mfma_f32_32x32x8_bf16 v[104:119], v[30:31], v[18:19], v[104:119]
    ds_read_b128 v[26:29], v3 offset:3840
    ds_read_b64 v[30:31], v4 offset:3840
    v_exp_f32 v96, v96
    v_exp_f32 v97, v97
    v_exp_f32 v98, v98
    v_exp_f32 v99, v99
    v_mfma_f32_32x32x16_bf16 v[56:71], v[40:43], v[48:51], v[56:71]
    v_exp_f32 v100, v100
    v_exp_f32 v101, v101
    v_exp_f32 v102, v102
    v_exp_f32 v103, v103
    v_cvt_pk_bf16_f32 v52, v96, v97
    v_cvt_pk_bf16_f32 v53, v98, v99
    v_cvt_pk_bf16_f32 v54, v100, v101
    v_cvt_pk_bf16_f32 v55, v102, v103
    s_waitcnt vmcnt(3)
    s_barrier
    v_exp_f32 v104, v104
    v_exp_f32 v105, v105
    v_mfma_f32_32x32x16_bf16 v[56:71], v[44:47], v[52:55], v[56:71]
    v_exp_f32 v106, v106
    v_exp_f32 v107, v107
    v_exp_f32 v108, v108
    v_exp_f32 v109, v109
    v_mfma_f32_32x32x16_bf16 v[88:103], v[20:23], v[8:11], 0
    v_exp_f32 v110, v110
    v_exp_f32 v111, v111
    v_cvt_pk_bf16_f32 v48, v104, v105
    v_cvt_pk_bf16_f32 v49, v106, v107
    v_cvt_pk_bf16_f32 v50, v108, v109
    v_cvt_pk_bf16_f32 v51, v110, v111
    v_mfma_f32_32x32x8_bf16 v[88:103], v[24:25], v[16:17], v[88:103]
    s_add_u32 m0, s69, 61440
    v_exp_f32 v112, v112
    v_exp_f32 v113, v113
    v_exp_f32 v114, v114
    v_exp_f32 v115, v115
    v_mfma_f32_32x32x16_bf16 v[72:87], v[40:43], v[48:51], v[72:87]
    buffer_load_dwordx4 v2, s[8:11], s68 offen offset:0 sc1 lds
    v_exp_f32 v116, v116
    v_exp_f32 v117, v117
    v_exp_f32 v118, v118
    v_exp_f32 v119, v119
    v_cvt_pk_bf16_f32 v52, v112, v113
    v_cvt_pk_bf16_f32 v53, v114, v115
    v_cvt_pk_bf16_f32 v54, v116, v117
    v_cvt_pk_bf16_f32 v55, v118, v119
    s_waitcnt lgkmcnt(0)
    v_exp_f32 v88, v88
    v_exp_f32 v89, v89
    v_mfma_f32_32x32x16_bf16 v[72:87], v[44:47], v[52:55], v[72:87]
    s_mov_b64 exec, s[20:21]
    ds_read_b128 v[40:43], v5 offset:3840
    ds_read_b128 v[44:47], v5 offset:4480
    s_mov_b64 exec, -1
    v_exp_f32 v90, v90
    v_exp_f32 v91, v91
    v_exp_f32 v92, v92
    v_exp_f32 v93, v93
    v_mfma_f32_32x32x16_bf16 v[104:119], v[20:23], v[12:15], 0
    v_exp_f32 v94, v94
    v_exp_f32 v95, v95
    v_cvt_pk_bf16_f32 v48, v88, v89
    v_cvt_pk_bf16_f32 v49, v90, v91
    v_cvt_pk_bf16_f32 v50, v92, v93
    v_cvt_pk_bf16_f32 v51, v94, v95
    v_mfma_f32_32x32x8_bf16 v[104:119], v[24:25], v[18:19], v[104:119]
    ds_read_b128 v[20:23], v3 offset:20480
    ds_read_b64 v[24:25], v4 offset:20480
    v_exp_f32 v96, v96
    v_exp_f32 v97, v97
    v_exp_f32 v98, v98
    v_exp_f32 v99, v99
    v_mfma_f32_32x32x16_bf16 v[56:71], v[32:35], v[48:51], v[56:71]
    buffer_load_dwordx4 v2, s[8:11], s68 offen offset:1024 sc1 lds
    v_exp_f32 v100, v100
    v_exp_f32 v101, v101
    v_exp_f32 v102, v102
    v_exp_f32 v103, v103
    v_cvt_pk_bf16_f32 v52, v96, v97
    v_cvt_pk_bf16_f32 v53, v98, v99
    v_cvt_pk_bf16_f32 v54, v100, v101
    v_cvt_pk_bf16_f32 v55, v102, v103
    v_exp_f32 v104, v104
    v_exp_f32 v105, v105
    v_mfma_f32_32x32x16_bf16 v[56:71], v[36:39], v[52:55], v[56:71]
    v_exp_f32 v106, v106
    v_exp_f32 v107, v107
    v_exp_f32 v108, v108
    v_exp_f32 v109, v109
    v_mfma_f32_32x32x16_bf16 v[88:103], v[26:29], v[8:11], 0
    v_exp_f32 v110, v110
    v_exp_f32 v111, v111
    v_cvt_pk_bf16_f32 v48, v104, v105
    v_cvt_pk_bf16_f32 v49, v106, v107
    v_cvt_pk_bf16_f32 v50, v108, v109
    v_cvt_pk_bf16_f32 v51, v110, v111
    v_mfma_f32_32x32x8_bf16 v[88:103], v[30:31], v[16:17], v[88:103]
    v_exp_f32 v112, v112
    v_exp_f32 v113, v113
    v_exp_f32 v114, v114
    v_exp_f32 v115, v115
    v_mfma_f32_32x32x16_bf16 v[72:87], v[32:35], v[48:51], v[72:87]
    s_mov_b64 exec, s[22:23]
    buffer_load_dwordx4 v2, s[8:11], s68 offen offset:2048 sc1 lds
    s_mov_b64 exec, -1
    v_exp_f32 v116, v116
    v_exp_f32 v117, v117
    v_exp_f32 v118, v118
    v_exp_f32 v119, v119
    v_cvt_pk_bf16_f32 v52, v112, v113
    v_cvt_pk_bf16_f32 v53, v114, v115
    v_cvt_pk_bf16_f32 v54, v116, v117
    v_cvt_pk_bf16_f32 v55, v118, v119
    s_waitcnt lgkmcnt(0)
    v_exp_f32 v88, v88
    v_exp_f32 v89, v89
    v_mfma_f32_32x32x16_bf16 v[72:87], v[36:39], v[52:55], v[72:87]
    s_mov_b64 exec, s[20:21]
    ds_read_b128 v[32:35], v5 offset:20480
    ds_read_b128 v[36:39], v5 offset:21120
    s_mov_b64 exec, -1
    v_exp_f32 v90, v90
    v_exp_f32 v91, v91
    v_exp_f32 v92, v92
    v_exp_f32 v93, v93
    v_mfma_f32_32x32x16_bf16 v[104:119], v[26:29], v[12:15], 0
    v_exp_f32 v94, v94
    v_exp_f32 v95, v95
    v_cvt_pk_bf16_f32 v48, v88, v89
    v_cvt_pk_bf16_f32 v49, v90, v91
    v_cvt_pk_bf16_f32 v50, v92, v93
    v_cvt_pk_bf16_f32 v51, v94, v95
    v_mfma_f32_32x32x8_bf16 v[104:119], v[30:31], v[18:19], v[104:119]
    ds_read_b128 v[26:29], v3 offset:21760
    ds_read_b64 v[30:31], v4 offset:21760
    v_exp_f32 v96, v96
    v_exp_f32 v97, v97
    v_exp_f32 v98, v98
    v_exp_f32 v99, v99
    v_mfma_f32_32x32x16_bf16 v[56:71], v[40:43], v[48:51], v[56:71]
    v_exp_f32 v100, v100
    v_exp_f32 v101, v101
    v_exp_f32 v102, v102
    v_exp_f32 v103, v103
    v_cvt_pk_bf16_f32 v52, v96, v97
    v_cvt_pk_bf16_f32 v53, v98, v99
    v_cvt_pk_bf16_f32 v54, v100, v101
    v_cvt_pk_bf16_f32 v55, v102, v103
    v_exp_f32 v104, v104
    v_exp_f32 v105, v105
    v_mfma_f32_32x32x16_bf16 v[56:71], v[44:47], v[52:55], v[56:71]
    v_exp_f32 v106, v106
    v_exp_f32 v107, v107
    v_exp_f32 v108, v108
    v_exp_f32 v109, v109
    v_mfma_f32_32x32x16_bf16 v[88:103], v[20:23], v[8:11], 0
    v_exp_f32 v110, v110
    v_exp_f32 v111, v111
    v_cvt_pk_bf16_f32 v48, v104, v105
    v_cvt_pk_bf16_f32 v49, v106, v107
    v_cvt_pk_bf16_f32 v50, v108, v109
    v_cvt_pk_bf16_f32 v51, v110, v111
    v_mfma_f32_32x32x8_bf16 v[88:103], v[24:25], v[16:17], v[88:103]
    v_exp_f32 v112, v112
    v_exp_f32 v113, v113
    v_exp_f32 v114, v114
    v_exp_f32 v115, v115
    v_mfma_f32_32x32x16_bf16 v[72:87], v[40:43], v[48:51], v[72:87]
    v_exp_f32 v116, v116
    v_exp_f32 v117, v117
    v_exp_f32 v118, v118
    v_exp_f32 v119, v119
    v_cvt_pk_bf16_f32 v52, v112, v113
    v_cvt_pk_bf16_f32 v53, v114, v115
    v_cvt_pk_bf16_f32 v54, v116, v117
    v_cvt_pk_bf16_f32 v55, v118, v119
    s_waitcnt lgkmcnt(0)
    v_exp_f32 v88, v88
    v_exp_f32 v89, v89
    v_mfma_f32_32x32x16_bf16 v[72:87], v[44:47], v[52:55], v[72:87]
    s_mov_b64 exec, s[20:21]
    ds_read_b128 v[40:43], v5 offset:21760
    ds_read_b128 v[44:47], v5 offset:22400
    s_mov_b64 exec, -1
    v_exp_f32 v90, v90
    v_exp_f32 v91, v91
    v_exp_f32 v92, v92
    v_exp_f32 v93, v93
    v_mfma_f32_32x32x16_bf16 v[104:119], v[20:23], v[12:15], 0
    v_exp_f32 v94, v94
    v_exp_f32 v95, v95
    v_cvt_pk_bf16_f32 v48, v88, v89
    v_cvt_pk_bf16_f32 v49, v90, v91
    v_cvt_pk_bf16_f32 v50, v92, v93
    v_cvt_pk_bf16_f32 v51, v94, v95
    v_mfma_f32_32x32x8_bf16 v[104:119], v[24:25], v[18:19], v[104:119]
    ds_read_b128 v[20:23], v3 offset:23040
    ds_read_b64 v[24:25], v4 offset:23040
    v_exp_f32 v96, v96
    v_exp_f32 v97, v97
    v_exp_f32 v98, v98
    v_exp_f32 v99, v99
    v_mfma_f32_32x32x16_bf16 v[56:71], v[32:35], v[48:51], v[56:71]
    v_exp_f32 v100, v100
    v_exp_f32 v101, v101
    v_exp_f32 v102, v102
    v_exp_f32 v103, v103
    v_cvt_pk_bf16_f32 v52, v96, v97
    v_cvt_pk_bf16_f32 v53, v98, v99
    v_cvt_pk_bf16_f32 v54, v100, v101
    v_cvt_pk_bf16_f32 v55, v102, v103
    v_exp_f32 v104, v104
    v_exp_f32 v105, v105
    v_mfma_f32_32x32x16_bf16 v[56:71], v[36:39], v[52:55], v[56:71]
    v_exp_f32 v106, v106
    v_exp_f32 v107, v107
    v_exp_f32 v108, v108
    v_exp_f32 v109, v109
    v_mfma_f32_32x32x16_bf16 v[88:103], v[26:29], v[8:11], 0
    v_exp_f32 v110, v110
    v_exp_f32 v111, v111
    v_cvt_pk_bf16_f32 v48, v104, v105
    v_cvt_pk_bf16_f32 v49, v106, v107
    v_cvt_pk_bf16_f32 v50, v108, v109
    v_cvt_pk_bf16_f32 v51, v110, v111
    v_mfma_f32_32x32x8_bf16 v[88:103], v[30:31], v[16:17], v[88:103]
    v_exp_f32 v112, v112
    v_exp_f32 v113, v113
    v_exp_f32 v114, v114
    v_exp_f32 v115, v115
    v_mfma_f32_32x32x16_bf16 v[72:87], v[32:35], v[48:51], v[72:87]
    v_exp_f32 v116, v116
    v_exp_f32 v117, v117
    v_exp_f32 v118, v118
    v_exp_f32 v119, v119
    v_cvt_pk_bf16_f32 v52, v112, v113
    v_cvt_pk_bf16_f32 v53, v114, v115
    v_cvt_pk_bf16_f32 v54, v116, v117
    v_cvt_pk_bf16_f32 v55, v118, v119
    s_waitcnt lgkmcnt(0)
    v_exp_f32 v88, v88
    v_exp_f32 v89, v89
    v_mfma_f32_32x32x16_bf16 v[72:87], v[36:39], v[52:55], v[72:87]
    s_mov_b64 exec, s[20:21]
    ds_read_b128 v[32:35], v5 offset:23040
    ds_read_b128 v[36:39], v5 offset:23680
    s_mov_b64 exec, -1
    v_exp_f32 v90, v90
    v_exp_f32 v91, v91
    v_exp_f32 v92, v92
    v_exp_f32 v93, v93
    v_mfma_f32_32x32x16_bf16 v[104:119], v[26:29], v[12:15], 0
    v_exp_f32 v94, v94
    v_exp_f32 v95, v95
    v_cvt_pk_bf16_f32 v48, v88, v89
    v_cvt_pk_bf16_f32 v49, v90, v91
    v_cvt_pk_bf16_f32 v50, v92, v93
    v_cvt_pk_bf16_f32 v51, v94, v95
    v_mfma_f32_32x32x8_bf16 v[104:119], v[30:31], v[18:19], v[104:119]
    ds_read_b128 v[26:29], v3 offset:24320
    ds_read_b64 v[30:31], v4 offset:24320
    v_exp_f32 v96, v96
    v_exp_f32 v97, v97
    v_exp_f32 v98, v98
    v_exp_f32 v99, v99
    v_mfma_f32_32x32x16_bf16 v[56:71], v[40:43], v[48:51], v[56:71]
    v_exp_f32 v100, v100
    v_exp_f32 v101, v101
    v_exp_f32 v102, v102
    v_exp_f32 v103, v103
    v_cvt_pk_bf16_f32 v52, v96, v97
    v_cvt_pk_bf16_f32 v53, v98, v99
    v_cvt_pk_bf16_f32 v54, v100, v101
    v_cvt_pk_bf16_f32 v55, v102, v103
    s_waitcnt vmcnt(3)
    s_barrier
    v_exp_f32 v104, v104
    v_exp_f32 v105, v105
    v_mfma_f32_32x32x16_bf16 v[56:71], v[44:47], v[52:55], v[56:71]
    v_exp_f32 v106, v106
    v_exp_f32 v107, v107
    v_exp_f32 v108, v108
    v_exp_f32 v109, v109
    v_mfma_f32_32x32x16_bf16 v[88:103], v[20:23], v[8:11], 0
    v_exp_f32 v110, v110
    v_exp_f32 v111, v111
    v_cvt_pk_bf16_f32 v48, v104, v105
    v_cvt_pk_bf16_f32 v49, v106, v107
    v_cvt_pk_bf16_f32 v50, v108, v109
    v_cvt_pk_bf16_f32 v51, v110, v111
    v_mfma_f32_32x32x8_bf16 v[88:103], v[24:25], v[16:17], v[88:103]
    v_exp_f32 v112, v112
    v_exp_f32 v113, v113
    v_exp_f32 v114, v114
    v_exp_f32 v115, v115
    v_mfma_f32_32x32x16_bf16 v[72:87], v[40:43], v[48:51], v[72:87]
    v_exp_f32 v116, v116
    v_exp_f32 v117, v117
    v_exp_f32 v118, v118
    v_exp_f32 v119, v119
    v_cvt_pk_bf16_f32 v52, v112, v113
    v_cvt_pk_bf16_f32 v53, v114, v115
    v_cvt_pk_bf16_f32 v54, v116, v117
    v_cvt_pk_bf16_f32 v55, v118, v119
    s_waitcnt lgkmcnt(0)
    v_exp_f32 v88, v88
    v_exp_f32 v89, v89
    v_mfma_f32_32x32x16_bf16 v[72:87], v[44:47], v[52:55], v[72:87]
    s_mov_b64 exec, s[20:21]
    ds_read_b128 v[40:43], v5 offset:24320
    ds_read_b128 v[44:47], v5 offset:24960
    s_mov_b64 exec, -1
    v_exp_f32 v90, v90
    v_exp_f32 v91, v91
    v_exp_f32 v92, v92
    v_exp_f32 v93, v93
    v_mfma_f32_32x32x16_bf16 v[104:119], v[20:23], v[12:15], 0
    v_exp_f32 v94, v94
    v_exp_f32 v95, v95
    v_cvt_pk_bf16_f32 v48, v88, v89
    v_cvt_pk_bf16_f32 v49, v90, v91
    v_cvt_pk_bf16_f32 v50, v92, v93
    v_cvt_pk_bf16_f32 v51, v94, v95
    v_mfma_f32_32x32x8_bf16 v[104:119], v[24:25], v[18:19], v[104:119]
    ds_read_b128 v[20:23], v3 offset:40960
    ds_read_b64 v[24:25], v4 offset:40960
    v_exp_f32 v96, v96
    v_exp_f32 v97, v97
    v_exp_f32 v98, v98
    v_exp_f32 v99, v99
    v_mfma_f32_32x32x16_bf16 v[56:71], v[32:35], v[48:51], v[56:71]
    v_exp_f32 v100, v100
    v_exp_f32 v101, v101
    v_exp_f32 v102, v102
    v_exp_f32 v103, v103
    v_cvt_pk_bf16_f32 v52, v96, v97
    v_cvt_pk_bf16_f32 v53, v98, v99
    v_cvt_pk_bf16_f32 v54, v100, v101
    v_cvt_pk_bf16_f32 v55, v102, v103
    v_exp_f32 v104, v104
    v_exp_f32 v105, v105
    v_mfma_f32_32x32x16_bf16 v[56:71], v[36:39], v[52:55], v[56:71]
    v_exp_f32 v106, v106
    v_exp_f32 v107, v107
    v_exp_f32 v108, v108
    v_exp_f32 v109, v109
    v_mfma_f32_32x32x16_bf16 v[88:103], v[26:29], v[8:11], 0
    v_exp_f32 v110, v110
    v_exp_f32 v111, v111
    v_cvt_pk_bf16_f32 v48, v104, v105
    v_cvt_pk_bf16_f32 v49, v106, v107
    v_cvt_pk_bf16_f32 v50, v108, v109
    v_cvt_pk_bf16_f32 v51, v110, v111
    v_mfma_f32_32x32x8_bf16 v[88:103], v[30:31], v[16:17], v[88:103]
    v_exp_f32 v112, v112
    v_exp_f32 v113, v113
    v_exp_f32 v114, v114
    v_exp_f32 v115, v115
    v_mfma_f32_32x32x16_bf16 v[72:87], v[32:35], v[48:51], v[72:87]
    v_exp_f32 v116, v116
    v_exp_f32 v117, v117
    v_exp_f32 v118, v118
    v_exp_f32 v119, v119
    v_cvt_pk_bf16_f32 v52, v112, v113
    v_cvt_pk_bf16_f32 v53, v114, v115
    v_cvt_pk_bf16_f32 v54, v116, v117
    v_cvt_pk_bf16_f32 v55, v118, v119
    s_waitcnt lgkmcnt(0)
    v_exp_f32 v88, v88
    v_exp_f32 v89, v89
    v_mfma_f32_32x32x16_bf16 v[72:87], v[36:39], v[52:55], v[72:87]
    s_mov_b64 exec, s[20:21]
    ds_read_b128 v[32:35], v5 offset:40960
    ds_read_b128 v[36:39], v5 offset:41600
    s_mov_b64 exec, -1
    v_exp_f32 v90, v90
    v_exp_f32 v91, v91
    v_exp_f32 v92, v92
    v_exp_f32 v93, v93
    v_mfma_f32_32x32x16_bf16 v[104:119], v[26:29], v[12:15], 0
    v_exp_f32 v94, v94
    v_exp_f32 v95, v95
    v_cvt_pk_bf16_f32 v48, v88, v89
    v_cvt_pk_bf16_f32 v49, v90, v91
    v_cvt_pk_bf16_f32 v50, v92, v93
    v_cvt_pk_bf16_f32 v51, v94, v95
    v_mfma_f32_32x32x8_bf16 v[104:119], v[30:31], v[18:19], v[104:119]
    ds_read_b128 v[26:29], v3 offset:42240
    ds_read_b64 v[30:31], v4 offset:42240
    v_exp_f32 v96, v96
    v_exp_f32 v97, v97
    v_exp_f32 v98, v98
    v_exp_f32 v99, v99
    v_mfma_f32_32x32x16_bf16 v[56:71], v[40:43], v[48:51], v[56:71]
    v_exp_f32 v100, v100
    v_exp_f32 v101, v101
    v_exp_f32 v102, v102
    v_exp_f32 v103, v103
    v_cvt_pk_bf16_f32 v52, v96, v97
    v_cvt_pk_bf16_f32 v53, v98, v99
    v_cvt_pk_bf16_f32 v54, v100, v101
    v_cvt_pk_bf16_f32 v55, v102, v103
    v_exp_f32 v104, v104
    v_exp_f32 v105, v105
    v_mfma_f32_32x32x16_bf16 v[56:71], v[44:47], v[52:55], v[56:71]
    v_exp_f32 v106, v106
    v_exp_f32 v107, v107
    v_exp_f32 v108, v108
    v_exp_f32 v109, v109
    v_mfma_f32_32x32x16_bf16 v[88:103], v[20:23], v[8:11], 0
    v_exp_f32 v110, v110
    v_exp_f32 v111, v111
    v_cvt_pk_bf16_f32 v48, v104, v105
    v_cvt_pk_bf16_f32 v49, v106, v107
    v_cvt_pk_bf16_f32 v50, v108, v109
    v_cvt_pk_bf16_f32 v51, v110, v111
    v_mfma_f32_32x32x8_bf16 v[88:103], v[24:25], v[16:17], v[88:103]
    v_exp_f32 v112, v112
    v_exp_f32 v113, v113
    v_exp_f32 v114, v114
    v_exp_f32 v115, v115
    v_mfma_f32_32x32x16_bf16 v[72:87], v[40:43], v[48:51], v[72:87]
    v_exp_f32 v116, v116
    v_exp_f32 v117, v117
    v_exp_f32 v118, v118
    v_exp_f32 v119, v119
    v_cvt_pk_bf16_f32 v52, v112, v113
    v_cvt_pk_bf16_f32 v53, v114, v115
    v_cvt_pk_bf16_f32 v54, v116, v117
    v_cvt_pk_bf16_f32 v55, v118, v119
    s_waitcnt lgkmcnt(0)
    v_exp_f32 v88, v88
    v_exp_f32 v89, v89
    v_mfma_f32_32x32x16_bf16 v[72:87], v[44:47], v[52:55], v[72:87]
    s_mov_b64 exec, s[20:21]
    ds_read_b128 v[40:43], v5 offset:42240
    ds_read_b128 v[44:47], v5 offset:42880
    s_mov_b64 exec, -1
    v_exp_f32 v90, v90
    v_exp_f32 v91, v91
    v_exp_f32 v92, v92
    v_exp_f32 v93, v93
    v_mfma_f32_32x32x16_bf16 v[104:119], v[20:23], v[12:15], 0
    v_exp_f32 v94, v94
    v_exp_f32 v95, v95
    v_cvt_pk_bf16_f32 v48, v88, v89
    v_cvt_pk_bf16_f32 v49, v90, v91
    v_cvt_pk_bf16_f32 v50, v92, v93
    v_cvt_pk_bf16_f32 v51, v94, v95
    v_mfma_f32_32x32x8_bf16 v[104:119], v[24:25], v[18:19], v[104:119]
    ds_read_b128 v[20:23], v3 offset:43520
    ds_read_b64 v[24:25], v4 offset:43520
    v_exp_f32 v96, v96
    v_exp_f32 v97, v97
    v_exp_f32 v98, v98
    v_exp_f32 v99, v99
    v_mfma_f32_32x32x16_bf16 v[56:71], v[32:35], v[48:51], v[56:71]
    v_exp_f32 v100, v100
    v_exp_f32 v101, v101
    v_exp_f32 v102, v102
    v_exp_f32 v103, v103
    v_cvt_pk_bf16_f32 v52, v96, v97
    v_cvt_pk_bf16_f32 v53, v98, v99
    v_cvt_pk_bf16_f32 v54, v100, v101
    v_cvt_pk_bf16_f32 v55, v102, v103
    v_exp_f32 v104, v104
    v_exp_f32 v105, v105
    v_mfma_f32_32x32x16_bf16 v[56:71], v[36:39], v[52:55], v[56:71]
    v_exp_f32 v106, v106
    v_exp_f32 v107, v107
    v_exp_f32 v108, v108
    v_exp_f32 v109, v109
    v_mfma_f32_32x32x16_bf16 v[88:103], v[26:29], v[8:11], 0
    v_exp_f32 v110, v110
    v_exp_f32 v111, v111
    v_cvt_pk_bf16_f32 v48, v104, v105
    v_cvt_pk_bf16_f32 v49, v106, v107
    v_cvt_pk_bf16_f32 v50, v108, v109
    v_cvt_pk_bf16_f32 v51, v110, v111
    v_mfma_f32_32x32x8_bf16 v[88:103], v[30:31], v[16:17], v[88:103]
    v_exp_f32 v112, v112
    v_exp_f32 v113, v113
    v_exp_f32 v114, v114
    v_exp_f32 v115, v115
    v_mfma_f32_32x32x16_bf16 v[72:87], v[32:35], v[48:51], v[72:87]
    v_exp_f32 v116, v116
    v_exp_f32 v117, v117
    v_exp_f32 v118, v118
    v_exp_f32 v119, v119
    v_cvt_pk_bf16_f32 v52, v112, v113
    v_cvt_pk_bf16_f32 v53, v114, v115
    v_cvt_pk_bf16_f32 v54, v116, v117
    v_cvt_pk_bf16_f32 v55, v118, v119
    s_waitcnt lgkmcnt(0)
    v_exp_f32 v88, v88
    v_exp_f32 v89, v89
    v_mfma_f32_32x32x16_bf16 v[72:87], v[36:39], v[52:55], v[72:87]
    s_mov_b64 exec, s[20:21]
    ds_read_b128 v[32:35], v5 offset:43520
    ds_read_b128 v[36:39], v5 offset:44160
    s_mov_b64 exec, -1
    v_exp_f32 v90, v90
    v_exp_f32 v91, v91
    v_exp_f32 v92, v92
    v_exp_f32 v93, v93
    v_mfma_f32_32x32x16_bf16 v[104:119], v[26:29], v[12:15], 0
    v_exp_f32 v94, v94
    v_exp_f32 v95, v95
    v_cvt_pk_bf16_f32 v48, v88, v89
    v_cvt_pk_bf16_f32 v49, v90, v91
    v_cvt_pk_bf16_f32 v50, v92, v93
    v_cvt_pk_bf16_f32 v51, v94, v95
    v_mfma_f32_32x32x8_bf16 v[104:119], v[30:31], v[18:19], v[104:119]
    ds_read_b128 v[26:29], v3 offset:44800
    ds_read_b64 v[30:31], v4 offset:44800
    v_exp_f32 v96, v96
    v_exp_f32 v97, v97
    v_exp_f32 v98, v98
    v_exp_f32 v99, v99
    v_mfma_f32_32x32x16_bf16 v[56:71], v[40:43], v[48:51], v[56:71]
    v_exp_f32 v100, v100
    v_exp_f32 v101, v101
    v_exp_f32 v102, v102
    v_exp_f32 v103, v103
    v_cvt_pk_bf16_f32 v52, v96, v97
    v_cvt_pk_bf16_f32 v53, v98, v99
    v_cvt_pk_bf16_f32 v54, v100, v101
    v_cvt_pk_bf16_f32 v55, v102, v103
    s_waitcnt vmcnt(0)
    s_barrier
    v_exp_f32 v104, v104
    v_exp_f32 v105, v105
    v_mfma_f32_32x32x16_bf16 v[56:71], v[44:47], v[52:55], v[56:71]
    v_exp_f32 v106, v106
    v_exp_f32 v107, v107
    v_exp_f32 v108, v108
    v_exp_f32 v109, v109
    v_mfma_f32_32x32x16_bf16 v[88:103], v[20:23], v[8:11], 0
    v_exp_f32 v110, v110
    v_exp_f32 v111, v111
    v_cvt_pk_bf16_f32 v48, v104, v105
    v_cvt_pk_bf16_f32 v49, v106, v107
    v_cvt_pk_bf16_f32 v50, v108, v109
    v_cvt_pk_bf16_f32 v51, v110, v111
    v_mfma_f32_32x32x8_bf16 v[88:103], v[24:25], v[16:17], v[88:103]
    v_exp_f32 v112, v112
    v_exp_f32 v113, v113
    v_exp_f32 v114, v114
    v_exp_f32 v115, v115
    v_mfma_f32_32x32x16_bf16 v[72:87], v[40:43], v[48:51], v[72:87]
    v_exp_f32 v116, v116
    v_exp_f32 v117, v117
    v_exp_f32 v118, v118
    v_exp_f32 v119, v119
    v_cvt_pk_bf16_f32 v52, v112, v113
    v_cvt_pk_bf16_f32 v53, v114, v115
    v_cvt_pk_bf16_f32 v54, v116, v117
    v_cvt_pk_bf16_f32 v55, v118, v119
    s_waitcnt lgkmcnt(0)
    v_exp_f32 v88, v88
    v_exp_f32 v89, v89
    v_mfma_f32_32x32x16_bf16 v[72:87], v[44:47], v[52:55], v[72:87]
    s_mov_b64 exec, s[20:21]
    ds_read_b128 v[40:43], v5 offset:44800
    ds_read_b128 v[44:47], v5 offset:45440
    s_mov_b64 exec, -1
    v_exp_f32 v90, v90
    v_exp_f32 v91, v91
    v_exp_f32 v92, v92
    v_exp_f32 v93, v93
    v_mfma_f32_32x32x16_bf16 v[104:119], v[20:23], v[12:15], 0
    v_exp_f32 v94, v94
    v_exp_f32 v95, v95
    v_cvt_pk_bf16_f32 v48, v88, v89
    v_cvt_pk_bf16_f32 v49, v90, v91
    v_cvt_pk_bf16_f32 v50, v92, v93
    v_cvt_pk_bf16_f32 v51, v94, v95
    v_mfma_f32_32x32x8_bf16 v[104:119], v[24:25], v[18:19], v[104:119]
    ds_read_b128 v[20:23], v3 offset:61440
    ds_read_b64 v[24:25], v4 offset:61440
    v_exp_f32 v96, v96
    v_exp_f32 v97, v97
    v_exp_f32 v98, v98
    v_exp_f32 v99, v99
    v_mfma_f32_32x32x16_bf16 v[56:71], v[32:35], v[48:51], v[56:71]
    v_exp_f32 v100, v100
    v_exp_f32 v101, v101
    v_exp_f32 v102, v102
    v_exp_f32 v103, v103
    v_cvt_pk_bf16_f32 v52, v96, v97
    v_cvt_pk_bf16_f32 v53, v98, v99
    v_cvt_pk_bf16_f32 v54, v100, v101
    v_cvt_pk_bf16_f32 v55, v102, v103
    v_exp_f32 v104, v104
    v_exp_f32 v105, v105
    v_mfma_f32_32x32x16_bf16 v[56:71], v[36:39], v[52:55], v[56:71]
    v_exp_f32 v106, v106
    v_exp_f32 v107, v107
    v_exp_f32 v108, v108
    v_exp_f32 v109, v109
    v_mfma_f32_32x32x16_bf16 v[88:103], v[26:29], v[8:11], 0
    v_exp_f32 v110, v110
    v_exp_f32 v111, v111
    v_cvt_pk_bf16_f32 v48, v104, v105
    v_cvt_pk_bf16_f32 v49, v106, v107
    v_cvt_pk_bf16_f32 v50, v108, v109
    v_cvt_pk_bf16_f32 v51, v110, v111
    v_mfma_f32_32x32x8_bf16 v[88:103], v[30:31], v[16:17], v[88:103]
    v_exp_f32 v112, v112
    v_exp_f32 v113, v113
    v_exp_f32 v114, v114
    v_exp_f32 v115, v115
    v_mfma_f32_32x32x16_bf16 v[72:87], v[32:35], v[48:51], v[72:87]
    v_exp_f32 v116, v116
    v_exp_f32 v117, v117
    v_exp_f32 v118, v118
    v_exp_f32 v119, v119
    v_cvt_pk_bf16_f32 v52, v112, v113
    v_cvt_pk_bf16_f32 v53, v114, v115
    v_cvt_pk_bf16_f32 v54, v116, v117
    v_cvt_pk_bf16_f32 v55, v118, v119
    s_waitcnt lgkmcnt(0)
    v_exp_f32 v88, v88
    v_exp_f32 v89, v89
    v_mfma_f32_32x32x16_bf16 v[72:87], v[36:39], v[52:55], v[72:87]
    s_mov_b64 exec, s[20:21]
    ds_read_b128 v[32:35], v1 offset:0
    ds_read_b128 v[36:39], v1 offset:640
    s_mov_b64 exec, -1
    v_exp_f32 v90, v90
    v_exp_f32 v91, v91
    v_exp_f32 v92, v92
    v_exp_f32 v93, v93
    v_mfma_f32_32x32x16_bf16 v[104:119], v[26:29], v[12:15], 0
    v_exp_f32 v94, v94
    v_exp_f32 v95, v95
    v_cvt_pk_bf16_f32 v48, v88, v89
    v_cvt_pk_bf16_f32 v49, v90, v91
    v_cvt_pk_bf16_f32 v50, v92, v93
    v_cvt_pk_bf16_f32 v51, v94, v95
    v_mfma_f32_32x32x8_bf16 v[104:119], v[30:31], v[18:19], v[104:119]
    ds_read_b128 v[26:29], v3 offset:62720
    ds_read_b64 v[30:31], v4 offset:62720
    v_exp_f32 v96, v96
    v_exp_f32 v97, v97
    v_exp_f32 v98, v98
    v_exp_f32 v99, v99
    v_mfma_f32_32x32x16_bf16 v[56:71], v[40:43], v[48:51], v[56:71]
    v_exp_f32 v100, v100
    v_exp_f32 v101, v101
    v_exp_f32 v102, v102
    v_exp_f32 v103, v103
    v_cvt_pk_bf16_f32 v52, v96, v97
    v_cvt_pk_bf16_f32 v53, v98, v99
    v_cvt_pk_bf16_f32 v54, v100, v101
    v_cvt_pk_bf16_f32 v55, v102, v103
    v_exp_f32 v104, v104
    v_exp_f32 v105, v105
    v_mfma_f32_32x32x16_bf16 v[56:71], v[44:47], v[52:55], v[56:71]
    v_exp_f32 v106, v106
    v_exp_f32 v107, v107
    v_exp_f32 v108, v108
    v_exp_f32 v109, v109
    v_mfma_f32_32x32x16_bf16 v[88:103], v[20:23], v[8:11], 0
    v_exp_f32 v110, v110
    v_exp_f32 v111, v111
    v_cvt_pk_bf16_f32 v48, v104, v105
    v_cvt_pk_bf16_f32 v49, v106, v107
    v_cvt_pk_bf16_f32 v50, v108, v109
    v_cvt_pk_bf16_f32 v51, v110, v111
    v_mfma_f32_32x32x8_bf16 v[88:103], v[24:25], v[16:17], v[88:103]
    v_exp_f32 v112, v112
    v_exp_f32 v113, v113
    v_exp_f32 v114, v114
    v_exp_f32 v115, v115
    v_mfma_f32_32x32x16_bf16 v[72:87], v[40:43], v[48:51], v[72:87]
    v_exp_f32 v116, v116
    v_exp_f32 v117, v117
    v_exp_f32 v118, v118
    v_exp_f32 v119, v119
    v_cvt_pk_bf16_f32 v52, v112, v113
    v_cvt_pk_bf16_f32 v53, v114, v115
    v_cvt_pk_bf16_f32 v54, v116, v117
    v_cvt_pk_bf16_f32 v55, v118, v119
    s_waitcnt lgkmcnt(0)
    v_exp_f32 v88, v88
    v_exp_f32 v89, v89
    v_mfma_f32_32x32x16_bf16 v[72:87], v[44:47], v[52:55], v[72:87]
    s_mov_b64 exec, s[20:21]
    ds_read_b128 v[40:43], v1 offset:1280
    ds_read_b128 v[44:47], v1 offset:1920
    s_mov_b64 exec, -1
    v_exp_f32 v90, v90
    v_exp_f32 v91, v91
    v_exp_f32 v92, v92
    v_exp_f32 v93, v93
    v_mfma_f32_32x32x16_bf16 v[104:119], v[20:23], v[12:15], 0
    v_exp_f32 v94, v94
    v_exp_f32 v95, v95
    v_cvt_pk_bf16_f32 v48, v88, v89
    v_cvt_pk_bf16_f32 v49, v90, v91
    v_cvt_pk_bf16_f32 v50, v92, v93
    v_cvt_pk_bf16_f32 v51, v94, v95
    v_mfma_f32_32x32x8_bf16 v[104:119], v[24:25], v[18:19], v[104:119]
    ds_read_b128 v[20:23], v3 offset:64000
    ds_read_b64 v[24:25], v4 offset:64000
    v_exp_f32 v96, v96
    v_exp_f32 v97, v97
    v_exp_f32 v98, v98
    v_exp_f32 v99, v99
    v_mfma_f32_32x32x16_bf16 v[56:71], v[32:35], v[48:51], v[56:71]
    v_exp_f32 v100, v100
    v_exp_f32 v101, v101
    v_exp_f32 v102, v102
    v_exp_f32 v103, v103
    v_cvt_pk_bf16_f32 v52, v96, v97
    v_cvt_pk_bf16_f32 v53, v98, v99
    v_cvt_pk_bf16_f32 v54, v100, v101
    v_cvt_pk_bf16_f32 v55, v102, v103
    v_exp_f32 v104, v104
    v_exp_f32 v105, v105
    v_mfma_f32_32x32x16_bf16 v[56:71], v[36:39], v[52:55], v[56:71]
    v_exp_f32 v106, v106
    v_exp_f32 v107, v107
    v_exp_f32 v108, v108
    v_exp_f32 v109, v109
    v_mfma_f32_32x32x16_bf16 v[88:103], v[26:29], v[8:11], 0
    v_exp_f32 v110, v110
    v_exp_f32 v111, v111
    v_cvt_pk_bf16_f32 v48, v104, v105
    v_cvt_pk_bf16_f32 v49, v106, v107
    v_cvt_pk_bf16_f32 v50, v108, v109
    v_cvt_pk_bf16_f32 v51, v110, v111
    v_mfma_f32_32x32x8_bf16 v[88:103], v[30:31], v[16:17], v[88:103]
    v_exp_f32 v112, v112
    v_exp_f32 v113, v113
    v_exp_f32 v114, v114
    v_exp_f32 v115, v115
    v_mfma_f32_32x32x16_bf16 v[72:87], v[32:35], v[48:51], v[72:87]
    v_exp_f32 v116, v116
    v_exp_f32 v117, v117
    v_exp_f32 v118, v118
    v_exp_f32 v119, v119
    v_cvt_pk_bf16_f32 v52, v112, v113
    v_cvt_pk_bf16_f32 v53, v114, v115
    v_cvt_pk_bf16_f32 v54, v116, v117
    v_cvt_pk_bf16_f32 v55, v118, v119
    s_waitcnt lgkmcnt(0)
    v_exp_f32 v88, v88
    v_exp_f32 v89, v89
    v_mfma_f32_32x32x16_bf16 v[72:87], v[36:39], v[52:55], v[72:87]
    s_mov_b64 exec, s[20:21]
    ds_read_b128 v[32:35], v1 offset:2560
    ds_read_b128 v[36:39], v1 offset:3200
    s_mov_b64 exec, -1
    v_exp_f32 v90, v90
    v_exp_f32 v91, v91
    v_exp_f32 v92, v92
    v_exp_f32 v93, v93
    v_mfma_f32_32x32x16_bf16 v[104:119], v[26:29], v[12:15], 0
    v_exp_f32 v94, v94
    v_exp_f32 v95, v95
    v_cvt_pk_bf16_f32 v48, v88, v89
    v_cvt_pk_bf16_f32 v49, v90, v91
    v_cvt_pk_bf16_f32 v50, v92, v93
    v_cvt_pk_bf16_f32 v51, v94, v95
    v_mfma_f32_32x32x8_bf16 v[104:119], v[30:31], v[18:19], v[104:119]
    ds_read_b128 v[26:29], v3 offset:65280
    ds_read_b64 v[30:31], v4 offset:65280
    v_exp_f32 v96, v96
    v_exp_f32 v97, v97
    v_exp_f32 v98, v98
    v_exp_f32 v99, v99
    v_mfma_f32_32x32x16_bf16 v[56:71], v[40:43], v[48:51], v[56:71]
    v_exp_f32 v100, v100
    v_exp_f32 v101, v101
    v_exp_f32 v102, v102
    v_exp_f32 v103, v103
    v_cvt_pk_bf16_f32 v52, v96, v97
    v_cvt_pk_bf16_f32 v53, v98, v99
    v_cvt_pk_bf16_f32 v54, v100, v101
    v_cvt_pk_bf16_f32 v55, v102, v103
    v_exp_f32 v104, v104
    v_exp_f32 v105, v105
    v_mfma_f32_32x32x16_bf16 v[56:71], v[44:47], v[52:55], v[56:71]
    v_exp_f32 v106, v106
    v_exp_f32 v107, v107
    v_exp_f32 v108, v108
    v_exp_f32 v109, v109
    v_mfma_f32_32x32x16_bf16 v[88:103], v[20:23], v[8:11], 0
    v_exp_f32 v110, v110
    v_exp_f32 v111, v111
    v_cvt_pk_bf16_f32 v48, v104, v105
    v_cvt_pk_bf16_f32 v49, v106, v107
    v_cvt_pk_bf16_f32 v50, v108, v109
    v_cvt_pk_bf16_f32 v51, v110, v111
    v_mfma_f32_32x32x8_bf16 v[88:103], v[24:25], v[16:17], v[88:103]
    v_exp_f32 v112, v112
    v_exp_f32 v113, v113
    v_exp_f32 v114, v114
    v_exp_f32 v115, v115
    v_mfma_f32_32x32x16_bf16 v[72:87], v[40:43], v[48:51], v[72:87]
    v_exp_f32 v116, v116
    v_exp_f32 v117, v117
    v_exp_f32 v118, v118
    v_exp_f32 v119, v119
    v_cvt_pk_bf16_f32 v52, v112, v113
    v_cvt_pk_bf16_f32 v53, v114, v115
    v_cvt_pk_bf16_f32 v54, v116, v117
    v_cvt_pk_bf16_f32 v55, v118, v119
    s_waitcnt lgkmcnt(0)
    v_exp_f32 v88, v88
    v_exp_f32 v89, v89
    v_mfma_f32_32x32x16_bf16 v[72:87], v[44:47], v[52:55], v[72:87]
    s_mov_b64 exec, s[20:21]
    ds_read_b128 v[40:43], v1 offset:3840
    ds_read_b128 v[44:47], v1 offset:4480
    s_mov_b64 exec, -1
    v_exp_f32 v90, v90
    v_exp_f32 v91, v91
    v_exp_f32 v92, v92
    v_exp_f32 v93, v93
    v_mfma_f32_32x32x16_bf16 v[104:119], v[20:23], v[12:15], 0
    v_exp_f32 v94, v94
    v_exp_f32 v95, v95
    v_cvt_pk_bf16_f32 v48, v88, v89
    v_cvt_pk_bf16_f32 v49, v90, v91
    v_cvt_pk_bf16_f32 v50, v92, v93
    v_cvt_pk_bf16_f32 v51, v94, v95
    v_mfma_f32_32x32x8_bf16 v[104:119], v[24:25], v[18:19], v[104:119]
    v_exp_f32 v96, v96
    v_exp_f32 v97, v97
    v_exp_f32 v98, v98
    v_exp_f32 v99, v99
    v_mfma_f32_32x32x16_bf16 v[56:71], v[32:35], v[48:51], v[56:71]
    v_exp_f32 v100, v100
    v_exp_f32 v101, v101
    v_exp_f32 v102, v102
    v_exp_f32 v103, v103
    v_cvt_pk_bf16_f32 v52, v96, v97
    v_cvt_pk_bf16_f32 v53, v98, v99
    v_cvt_pk_bf16_f32 v54, v100, v101
    v_cvt_pk_bf16_f32 v55, v102, v103
    v_exp_f32 v104, v104
    v_exp_f32 v105, v105
    v_mfma_f32_32x32x16_bf16 v[56:71], v[36:39], v[52:55], v[56:71]
    v_exp_f32 v106, v106
    v_exp_f32 v107, v107
    v_exp_f32 v108, v108
    v_exp_f32 v109, v109
    v_mfma_f32_32x32x16_bf16 v[88:103], v[26:29], v[8:11], 0
    v_exp_f32 v110, v110
    v_exp_f32 v111, v111
    v_cvt_pk_bf16_f32 v48, v104, v105
    v_cvt_pk_bf16_f32 v49, v106, v107
    v_cvt_pk_bf16_f32 v50, v108, v109
    v_cvt_pk_bf16_f32 v51, v110, v111
    v_mfma_f32_32x32x8_bf16 v[88:103], v[30:31], v[16:17], v[88:103]
    v_exp_f32 v112, v112
    v_exp_f32 v113, v113
    v_exp_f32 v114, v114
    v_exp_f32 v115, v115
    v_mfma_f32_32x32x16_bf16 v[72:87], v[32:35], v[48:51], v[72:87]
    v_exp_f32 v116, v116
    v_exp_f32 v117, v117
    v_exp_f32 v118, v118
    v_exp_f32 v119, v119
    v_cvt_pk_bf16_f32 v52, v112, v113
    v_cvt_pk_bf16_f32 v53, v114, v115
    v_cvt_pk_bf16_f32 v54, v116, v117
    v_cvt_pk_bf16_f32 v55, v118, v119
    s_waitcnt lgkmcnt(0)
    v_exp_f32 v88, v88
    v_exp_f32 v89, v89
    v_mfma_f32_32x32x16_bf16 v[72:87], v[36:39], v[52:55], v[72:87]
    v_exp_f32 v90, v90
    v_exp_f32 v91, v91
    v_exp_f32 v92, v92
    v_exp_f32 v93, v93
    v_mfma_f32_32x32x16_bf16 v[104:119], v[26:29], v[12:15], 0
    v_exp_f32 v94, v94
    v_exp_f32 v95, v95
    v_cvt_pk_bf16_f32 v48, v88, v89
    v_cvt_pk_bf16_f32 v49, v90, v91
    v_cvt_pk_bf16_f32 v50, v92, v93
    v_cvt_pk_bf16_f32 v51, v94, v95
    v_mfma_f32_32x32x8_bf16 v[104:119], v[30:31], v[18:19], v[104:119]
    v_exp_f32 v96, v96
    v_exp_f32 v97, v97
    v_exp_f32 v98, v98
    v_exp_f32 v99, v99
    v_mfma_f32_32x32x16_bf16 v[56:71], v[40:43], v[48:51], v[56:71]
    v_exp_f32 v100, v100
    v_exp_f32 v101, v101
    v_exp_f32 v102, v102
    v_exp_f32 v103, v103
    v_cvt_pk_bf16_f32 v52, v96, v97
    v_cvt_pk_bf16_f32 v53, v98, v99
    v_cvt_pk_bf16_f32 v54, v100, v101
    v_cvt_pk_bf16_f32 v55, v102, v103
    v_exp_f32 v104, v104
    v_exp_f32 v105, v105
    v_mfma_f32_32x32x16_bf16 v[56:71], v[44:47], v[52:55], v[56:71]
    v_exp_f32 v106, v106
    v_exp_f32 v107, v107
    v_exp_f32 v108, v108
    v_exp_f32 v109, v109
    v_exp_f32 v110, v110
    v_exp_f32 v111, v111
    v_cvt_pk_bf16_f32 v48, v104, v105
    v_cvt_pk_bf16_f32 v49, v106, v107
    v_cvt_pk_bf16_f32 v50, v108, v109
    v_cvt_pk_bf16_f32 v51, v110, v111
    v_exp_f32 v112, v112
    v_exp_f32 v113, v113
    v_exp_f32 v114, v114
    v_exp_f32 v115, v115
    v_mfma_f32_32x32x16_bf16 v[72:87], v[40:43], v[48:51], v[72:87]
    v_exp_f32 v116, v116
    v_exp_f32 v117, v117
    v_exp_f32 v118, v118
    v_exp_f32 v119, v119
    v_cvt_pk_bf16_f32 v52, v112, v113
    v_cvt_pk_bf16_f32 v53, v114, v115
    v_cvt_pk_bf16_f32 v54, v116, v117
    v_cvt_pk_bf16_f32 v55, v118, v119
at_done:
    s_setprio 3
    s_nop 1
    v_mfma_f32_32x32x16_bf16 v[72:87], v[44:47], v[52:55], v[72:87]
    s_waitcnt lgkmcnt(0)
    s_nop 7
    s_nop 3
    s_and_b32 s24, s12, 3
    s_mul_i32 s24, s24, 6144
    s_mul_i32 s25, s34, 3072
    s_add_u32 s26, s24, s25
    s_xor_b32 s25, s34, 1
    s_mul_i32 s25, s25, 3072
    s_add_u32 s27, s24, s25
    v_add_u32 v120, s26, v2
    v_add_u32 v121, s27, v2
    s_cmp_eq_u32 s34, 1
    s_cbranch_scc1 at_x1
    ds_write_b128 v120, v[72:75] offset:0
    ds_write_b128 v120, v[76:79] offset:1024
    ds_write_b128 v120, v[80:83] offset:2048
    s_branch at_x2
at_x1:
    ds_write_b128 v120, v[56:59] offset:0
    ds_write_b128 v120, v[60:63] offset:1024
    ds_write_b128 v120, v[64:67] offset:2048
    s_waitcnt lgkmcnt(0)
    v_mov_b32 v56, v72
    v_mov_b32 v57, v73
    v_mov_b32 v58, v74
    v_mov_b32 v59, v75
    v_mov_b32 v60, v76
    v_mov_b32 v61, v77
    v_mov_b32 v62, v78
    v_mov_b32 v63, v79
    v_mov_b32 v64, v80
    v_mov_b32 v65, v81
    v_mov_b32 v66, v82
    v_mov_b32 v67, v83
    v_mov_b32 v8, v12
    v_mov_b32 v9, v13
    v_mov_b32 v10, v14
    v_mov_b32 v11, v15
    v_mov_b32 v16, v18
    v_mov_b32 v17, v19
    s_add_u32 s14, s14, 1
    v_mov_b32 v126, v127
at_x2:
    s_waitcnt lgkmcnt(0)
    s_barrier
    ds_read_b128 v[88:91], v121 offset:0
    ds_read_b128 v[92:95], v121 offset:1024
    ds_read_b128 v[96:99], v121 offset:2048
    s_waitcnt lgkmcnt(0)
    v_add_f32 v56, v56, v88
    v_add_f32 v57, v57, v89
    v_add_f32 v58, v58, v90
    v_add_f32 v59, v59, v91
    v_add_f32 v60, v60, v92
    v_add_f32 v61, v61, v93
    v_add_f32 v62, v62, v94
    v_add_f32 v63, v63, v95
    v_add_f32 v64, v64, v96
    v_add_f32 v65, v65, v97
    v_add_f32 v66, v66, v98
    v_add_f32 v67, v67, v99
    v_mov_b32 v120, v64
    v_mov_b32 v121, v64
    s_nop 1
    v_permlane32_swap_b32 v120, v121
    s_nop 1
    v_mov_b32 v122, 0
    v_fma_f32 v122, v56, 0, v122
    v_fma_f32 v122, v57, 0, v122
    v_fma_f32 v122, v58, 0, v122
    v_fma_f32 v122, v59, 0, v122
    v_fma_f32 v122, v60, 0, v122
    v_fma_f32 v122, v61, 0, v122
    v_fma_f32 v122, v62, 0, v122
    v_fma_f32 v122, v63, 0, v122
    v_fma_f32 v122, v64, 0, v122
    v_fma_f32 v122, v65, 0, v122
    v_fma_f32 v122, v66, 0, v122
    v_fma_f32 v122, v67, 0, v122
    v_mov_b32 v123, 0x21800000
    v_mov_b32 v124, 0x5d800000
    v_cmp_nge_f32 s[24:25], v121, v123
    v_cmp_nle_f32 s[26:27], v121, v124
    v_cmp_u_f32 vcc, v122, v122
    s_or_b64 s[24:25], s[24:25], s[26:27]
    s_or_b64 s[24:25], s[24:25], vcc
    s_cbranch_scc1 at_slow
at_fin:
    v_rcp_f32 v122, v121
    s_nop 0
    v_mul_f32 v122, v122, v126
    v_mul_f32 v56, v56, v122
    v_mul_f32 v57, v57, v122
    v_mul_f32 v58, v58, v122
    v_mul_f32 v59, v59, v122
    v_mul_f32 v60, v60, v122
    v_mul_f32 v61, v61, v122
    v_mul_f32 v62, v62, v122
    v_mul_f32 v63, v63, v122
    v_mul_f32 v64, v64, v122
    v_mul_f32 v65, v65, v122
    v_mul_f32 v66, v66, v122
    v_mul_f32 v67, v67, v122
    v_cvt_pk_bf16_f32 v48, v56, v57
    v_cvt_pk_bf16_f32 v49, v58, v59
    v_cvt_pk_bf16_f32 v50, v60, v61
    v_cvt_pk_bf16_f32 v51, v62, v63
    v_cvt_pk_bf16_f32 v52, v64, v65
    v_cvt_pk_bf16_f32 v53, v66, v67
    s_lshl_b32 s24, s14, 5
    s_add_u32 s24, s24, s13
    s_lshl_b32 s25, s24, 10
    s_add_u32 s25, s25, 7864320
    s_lshl_b32 s27, s24, 8
    s_add_u32 s27, s27, 9961472
    v_lshrrev_b32 v125, 1, v2
    buffer_store_dwordx4 v[48:51], v2, s[8:11], s25 offen sc1
    s_mov_b64 exec, s[22:23]
    buffer_store_dwordx2 v[52:53], v125, s[8:11], s27 offen sc1
    s_waitcnt vmcnt(0)
    s_lshl_b32 s26, s14, 5
    s_add_u32 s26, s26, s13
    s_lshl_b32 s26, s26, 7
    s_add_u32 s26, s26, 34734080
    v_mov_b32 v120, 0
    v_mov_b32 v121, s95
    s_mov_b64 exec, 1
    buffer_store_dword v121, v120, s[8:11], s26 offen sc1
    s_endpgm
at_slow:
    v_mov_b32 v56, 0
    v_mov_b32 v57, 0
    v_mov_b32 v58, 0
    v_mov_b32 v59, 0
    v_mov_b32 v60, 0
    v_mov_b32 v61, 0
    v_mov_b32 v62, 0
    v_mov_b32 v63, 0
    v_mov_b32 v64, 0
    v_mov_b32 v65, 0
    v_mov_b32 v66, 0
    v_mov_b32 v67, 0
    v_mov_b32 v68, 0
    v_mov_b32 v69, 0
    v_mov_b32 v70, 0
    v_mov_b32 v71, 0
    v_mov_b32 v104, 0xff800000
    s_mul_i32 s27, s13, 81920
    s_add_u32 s28, s27, 2621440
    s_add_u32 s29, s27, 5242880
    v_and_b32 v108, 31, v0
    v_lshrrev_b32 v109, 5, v0
    v_mul_u32_u24 v109, 320, v109
    v_lshl_add_u32 v109, v108, 4, v109
    v_lshlrev_b32 v108, 3, v108
    s_mov_b32 s17, 0
at_sl:
    buffer_load_dwordx4 v[20:23], v2, s[8:11], s28 offen sc1
    buffer_load_dwordx2 v[24:25], v108, s[8:11], s28 offen offset:1024 sc1
    s_mov_b64 exec, s[20:21]
    buffer_load_dwordx4 v[32:35], v109, s[8:11], s29 offen sc1
    buffer_load_dwordx4 v[36:39], v109, s[8:11], s29 offen offset:640 sc1
    s_mov_b64 exec, -1
    s_waitcnt vmcnt(0)
    v_mfma_f32_32x32x16_bf16 v[88:103], v[20:23], v[8:11], 0
    v_mfma_f32_32x32x8_bf16 v[88:103], v[24:25], v[16:17], v[88:103]
    s_nop 7
    s_nop 7
    v_max3_f32 v106, v88, v89, v90
    v_max3_f32 v106, v106, v91, v92
    v_max3_f32 v106, v106, v93, v94
    v_max3_f32 v106, v106, v95, v96
    v_max3_f32 v106, v106, v97, v98
    v_max3_f32 v106, v106, v99, v100
    v_max3_f32 v106, v106, v101, v102
    v_max_f32 v106, v106, v103
    v_mov_b32 v107, v106
    s_nop 1
    v_permlane32_swap_b32 v106, v107
    s_nop 1
    v_max3_f32 v106, v106, v107, v104
    v_sub_f32 v105, v104, v106
    v_exp_f32 v105, v105
    v_mov_b32 v104, v106
    v_sub_f32 v88, v88, v106
    v_sub_f32 v89, v89, v106
    v_sub_f32 v90, v90, v106
    v_sub_f32 v91, v91, v106
    v_sub_f32 v92, v92, v106
    v_sub_f32 v93, v93, v106
    v_sub_f32 v94, v94, v106
    v_sub_f32 v95, v95, v106
    v_sub_f32 v96, v96, v106
    v_sub_f32 v97, v97, v106
    v_sub_f32 v98, v98, v106
    v_sub_f32 v99, v99, v106
    v_sub_f32 v100, v100, v106
    v_sub_f32 v101, v101, v106
    v_sub_f32 v102, v102, v106
    v_sub_f32 v103, v103, v106
    v_mul_f32 v56, v56, v105
    v_mul_f32 v57, v57, v105
    v_mul_f32 v58, v58, v105
    v_mul_f32 v59, v59, v105
    v_mul_f32 v60, v60, v105
    v_mul_f32 v61, v61, v105
    v_mul_f32 v62, v62, v105
    v_mul_f32 v63, v63, v105
    v_mul_f32 v64, v64, v105
    v_mul_f32 v65, v65, v105
    v_mul_f32 v66, v66, v105
    v_mul_f32 v67, v67, v105
    v_mul_f32 v68, v68, v105
    v_mul_f32 v69, v69, v105
    v_mul_f32 v70, v70, v105
    v_mul_f32 v71, v71, v105
    v_exp_f32 v88, v88
    v_exp_f32 v89, v89
    v_exp_f32 v90, v90
    v_exp_f32 v91, v91
    v_exp_f32 v92, v92
    v_exp_f32 v93, v93
    v_exp_f32 v94, v94
    v_exp_f32 v95, v95
    v_exp_f32 v96, v96
    v_exp_f32 v97, v97
    v_exp_f32 v98, v98
    v_exp_f32 v99, v99
    v_exp_f32 v100, v100
    v_exp_f32 v101, v101
    v_exp_f32 v102, v102
    v_exp_f32 v103, v103
    s_nop 0
    v_cvt_pk_bf16_f32 v48, v88, v89
    v_cvt_pk_bf16_f32 v49, v90, v91
    v_cvt_pk_bf16_f32 v50, v92, v93
    v_cvt_pk_bf16_f32 v51, v94, v95
    v_cvt_pk_bf16_f32 v52, v96, v97
    v_cvt_pk_bf16_f32 v53, v98, v99
    v_cvt_pk_bf16_f32 v54, v100, v101
    v_cvt_pk_bf16_f32 v55, v102, v103
    s_nop 3
    v_mfma_f32_32x32x16_bf16 v[56:71], v[32:35], v[48:51], v[56:71]
    v_mfma_f32_32x32x16_bf16 v[56:71], v[36:39], v[52:55], v[56:71]
    s_nop 7
    s_nop 7
    s_add_u32 s28, s28, 1280
    s_add_u32 s29, s29, 1280
    s_add_u32 s17, s17, 1
    s_cmp_lt_u32 s17, 64
    s_cbranch_scc1 at_sl
    v_mov_b32 v120, v64
    v_mov_b32 v121, v64
    s_nop 1
    v_permlane32_swap_b32 v120, v121
    s_nop 1
    s_branch at_fin
fz_F:
    s_load_dwordx2 s[4:5], s[0:1], 0
    s_load_dwordx2 s[6:7], s[0:1], 32
    s_load_dwordx2 s[50:51], s[0:1], 88
    s_load_dwordx2 s[54:55], s[0:1], 40
    s_sub_u32 s35, s2, 256
    s_and_b32 s24, s35, 7
    s_lshr_b32 s25, s35, 3
    s_and_b32 s26, s24, 3
    s_lshl_b32 s26, s26, 2
    s_and_b32 s27, s25, 3
    s_add_u32 s41, s26, s27
    s_lshr_b32 s26, s24, 2
    s_lshl_b32 s26, s26, 3
    s_lshr_b32 s27, s25, 2
    s_add_u32 s40, s26, s27
    s_mul_i32 s24, s41, 3
    s_add_u32 s24, s24, s40
    s_mul_i32 s25, s24, 6554
    s_lshr_b32 s25, s25, 16
    s_mul_i32 s25, s25, 10
    s_sub_u32 s48, s24, s25
    s_mul_i32 s21, s41, 163840
    s_mul_i32 s22, s40, 192
    s_waitcnt lgkmcnt(0)
    s_mov_b32 s8, s4
    s_and_b32 s9, s5, 0xffff
    s_mov_b32 s10, 2621440
    s_mov_b32 s11, 0x20000
    s_mov_b32 s12, s6
    s_and_b32 s13, s7, 0xffff
    s_mov_b32 s14, 1966080
    s_mov_b32 s15, 0x20000
    s_mov_b32 s16, s50
    s_and_b32 s17, s51, 0xffff
    s_mov_b32 s18, 50331648
    s_mov_b32 s19, 0x20000
    s_load_dwordx2 s[70:71], s[0:1], 72
    s_load_dwordx2 s[72:73], s[0:1], 48
    s_load_dwordx2 s[74:75], s[0:1], 16
    s_cmp_lg_u32 s20, 1
    s_cbranch_scc1 f1_nt
    v_lshlrev_b32 v32, 21, v0
    v_cmp_gt_u32 vcc, 18, v0
    s_and_saveexec_b64 s[76:77], vcc
    buffer_load_dword v33, v32, s[16:19], 0 offen
    s_mov_b64 exec, s[76:77]
    s_waitcnt lgkmcnt(0)
    v_lshlrev_b32 v32, 20, v0
    s_mov_b64 exec, 7
    global_load_dword v34, v32, s[70:71]
    s_mov_b64 exec, 3
    global_load_dword v35, v32, s[72:73]
    s_mov_b64 exec, 1
    global_load_dword v36, v32, s[74:75]
    s_mov_b64 exec, -1
f1_nt:
    s_cmp_lg_u32 s20, 0
    s_cbranch_scc1 f1_w1
    s_load_dwordx2 s[90:91], s[0:1], 80
    v_mov_b32 v30, 0
    s_mov_b32 s89, 0x40000
    s_waitcnt lgkmcnt(0)
f1w_nl:
    global_load_dword v31, v30, s[90:91] sc1
    s_waitcnt vmcnt(0)
    v_readfirstlane_b32 s95, v31
    s_cmp_lg_u32 s95, 0
    s_cbranch_scc1 f1w_nd
    s_sleep 8
    s_sub_u32 s89, s89, 1
    s_cmp_lg_u32 s89, 0
    s_cbranch_scc1 f1w_nl
f1w_nd:
f1_w1:
    s_barrier
    s_load_dwordx2 s[90:91], s[0:1], 80
    v_mov_b32 v30, 0
    s_mov_b32 s89, 0x40000
    s_waitcnt lgkmcnt(0)
f1w2_nl:
    global_load_dword v31, v30, s[90:91] sc1
    s_waitcnt vmcnt(0)
    v_readfirstlane_b32 s95, v31
    s_cmp_lg_u32 s95, 0
    s_cbranch_scc1 f1w2_nd
    s_sleep 1
    s_sub_u32 s89, s89, 1
    s_cmp_lg_u32 s89, 0
    s_cbranch_scc1 f1w2_nl
f1w2_nd:
    s_cmp_ge_u32 s20, 4
    s_cbranch_scc0 f1_c
    s_setprio 1
    s_sub_u32 s24, s20, 4
    v_lshrrev_b32 v20, 3, v0
    v_and_b32 v21, 7, v0
    s_lshl_b32 s25, s24, 5
    v_add_u32 v22, s25, v20
    v_bfe_u32 v23, v22, 1, 3
    v_xor_b32 v23, v23, v21
    v_lshlrev_b32 v23, 4, v23
    v_mul_u32_u24 v22, 1280, v22
    v_add_u32 v2, v22, v23
    v_add_u32 v22, s25, v20
    v_add_u32 v22, 8, v22
    v_bfe_u32 v23, v22, 1, 3
    v_xor_b32 v23, v23, v21
    v_lshlrev_b32 v23, 4, v23
    v_mul_u32_u24 v22, 1280, v22
    v_add_u32 v3, v22, v23
    v_subrev_u32 v3, 1024, v3
    v_add_u32 v22, s25, v20
    v_add_u32 v22, 16, v22
    v_bfe_u32 v23, v22, 1, 3
    v_xor_b32 v23, v23, v21
    v_lshlrev_b32 v23, 4, v23
    v_mul_u32_u24 v22, 1280, v22
    v_add_u32 v4, v22, v23
    v_subrev_u32 v4, 2048, v4
    v_add_u32 v22, s25, v20
    v_add_u32 v22, 24, v22
    v_bfe_u32 v23, v22, 1, 3
    v_xor_b32 v23, v23, v21
    v_lshlrev_b32 v23, 4, v23
    v_mul_u32_u24 v22, 1280, v22
    v_add_u32 v5, v22, v23
    v_subrev_u32 v5, 3072, v5
    s_mul_i32 s25, s24, 96
    v_add_u32 v22, s25, v0
    v_mul_u32_u24 v23, 5462, v22
    v_lshrrev_b32 v23, 16, v23
    v_mul_u32_u24 v20, 12, v23
    v_sub_u32 v22, v22, v20
    v_lshlrev_b32 v22, 4, v22
    v_mul_u32_u24 v23, 3072, v23
    v_add_u32 v6, v22, v23
    v_add_u32 v22, s25, v0
    v_add_u32 v22, 64, v22
    v_mul_u32_u24 v23, 5462, v22
    v_lshrrev_b32 v23, 16, v23
    v_mul_u32_u24 v20, 12, v23
    v_sub_u32 v22, v22, v20
    v_lshlrev_b32 v22, 4, v22
    v_mul_u32_u24 v23, 3072, v23
    v_add_u32 v7, v22, v23
    v_subrev_u32 v7, 1024, v7
    s_lshl_b32 s26, s24, 12
    s_mul_i32 s27, s24, 1536
    s_add_u32 s27, s27, 49152
    s_mov_b32 s30, -1
    s_mov_b32 s31, 0
    s_add_u32 s32, s48, 0
    s_cmp_ge_u32 s32, 10
    s_cselect_b32 s33, 10, 0
    s_sub_u32 s32, s32, s33
    s_lshl_b32 s64, s32, 7
    s_add_u32 s64, s64, s21
    s_add_u32 s65, s26, 0
    s_mov_b32 m0, s65
    s_nop 0
    buffer_load_dwordx4 v2, s[8:11], s64 offen offset:0 lds
    buffer_load_dwordx4 v3, s[8:11], s64 offen offset:1024 lds
    buffer_load_dwordx4 v4, s[8:11], s64 offen offset:2048 lds
    buffer_load_dwordx4 v5, s[8:11], s64 offen offset:3072 lds
    s_add_u32 s32, s48, 0
    s_cmp_ge_u32 s32, 10
    s_cselect_b32 s33, 10, 0
    s_sub_u32 s32, s32, s33
    s_lshl_b32 s32, s32, 1
    s_mul_i32 s66, s32, 98304
    s_add_u32 s66, s66, s22
    s_add_u32 s67, s27, 0
    s_mov_b32 m0, s67
    s_nop 0
    buffer_load_dwordx4 v6, s[12:15], s66 offen lds
    s_mov_b64 exec, s[30:31]
    buffer_load_dwordx4 v7, s[12:15], s66 offen offset:1024 lds
    s_mov_b64 exec, -1
    s_add_u32 s32, s48, 0
    s_cmp_ge_u32 s32, 10
    s_cselect_b32 s33, 10, 0
    s_sub_u32 s32, s32, s33
    s_lshl_b32 s32, s32, 1
    s_add_u32 s32, s32, 1
    s_mul_i32 s68, s32, 98304
    s_add_u32 s68, s68, s22
    s_add_u32 s69, s27, 6144
    s_mov_b32 m0, s69
    s_nop 0
    buffer_load_dwordx4 v6, s[12:15], s68 offen lds
    s_mov_b64 exec, s[30:31]
    buffer_load_dwordx4 v7, s[12:15], s68 offen offset:1024 lds
    s_mov_b64 exec, -1
    s_add_u32 s32, s48, 1
    s_cmp_ge_u32 s32, 10
    s_cselect_b32 s33, 10, 0
    s_sub_u32 s32, s32, s33
    s_lshl_b32 s64, s32, 7
    s_add_u32 s64, s64, s21
    s_add_u32 s65, s26, 16384
    s_mov_b32 m0, s65
    s_nop 0
    buffer_load_dwordx4 v2, s[8:11], s64 offen offset:0 lds
    buffer_load_dwordx4 v3, s[8:11], s64 offen offset:1024 lds
    buffer_load_dwordx4 v4, s[8:11], s64 offen offset:2048 lds
    buffer_load_dwordx4 v5, s[8:11], s64 offen offset:3072 lds
    s_add_u32 s32, s48, 1
    s_cmp_ge_u32 s32, 10
    s_cselect_b32 s33, 10, 0
    s_sub_u32 s32, s32, s33
    s_lshl_b32 s32, s32, 1
    s_mul_i32 s66, s32, 98304
    s_add_u32 s66, s66, s22
    s_add_u32 s67, s27, 12288
    s_mov_b32 m0, s67
    s_nop 0
    buffer_load_dwordx4 v6, s[12:15], s66 offen lds
    s_mov_b64 exec, s[30:31]
    buffer_load_dwordx4 v7, s[12:15], s66 offen offset:1024 lds
    s_mov_b64 exec, -1
    s_add_u32 s32, s48, 2
    s_cmp_ge_u32 s32, 10
    s_cselect_b32 s33, 10, 0
    s_sub_u32 s32, s32, s33
    s_lshl_b32 s68, s32, 7
    s_add_u32 s68, s68, s21
    s_add_u32 s69, s26, 32768
    s_add_u32 s32, s48, 1
    s_cmp_ge_u32 s32, 10
    s_cselect_b32 s33, 10, 0
    s_sub_u32 s32, s32, s33
    s_lshl_b32 s32, s32, 1
    s_add_u32 s32, s32, 1
    s_mul_i32 s64, s32, 98304
    s_add_u32 s64, s64, s22
    s_add_u32 s65, s27, 18432
    s_waitcnt vmcnt(8)
    s_barrier
    s_mov_b32 m0, s69
    s_nop 0
    buffer_load_dwordx4 v2, s[8:11], s68 offen offset:0 lds
    buffer_load_dwordx4 v3, s[8:11], s68 offen offset:1024 lds
    buffer_load_dwordx4 v4, s[8:11], s68 offen offset:2048 lds
    buffer_load_dwordx4 v5, s[8:11], s68 offen offset:3072 lds
    s_mov_b32 m0, s65
    s_nop 0
    buffer_load_dwordx4 v6, s[12:15], s64 offen lds
    s_mov_b64 exec, s[30:31]
    buffer_load_dwordx4 v7, s[12:15], s64 offen offset:1024 lds
    s_mov_b64 exec, -1
    s_add_u32 s32, s48, 2
    s_cmp_ge_u32 s32, 10
    s_cselect_b32 s33, 10, 0
    s_sub_u32 s32, s32, s33
    s_lshl_b32 s32, s32, 1
    s_mul_i32 s66, s32, 98304
    s_add_u32 s66, s66, s22
    s_add_u32 s67, s27, 24576
    s_waitcnt vmcnt(12)
    s_barrier
    s_mov_b32 m0, s67
    s_nop 0
    buffer_load_dwordx4 v6, s[12:15], s66 offen lds
    s_mov_b64 exec, s[30:31]
    buffer_load_dwordx4 v7, s[12:15], s66 offen offset:1024 lds
    s_mov_b64 exec, -1
    s_add_u32 s32, s48, 2
    s_cmp_ge_u32 s32, 10
    s_cselect_b32 s33, 10, 0
    s_sub_u32 s32, s32, s33
    s_lshl_b32 s32, s32, 1
    s_add_u32 s32, s32, 1
    s_mul_i32 s68, s32, 98304
    s_add_u32 s68, s68, s22
    s_add_u32 s69, s27, 0
    s_waitcnt vmcnt(8)
    s_barrier
    s_mov_b32 m0, s69
    s_nop 0
    buffer_load_dwordx4 v6, s[12:15], s68 offen lds
    s_mov_b64 exec, s[30:31]
    buffer_load_dwordx4 v7, s[12:15], s68 offen offset:1024 lds
    s_mov_b64 exec, -1
    s_add_u32 s32, s48, 3
    s_cmp_ge_u32 s32, 10
    s_cselect_b32 s33, 10, 0
    s_sub_u32 s32, s32, s33
    s_lshl_b32 s64, s32, 7
    s_add_u32 s64, s64, s21
    s_add_u32 s65, s26, 0
    s_add_u32 s32, s48, 3
    s_cmp_ge_u32 s32, 10
    s_cselect_b32 s33, 10, 0
    s_sub_u32 s32, s32, s33
    s_lshl_b32 s32, s32, 1
    s_mul_i32 s66, s32, 98304
    s_add_u32 s66, s66, s22
    s_add_u32 s67, s27, 6144
    s_waitcnt vmcnt(4)
    s_barrier
    s_mov_b32 m0, s65
    s_nop 0
    buffer_load_dwordx4 v2, s[8:11], s64 offen offset:0 lds
    buffer_load_dwordx4 v3, s[8:11], s64 offen offset:1024 lds
    buffer_load_dwordx4 v4, s[8:11], s64 offen offset:2048 lds
    buffer_load_dwordx4 v5, s[8:11], s64 offen offset:3072 lds
    s_mov_b32 m0, s67
    s_nop 0
    buffer_load_dwordx4 v6, s[12:15], s66 offen lds
    s_mov_b64 exec, s[30:31]
    buffer_load_dwordx4 v7, s[12:15], s66 offen offset:1024 lds
    s_mov_b64 exec, -1
    s_add_u32 s32, s48, 3
    s_cmp_ge_u32 s32, 10
    s_cselect_b32 s33, 10, 0
    s_sub_u32 s32, s32, s33
    s_lshl_b32 s32, s32, 1
    s_add_u32 s32, s32, 1
    s_mul_i32 s68, s32, 98304
    s_add_u32 s68, s68, s22
    s_add_u32 s69, s27, 12288
    s_waitcnt vmcnt(8)
    s_barrier
    s_mov_b32 m0, s69
    s_nop 0
    buffer_load_dwordx4 v6, s[12:15], s68 offen lds
    s_mov_b64 exec, s[30:31]
    buffer_load_dwordx4 v7, s[12:15], s68 offen offset:1024 lds
    s_mov_b64 exec, -1
    s_add_u32 s32, s48, 4
    s_cmp_ge_u32 s32, 10
    s_cselect_b32 s33, 10, 0
    s_sub_u32 s32, s32, s33
    s_lshl_b32 s64, s32, 7
    s_add_u32 s64, s64, s21
    s_add_u32 s65, s26, 16384
    s_add_u32 s32, s48, 4
    s_cmp_ge_u32 s32, 10
    s_cselect_b32 s33, 10, 0
    s_sub_u32 s32, s32, s33
    s_lshl_b32 s32, s32, 1
    s_mul_i32 s66, s32, 98304
    s_add_u32 s66, s66, s22
    s_add_u32 s67, s27, 18432
    s_waitcnt vmcnt(8)
    s_barrier
    s_mov_b32 m0, s65
    s_nop 0
    buffer_load_dwordx4 v2, s[8:11], s64 offen offset:0 lds
    buffer_load_dwordx4 v3, s[8:11], s64 offen offset:1024 lds
    buffer_load_dwordx4 v4, s[8:11], s64 offen offset:2048 lds
    buffer_load_dwordx4 v5, s[8:11], s64 offen offset:3072 lds
    s_mov_b32 m0, s67
    s_nop 0
    buffer_load_dwordx4 v6, s[12:15], s66 offen lds
    s_mov_b64 exec, s[30:31]
    buffer_load_dwordx4 v7, s[12:15], s66 offen offset:1024 lds
    s_mov_b64 exec, -1
    s_add_u32 s32, s48, 4
    s_cmp_ge_u32 s32, 10
    s_cselect_b32 s33, 10, 0
    s_sub_u32 s32, s32, s33
    s_lshl_b32 s32, s32, 1
    s_add_u32 s32, s32, 1
    s_mul_i32 s68, s32, 98304
    s_add_u32 s68, s68, s22
    s_add_u32 s69, s27, 24576
    s_waitcnt vmcnt(8)
    s_barrier
    s_mov_b32 m0, s69
    s_nop 0
    buffer_load_dwordx4 v6, s[12:15], s68 offen lds
    s_mov_b64 exec, s[30:31]
    buffer_load_dwordx4 v7, s[12:15], s68 offen offset:1024 lds
    s_mov_b64 exec, -1
    s_add_u32 s32, s48, 5
    s_cmp_ge_u32 s32, 10
    s_cselect_b32 s33, 10, 0
    s_sub_u32 s32, s32, s33
    s_lshl_b32 s64, s32, 7
    s_add_u32 s64, s64, s21
    s_add_u32 s65, s26, 32768
    s_add_u32 s32, s48, 5
    s_cmp_ge_u32 s32, 10
    s_cselect_b32 s33, 10, 0
    s_sub_u32 s32, s32, s33
    s_lshl_b32 s32, s32, 1
    s_mul_i32 s66, s32, 98304
    s_add_u32 s66, s66, s22
    s_add_u32 s67, s27, 0
    s_waitcnt vmcnt(8)
    s_barrier
    s_mov_b32 m0, s65
    s_nop 0
    buffer_load_dwordx4 v2, s[8:11], s64 offen offset:0 lds
    buffer_load_dwordx4 v3, s[8:11], s64 offen offset:1024 lds
    buffer_load_dwordx4 v4, s[8:11], s64 offen offset:2048 lds
    buffer_load_dwordx4 v5, s[8:11], s64 offen offset:3072 lds
    s_mov_b32 m0, s67
    s_nop 0
    buffer_load_dwordx4 v6, s[12:15], s66 offen lds
    s_mov_b64 exec, s[30:31]
    buffer_load_dwordx4 v7, s[12:15], s66 offen offset:1024 lds
    s_mov_b64 exec, -1
    s_add_u32 s32, s48, 5
    s_cmp_ge_u32 s32, 10
    s_cselect_b32 s33, 10, 0
    s_sub_u32 s32, s32, s33
    s_lshl_b32 s32, s32, 1
    s_add_u32 s32, s32, 1
    s_mul_i32 s68, s32, 98304
    s_add_u32 s68, s68, s22
    s_add_u32 s69, s27, 6144
    s_waitcnt vmcnt(8)
    s_barrier
    s_mov_b32 m0, s69
    s_nop 0
    buffer_load_dwordx4 v6, s[12:15], s68 offen lds
    s_mov_b64 exec, s[30:31]
    buffer_load_dwordx4 v7, s[12:15], s68 offen offset:1024 lds
    s_mov_b64 exec, -1
    s_add_u32 s32, s48, 6
    s_cmp_ge_u32 s32, 10
    s_cselect_b32 s33, 10, 0
    s_sub_u32 s32, s32, s33
    s_lshl_b32 s64, s32, 7
    s_add_u32 s64, s64, s21
    s_add_u32 s65, s26, 0
    s_add_u32 s32, s48, 6
    s_cmp_ge_u32 s32, 10
    s_cselect_b32 s33, 10, 0
    s_sub_u32 s32, s32, s33
    s_lshl_b32 s32, s32, 1
    s_mul_i32 s66, s32, 98304
    s_add_u32 s66, s66, s22
    s_add_u32 s67, s27, 12288
    s_waitcnt vmcnt(8)
    s_barrier
    s_mov_b32 m0, s65
    s_nop 0
    buffer_load_dwordx4 v2, s[8:11], s64 offen offset:0 lds
    buffer_load_dwordx4 v3, s[8:11], s64 offen offset:1024 lds
    buffer_load_dwordx4 v4, s[8:11], s64 offen offset:2048 lds
    buffer_load_dwordx4 v5, s[8:11], s64 offen offset:3072 lds
    s_mov_b32 m0, s67
    s_nop 0
    buffer_load_dwordx4 v6, s[12:15], s66 offen lds
    s_mov_b64 exec, s[30:31]
    buffer_load_dwordx4 v7, s[12:15], s66 offen offset:1024 lds
    s_mov_b64 exec, -1
    s_add_u32 s32, s48, 6
    s_cmp_ge_u32 s32, 10
    s_cselect_b32 s33, 10, 0
    s_sub_u32 s32, s32, s33
    s_lshl_b32 s32, s32, 1
    s_add_u32 s32, s32, 1
    s_mul_i32 s68, s32, 98304
    s_add_u32 s68, s68, s22
    s_add_u32 s69, s27, 18432
    s_waitcnt vmcnt(8)
    s_barrier
    s_mov_b32 m0, s69
    s_nop 0
    buffer_load_dwordx4 v6, s[12:15], s68 offen lds
    s_mov_b64 exec, s[30:31]
    buffer_load_dwordx4 v7, s[12:15], s68 offen offset:1024 lds
    s_mov_b64 exec, -1
    s_add_u32 s32, s48, 7
    s_cmp_ge_u32 s32, 10
    s_cselect_b32 s33, 10, 0
    s_sub_u32 s32, s32, s33
    s_lshl_b32 s64, s32, 7
    s_add_u32 s64, s64, s21
    s_add_u32 s65, s26, 16384
    s_add_u32 s32, s48, 7
    s_cmp_ge_u32 s32, 10
    s_cselect_b32 s33, 10, 0
    s_sub_u32 s32, s32, s33
    s_lshl_b32 s32, s32, 1
    s_mul_i32 s66, s32, 98304
    s_add_u32 s66, s66, s22
    s_add_u32 s67, s27, 24576
    s_waitcnt vmcnt(8)
    s_barrier
    s_mov_b32 m0, s65
    s_nop 0
    buffer_load_dwordx4 v2, s[8:11], s64 offen offset:0 lds
    buffer_load_dwordx4 v3, s[8:11], s64 offen offset:1024 lds
    buffer_load_dwordx4 v4, s[8:11], s64 offen offset:2048 lds
    buffer_load_dwordx4 v5, s[8:11], s64 offen offset:3072 lds
    s_mov_b32 m0, s67
    s_nop 0
    buffer_load_dwordx4 v6, s[12:15], s66 offen lds
    s_mov_b64 exec, s[30:31]
    buffer_load_dwordx4 v7, s[12:15], s66 offen offset:1024 lds
    s_mov_b64 exec, -1
    s_add_u32 s32, s48, 7
    s_cmp_ge_u32 s32, 10
    s_cselect_b32 s33, 10, 0
    s_sub_u32 s32, s32, s33
    s_lshl_b32 s32, s32, 1
    s_add_u32 s32, s32, 1
    s_mul_i32 s68, s32, 98304
    s_add_u32 s68, s68, s22
    s_add_u32 s69, s27, 0
    s_waitcnt vmcnt(8)
    s_barrier
    s_mov_b32 m0, s69
    s_nop 0
    buffer_load_dwordx4 v6, s[12:15], s68 offen lds
    s_mov_b64 exec, s[30:31]
    buffer_load_dwordx4 v7, s[12:15], s68 offen offset:1024 lds
    s_mov_b64 exec, -1
    s_add_u32 s32, s48, 8
    s_cmp_ge_u32 s32, 10
    s_cselect_b32 s33, 10, 0
    s_sub_u32 s32, s32, s33
    s_lshl_b32 s64, s32, 7
    s_add_u32 s64, s64, s21
    s_add_u32 s65, s26, 32768
    s_add_u32 s32, s48, 8
    s_cmp_ge_u32 s32, 10
    s_cselect_b32 s33, 10, 0
    s_sub_u32 s32, s32, s33
    s_lshl_b32 s32, s32, 1
    s_mul_i32 s66, s32, 98304
    s_add_u32 s66, s66, s22
    s_add_u32 s67, s27, 6144
    s_waitcnt vmcnt(8)
    s_barrier
    s_mov_b32 m0, s65
    s_nop 0
    buffer_load_dwordx4 v2, s[8:11], s64 offen offset:0 lds
    buffer_load_dwordx4 v3, s[8:11], s64 offen offset:1024 lds
    buffer_load_dwordx4 v4, s[8:11], s64 offen offset:2048 lds
    buffer_load_dwordx4 v5, s[8:11], s64 offen offset:3072 lds
    s_mov_b32 m0, s67
    s_nop 0
    buffer_load_dwordx4 v6, s[12:15], s66 offen lds
    s_mov_b64 exec, s[30:31]
    buffer_load_dwordx4 v7, s[12:15], s66 offen offset:1024 lds
    s_mov_b64 exec, -1
    s_add_u32 s32, s48, 8
    s_cmp_ge_u32 s32, 10
    s_cselect_b32 s33, 10, 0
    s_sub_u32 s32, s32, s33
    s_lshl_b32 s32, s32, 1
    s_add_u32 s32, s32, 1
    s_mul_i32 s68, s32, 98304
    s_add_u32 s68, s68, s22
    s_add_u32 s69, s27, 12288
    s_waitcnt vmcnt(8)
    s_barrier
    s_mov_b32 m0, s69
    s_nop 0
    buffer_load_dwordx4 v6, s[12:15], s68 offen lds
    s_mov_b64 exec, s[30:31]
    buffer_load_dwordx4 v7, s[12:15], s68 offen offset:1024 lds
    s_mov_b64 exec, -1
    s_add_u32 s32, s48, 9
    s_cmp_ge_u32 s32, 10
    s_cselect_b32 s33, 10, 0
    s_sub_u32 s32, s32, s33
    s_lshl_b32 s64, s32, 7
    s_add_u32 s64, s64, s21
    s_add_u32 s65, s26, 0
    s_add_u32 s32, s48, 9
    s_cmp_ge_u32 s32, 10
    s_cselect_b32 s33, 10, 0
    s_sub_u32 s32, s32, s33
    s_lshl_b32 s32, s32, 1
    s_mul_i32 s66, s32, 98304
    s_add_u32 s66, s66, s22
    s_add_u32 s67, s27, 18432
    s_waitcnt vmcnt(8)
    s_barrier
    s_mov_b32 m0, s65
    s_nop 0
    buffer_load_dwordx4 v2, s[8:11], s64 offen offset:0 lds
    buffer_load_dwordx4 v3, s[8:11], s64 offen offset:1024 lds
    buffer_load_dwordx4 v4, s[8:11], s64 offen offset:2048 lds
    buffer_load_dwordx4 v5, s[8:11], s64 offen offset:3072 lds
    s_mov_b32 m0, s67
    s_nop 0
    buffer_load_dwordx4 v6, s[12:15], s66 offen lds
    s_mov_b64 exec, s[30:31]
    buffer_load_dwordx4 v7, s[12:15], s66 offen offset:1024 lds
    s_mov_b64 exec, -1
    s_add_u32 s32, s48, 9
    s_cmp_ge_u32 s32, 10
    s_cselect_b32 s33, 10, 0
    s_sub_u32 s32, s32, s33
    s_lshl_b32 s32, s32, 1
    s_add_u32 s32, s32, 1
    s_mul_i32 s68, s32, 98304
    s_add_u32 s68, s68, s22
    s_add_u32 s69, s27, 24576
    s_waitcnt vmcnt(8)
    s_barrier
    s_mov_b32 m0, s69
    s_nop 0
    buffer_load_dwordx4 v6, s[12:15], s68 offen lds
    s_mov_b64 exec, s[30:31]
    buffer_load_dwordx4 v7, s[12:15], s68 offen offset:1024 lds
    s_mov_b64 exec, -1
    s_waitcnt vmcnt(8)
    s_barrier
    s_waitcnt vmcnt(2)
    s_barrier
    s_waitcnt vmcnt(0)
    s_barrier
    s_barrier
    s_branch f1_done
f1_c:
    s_setprio 0
    s_lshl_b32 s24, s20, 5
    v_and_b32 v89, 31, v0
    v_lshrrev_b32 v90, 5, v0
    v_bfe_u32 v91, v89, 1, 3
    v_xor_b32 v91, v91, v90
    v_lshlrev_b32 v91, 4, v91
    v_add_u32 v89, s24, v89
    v_lshlrev_b32 v89, 7, v89
    v_add_u32 v89, v89, v91
    v_xor_b32 v2, 0, v89
    v_xor_b32 v3, 32, v89
    v_xor_b32 v4, 64, v89
    v_xor_b32 v5, 96, v89
    v_lshrrev_b32 v89, 4, v0
    v_and_b32 v90, 15, v0
    v_lshrrev_b32 v91, 2, v90
    v_and_b32 v90, 3, v90
    v_lshrrev_b32 v92, 1, v89
    v_and_b32 v89, 1, v89
    v_lshl_add_u32 v92, v92, 3, v91
    v_mul_u32_u24 v92, 192, v92
    v_lshlrev_b32 v89, 5, v89
    v_lshlrev_b32 v90, 3, v90
    v_add3_u32 v6, v92, v89, v90
    v_add_u32 v6, 49152, v6
    v_mov_b32 v40, 0
    v_mov_b32 v41, 0
    v_mov_b32 v42, 0
    v_mov_b32 v43, 0
    v_mov_b32 v44, 0
    v_mov_b32 v45, 0
    v_mov_b32 v46, 0
    v_mov_b32 v47, 0
    v_mov_b32 v48, 0
    v_mov_b32 v49, 0
    v_mov_b32 v50, 0
    v_mov_b32 v51, 0
    v_mov_b32 v52, 0
    v_mov_b32 v53, 0
    v_mov_b32 v54, 0
    v_mov_b32 v55, 0
    v_mov_b32 v56, 0
    v_mov_b32 v57, 0
    v_mov_b32 v58, 0
    v_mov_b32 v59, 0
    v_mov_b32 v60, 0
    v_mov_b32 v61, 0
    v_mov_b32 v62, 0
    v_mov_b32 v63, 0
    v_mov_b32 v64, 0
    v_mov_b32 v65, 0
    v_mov_b32 v66, 0
    v_mov_b32 v67, 0
    v_mov_b32 v68, 0
    v_mov_b32 v69, 0
    v_mov_b32 v70, 0
    v_mov_b32 v71, 0
    v_mov_b32 v72, 0
    v_mov_b32 v73, 0
    v_mov_b32 v74, 0
    v_mov_b32 v75, 0
    v_mov_b32 v76, 0
    v_mov_b32 v77, 0
    v_mov_b32 v78, 0
    v_mov_b32 v79, 0
    v_mov_b32 v80, 0
    v_mov_b32 v81, 0
    v_mov_b32 v82, 0
    v_mov_b32 v83, 0
    v_mov_b32 v84, 0
    v_mov_b32 v85, 0
    v_mov_b32 v86, 0
    v_mov_b32 v87, 0
    s_mov_b32 s28, s54
    s_and_b32 s29, s55, 0xffff
    s_mov_b32 s30, 3072
    s_mov_b32 s31, 0x20000
    v_lshrrev_b32 v88, 5, v0
    v_lshlrev_b32 v88, 3, v88
    buffer_load_dwordx2 v[100:101], v88, s[28:31], s22 offen offset:0
    buffer_load_dwordx2 v[102:103], v88, s[28:31], s22 offen offset:16
    buffer_load_dwordx2 v[104:105], v88, s[28:31], s22 offen offset:32
    buffer_load_dwordx2 v[106:107], v88, s[28:31], s22 offen offset:48
    buffer_load_dwordx2 v[108:109], v88, s[28:31], s22 offen offset:64
    buffer_load_dwordx2 v[110:111], v88, s[28:31], s22 offen offset:80
    buffer_load_dwordx2 v[112:113], v88, s[28:31], s22 offen offset:96
    buffer_load_dwordx2 v[114:115], v88, s[28:31], s22 offen offset:112
    buffer_load_dwordx2 v[116:117], v88, s[28:31], s22 offen offset:128
    buffer_load_dwordx2 v[118:119], v88, s[28:31], s22 offen offset:144
    buffer_load_dwordx2 v[120:121], v88, s[28:31], s22 offen offset:160
    buffer_load_dwordx2 v[122:123], v88, s[28:31], s22 offen offset:176
    s_mov_b32 s38, 0
    s_mov_b32 s39, 0
    s_barrier
    ds_read_b128 v[8:11], v2
    ds_read_b64_tr_b16 v[16:17], v6 offset:0
    ds_read_b64_tr_b16 v[18:19], v6 offset:768
    ds_read_b64_tr_b16 v[20:21], v6 offset:64
    ds_read_b64_tr_b16 v[22:23], v6 offset:832
    ds_read_b64_tr_b16 v[24:25], v6 offset:128
    ds_read_b64_tr_b16 v[26:27], v6 offset:896
    s_mov_b32 s36, 9
f1_ml11:
    s_waitcnt lgkmcnt(0)
    v_mfma_f32_32x32x16_bf16 v[40:55], v[16:19], v[8:11], v[40:55]
    ds_read_b128 v[12:15], v3
    ds_read_b64_tr_b16 v[28:29], v6 offset:3072
    ds_read_b64_tr_b16 v[30:31], v6 offset:3840
    ds_read_b64_tr_b16 v[32:33], v6 offset:3136
    v_mfma_f32_32x32x16_bf16 v[56:71], v[20:23], v[8:11], v[56:71]
    ds_read_b64_tr_b16 v[34:35], v6 offset:3904
    ds_read_b64_tr_b16 v[36:37], v6 offset:3200
    v_mfma_f32_32x32x16_bf16 v[72:87], v[24:27], v[8:11], v[72:87]
    ds_read_b64_tr_b16 v[38:39], v6 offset:3968
    s_add_u32 s38, s38, 6144
    s_cmp_ge_u32 s38, 30720
    s_cselect_b32 s37, 30720, 0
    s_sub_u32 s38, s38, s37
    s_sub_u32 s37, 6144, s37
    v_add_u32 v6, s37, v6
    s_waitcnt lgkmcnt(0)
    s_barrier
    v_mfma_f32_32x32x16_bf16 v[40:55], v[28:31], v[12:15], v[40:55]
    ds_read_b128 v[8:11], v4
    ds_read_b64_tr_b16 v[16:17], v6 offset:0
    ds_read_b64_tr_b16 v[18:19], v6 offset:768
    ds_read_b64_tr_b16 v[20:21], v6 offset:64
    v_mfma_f32_32x32x16_bf16 v[56:71], v[32:35], v[12:15], v[56:71]
    ds_read_b64_tr_b16 v[22:23], v6 offset:832
    ds_read_b64_tr_b16 v[24:25], v6 offset:128
    v_mfma_f32_32x32x16_bf16 v[72:87], v[36:39], v[12:15], v[72:87]
    ds_read_b64_tr_b16 v[26:27], v6 offset:896
    s_waitcnt lgkmcnt(0)
    v_mfma_f32_32x32x16_bf16 v[40:55], v[16:19], v[8:11], v[40:55]
    ds_read_b128 v[12:15], v5
    ds_read_b64_tr_b16 v[28:29], v6 offset:3072
    ds_read_b64_tr_b16 v[30:31], v6 offset:3840
    ds_read_b64_tr_b16 v[32:33], v6 offset:3136
    v_mfma_f32_32x32x16_bf16 v[56:71], v[20:23], v[8:11], v[56:71]
    ds_read_b64_tr_b16 v[34:35], v6 offset:3904
    ds_read_b64_tr_b16 v[36:37], v6 offset:3200
    v_mfma_f32_32x32x16_bf16 v[72:87], v[24:27], v[8:11], v[72:87]
    ds_read_b64_tr_b16 v[38:39], v6 offset:3968
    s_add_u32 s38, s38, 6144
    s_cmp_ge_u32 s38, 30720
    s_cselect_b32 s37, 30720, 0
    s_sub_u32 s38, s38, s37
    s_sub_u32 s37, 6144, s37
    v_add_u32 v6, s37, v6
    s_add_u32 s39, s39, 16384
    s_cmp_ge_u32 s39, 49152
    s_cselect_b32 s37, 49152, 0
    s_sub_u32 s39, s39, s37
    s_sub_u32 s37, 16384, s37
    v_add_u32 v2, s37, v2
    v_add_u32 v3, s37, v3
    v_add_u32 v4, s37, v4
    v_add_u32 v5, s37, v5
    s_waitcnt lgkmcnt(0)
    s_barrier
    v_mfma_f32_32x32x16_bf16 v[40:55], v[28:31], v[12:15], v[40:55]
    ds_read_b128 v[8:11], v2
    ds_read_b64_tr_b16 v[16:17], v6 offset:0
    ds_read_b64_tr_b16 v[18:19], v6 offset:768
    ds_read_b64_tr_b16 v[20:21], v6 offset:64
    v_mfma_f32_32x32x16_bf16 v[56:71], v[32:35], v[12:15], v[56:71]
    ds_read_b64_tr_b16 v[22:23], v6 offset:832
    ds_read_b64_tr_b16 v[24:25], v6 offset:128
    v_mfma_f32_32x32x16_bf16 v[72:87], v[36:39], v[12:15], v[72:87]
    ds_read_b64_tr_b16 v[26:27], v6 offset:896
    s_sub_u32 s36, s36, 1
    s_cmp_lg_u32 s36, 0
    s_cbranch_scc1 f1_ml11
    s_waitcnt lgkmcnt(0)
    v_mfma_f32_32x32x16_bf16 v[40:55], v[16:19], v[8:11], v[40:55]
    ds_read_b128 v[12:15], v3
    ds_read_b64_tr_b16 v[28:29], v6 offset:3072
    ds_read_b64_tr_b16 v[30:31], v6 offset:3840
    ds_read_b64_tr_b16 v[32:33], v6 offset:3136
    v_mfma_f32_32x32x16_bf16 v[56:71], v[20:23], v[8:11], v[56:71]
    ds_read_b64_tr_b16 v[34:35], v6 offset:3904
    ds_read_b64_tr_b16 v[36:37], v6 offset:3200
    v_mfma_f32_32x32x16_bf16 v[72:87], v[24:27], v[8:11], v[72:87]
    ds_read_b64_tr_b16 v[38:39], v6 offset:3968
    s_add_u32 s38, s38, 6144
    s_cmp_ge_u32 s38, 30720
    s_cselect_b32 s37, 30720, 0
    s_sub_u32 s38, s38, s37
    s_sub_u32 s37, 6144, s37
    v_add_u32 v6, s37, v6
    s_waitcnt lgkmcnt(0)
    s_barrier
    v_mfma_f32_32x32x16_bf16 v[40:55], v[28:31], v[12:15], v[40:55]
    ds_read_b128 v[8:11], v4
    ds_read_b64_tr_b16 v[16:17], v6 offset:0
    ds_read_b64_tr_b16 v[18:19], v6 offset:768
    ds_read_b64_tr_b16 v[20:21], v6 offset:64
    v_mfma_f32_32x32x16_bf16 v[56:71], v[32:35], v[12:15], v[56:71]
    ds_read_b64_tr_b16 v[22:23], v6 offset:832
    ds_read_b64_tr_b16 v[24:25], v6 offset:128
    v_mfma_f32_32x32x16_bf16 v[72:87], v[36:39], v[12:15], v[72:87]
    ds_read_b64_tr_b16 v[26:27], v6 offset:896
    s_waitcnt lgkmcnt(0)
    v_mfma_f32_32x32x16_bf16 v[40:55], v[16:19], v[8:11], v[40:55]
    ds_read_b128 v[12:15], v5
    ds_read_b64_tr_b16 v[28:29], v6 offset:3072
    ds_read_b64_tr_b16 v[30:31], v6 offset:3840
    ds_read_b64_tr_b16 v[32:33], v6 offset:3136
    v_mfma_f32_32x32x16_bf16 v[56:71], v[20:23], v[8:11], v[56:71]
    ds_read_b64_tr_b16 v[34:35], v6 offset:3904
    ds_read_b64_tr_b16 v[36:37], v6 offset:3200
    v_mfma_f32_32x32x16_bf16 v[72:87], v[24:27], v[8:11], v[72:87]
    ds_read_b64_tr_b16 v[38:39], v6 offset:3968
    s_waitcnt lgkmcnt(0)
    v_mfma_f32_32x32x16_bf16 v[40:55], v[28:31], v[12:15], v[40:55]
    v_mfma_f32_32x32x16_bf16 v[56:71], v[32:35], v[12:15], v[56:71]
    v_mfma_f32_32x32x16_bf16 v[72:87], v[36:39], v[12:15], v[72:87]
    s_barrier
    s_setprio 3
    s_lshl_b32 s24, s41, 2
    s_add_u32 s24, s24, s20
    s_mul_i32 s24, s24, 98304
    s_mul_i32 s25, s40, 6144
    s_add_u32 s24, s24, s25
    s_add_u32 s24, s24, 10485760
    v_lshlrev_b32 v88, 4, v0
    s_waitcnt vmcnt(0)
    s_nop 7
    v_lshlrev_b32 v124, 16, v100
    v_and_b32 v125, 0xffff0000, v100
    v_lshlrev_b32 v126, 16, v101
    v_and_b32 v127, 0xffff0000, v101
    v_add_f32 v40, v40, v124
    v_add_f32 v41, v41, v125
    v_add_f32 v42, v42, v126
    v_add_f32 v43, v43, v127
    v_lshlrev_b32 v124, 16, v102
    v_and_b32 v125, 0xffff0000, v102
    v_lshlrev_b32 v126, 16, v103
    v_and_b32 v127, 0xffff0000, v103
    v_add_f32 v44, v44, v124
    v_add_f32 v45, v45, v125
    v_add_f32 v46, v46, v126
    v_add_f32 v47, v47, v127
    v_max_f32 v40, 0, v40
    v_max_f32 v41, 0, v41
    v_max_f32 v42, 0, v42
    v_max_f32 v43, 0, v43
    v_max_f32 v44, 0, v44
    v_max_f32 v45, 0, v45
    v_max_f32 v46, 0, v46
    v_max_f32 v47, 0, v47
    v_mul_f32 v40, v40, v40
    v_mul_f32 v41, v41, v41
    v_mul_f32 v42, v42, v42
    v_mul_f32 v43, v43, v43
    v_mul_f32 v44, v44, v44
    v_mul_f32 v45, v45, v45
    v_mul_f32 v46, v46, v46
    v_mul_f32 v47, v47, v47
    v_cvt_pk_bf16_f32 v90, v40, v41
    v_cvt_pk_bf16_f32 v91, v42, v43
    v_cvt_pk_bf16_f32 v92, v44, v45
    v_cvt_pk_bf16_f32 v93, v46, v47
    buffer_store_dwordx4 v[90:93], v88, s[16:19], s24 offen offset:0 sc0 sc1
    v_lshlrev_b32 v124, 16, v104
    v_and_b32 v125, 0xffff0000, v104
    v_lshlrev_b32 v126, 16, v105
    v_and_b32 v127, 0xffff0000, v105
    v_add_f32 v48, v48, v124
    v_add_f32 v49, v49, v125
    v_add_f32 v50, v50, v126
    v_add_f32 v51, v51, v127
    v_lshlrev_b32 v124, 16, v106
    v_and_b32 v125, 0xffff0000, v106
    v_lshlrev_b32 v126, 16, v107
    v_and_b32 v127, 0xffff0000, v107
    v_add_f32 v52, v52, v124
    v_add_f32 v53, v53, v125
    v_add_f32 v54, v54, v126
    v_add_f32 v55, v55, v127
    v_max_f32 v48, 0, v48
    v_max_f32 v49, 0, v49
    v_max_f32 v50, 0, v50
    v_max_f32 v51, 0, v51
    v_max_f32 v52, 0, v52
    v_max_f32 v53, 0, v53
    v_max_f32 v54, 0, v54
    v_max_f32 v55, 0, v55
    v_mul_f32 v48, v48, v48
    v_mul_f32 v49, v49, v49
    v_mul_f32 v50, v50, v50
    v_mul_f32 v51, v51, v51
    v_mul_f32 v52, v52, v52
    v_mul_f32 v53, v53, v53
    v_mul_f32 v54, v54, v54
    v_mul_f32 v55, v55, v55
    v_cvt_pk_bf16_f32 v94, v48, v49
    v_cvt_pk_bf16_f32 v95, v50, v51
    v_cvt_pk_bf16_f32 v96, v52, v53
    v_cvt_pk_bf16_f32 v97, v54, v55
    buffer_store_dwordx4 v[94:97], v88, s[16:19], s24 offen offset:1024 sc0 sc1
    v_lshlrev_b32 v124, 16, v108
    v_and_b32 v125, 0xffff0000, v108
    v_lshlrev_b32 v126, 16, v109
    v_and_b32 v127, 0xffff0000, v109
    v_add_f32 v56, v56, v124
    v_add_f32 v57, v57, v125
    v_add_f32 v58, v58, v126
    v_add_f32 v59, v59, v127
    v_lshlrev_b32 v124, 16, v110
    v_and_b32 v125, 0xffff0000, v110
    v_lshlrev_b32 v126, 16, v111
    v_and_b32 v127, 0xffff0000, v111
    v_add_f32 v60, v60, v124
    v_add_f32 v61, v61, v125
    v_add_f32 v62, v62, v126
    v_add_f32 v63, v63, v127
    v_max_f32 v56, 0, v56
    v_max_f32 v57, 0, v57
    v_max_f32 v58, 0, v58
    v_max_f32 v59, 0, v59
    v_max_f32 v60, 0, v60
    v_max_f32 v61, 0, v61
    v_max_f32 v62, 0, v62
    v_max_f32 v63, 0, v63
    v_mul_f32 v56, v56, v56
    v_mul_f32 v57, v57, v57
    v_mul_f32 v58, v58, v58
    v_mul_f32 v59, v59, v59
    v_mul_f32 v60, v60, v60
    v_mul_f32 v61, v61, v61
    v_mul_f32 v62, v62, v62
    v_mul_f32 v63, v63, v63
    v_cvt_pk_bf16_f32 v90, v56, v57
    v_cvt_pk_bf16_f32 v91, v58, v59
    v_cvt_pk_bf16_f32 v92, v60, v61
    v_cvt_pk_bf16_f32 v93, v62, v63
    buffer_store_dwordx4 v[90:93], v88, s[16:19], s24 offen offset:2048 sc0 sc1
    v_lshlrev_b32 v124, 16, v112
    v_and_b32 v125, 0xffff0000, v112
    v_lshlrev_b32 v126, 16, v113
    v_and_b32 v127, 0xffff0000, v113
    v_add_f32 v64, v64, v124
    v_add_f32 v65, v65, v125
    v_add_f32 v66, v66, v126
    v_add_f32 v67, v67, v127
    v_lshlrev_b32 v124, 16, v114
    v_and_b32 v125, 0xffff0000, v114
    v_lshlrev_b32 v126, 16, v115
    v_and_b32 v127, 0xffff0000, v115
    v_add_f32 v68, v68, v124
    v_add_f32 v69, v69, v125
    v_add_f32 v70, v70, v126
    v_add_f32 v71, v71, v127
    v_max_f32 v64, 0, v64
    v_max_f32 v65, 0, v65
    v_max_f32 v66, 0, v66
    v_max_f32 v67, 0, v67
    v_max_f32 v68, 0, v68
    v_max_f32 v69, 0, v69
    v_max_f32 v70, 0, v70
    v_max_f32 v71, 0, v71
    v_mul_f32 v64, v64, v64
    v_mul_f32 v65, v65, v65
    v_mul_f32 v66, v66, v66
    v_mul_f32 v67, v67, v67
    v_mul_f32 v68, v68, v68
    v_mul_f32 v69, v69, v69
    v_mul_f32 v70, v70, v70
    v_mul_f32 v71, v71, v71
    v_cvt_pk_bf16_f32 v94, v64, v65
    v_cvt_pk_bf16_f32 v95, v66, v67
    v_cvt_pk_bf16_f32 v96, v68, v69
    v_cvt_pk_bf16_f32 v97, v70, v71
    buffer_store_dwordx4 v[94:97], v88, s[16:19], s24 offen offset:3072 sc0 sc1
    v_lshlrev_b32 v124, 16, v116
    v_and_b32 v125, 0xffff0000, v116
    v_lshlrev_b32 v126, 16, v117
    v_and_b32 v127, 0xffff0000, v117
    v_add_f32 v72, v72, v124
    v_add_f32 v73, v73, v125
    v_add_f32 v74, v74, v126
    v_add_f32 v75, v75, v127
    v_lshlrev_b32 v124, 16, v118
    v_and_b32 v125, 0xffff0000, v118
    v_lshlrev_b32 v126, 16, v119
    v_and_b32 v127, 0xffff0000, v119
    v_add_f32 v76, v76, v124
    v_add_f32 v77, v77, v125
    v_add_f32 v78, v78, v126
    v_add_f32 v79, v79, v127
    v_max_f32 v72, 0, v72
    v_max_f32 v73, 0, v73
    v_max_f32 v74, 0, v74
    v_max_f32 v75, 0, v75
    v_max_f32 v76, 0, v76
    v_max_f32 v77, 0, v77
    v_max_f32 v78, 0, v78
    v_max_f32 v79, 0, v79
    v_mul_f32 v72, v72, v72
    v_mul_f32 v73, v73, v73
    v_mul_f32 v74, v74, v74
    v_mul_f32 v75, v75, v75
    v_mul_f32 v76, v76, v76
    v_mul_f32 v77, v77, v77
    v_mul_f32 v78, v78, v78
    v_mul_f32 v79, v79, v79
    v_cvt_pk_bf16_f32 v90, v72, v73
    v_cvt_pk_bf16_f32 v91, v74, v75
    v_cvt_pk_bf16_f32 v92, v76, v77
    v_cvt_pk_bf16_f32 v93, v78, v79
    s_add_u32 s24, s24, 4096
    buffer_store_dwordx4 v[90:93], v88, s[16:19], s24 offen offset:0 sc0 sc1
    v_lshlrev_b32 v124, 16, v120
    v_and_b32 v125, 0xffff0000, v120
    v_lshlrev_b32 v126, 16, v121
    v_and_b32 v127, 0xffff0000, v121
    v_add_f32 v80, v80, v124
    v_add_f32 v81, v81, v125
    v_add_f32 v82, v82, v126
    v_add_f32 v83, v83, v127
    v_lshlrev_b32 v124, 16, v122
    v_and_b32 v125, 0xffff0000, v122
    v_lshlrev_b32 v126, 16, v123
    v_and_b32 v127, 0xffff0000, v123
    v_add_f32 v84, v84, v124
    v_add_f32 v85, v85, v125
    v_add_f32 v86, v86, v126
    v_add_f32 v87, v87, v127
    v_max_f32 v80, 0, v80
    v_max_f32 v81, 0, v81
    v_max_f32 v82, 0, v82
    v_max_f32 v83, 0, v83
    v_max_f32 v84, 0, v84
    v_max_f32 v85, 0, v85
    v_max_f32 v86, 0, v86
    v_max_f32 v87, 0, v87
    v_mul_f32 v80, v80, v80
    v_mul_f32 v81, v81, v81
    v_mul_f32 v82, v82, v82
    v_mul_f32 v83, v83, v83
    v_mul_f32 v84, v84, v84
    v_mul_f32 v85, v85, v85
    v_mul_f32 v86, v86, v86
    v_mul_f32 v87, v87, v87
    v_cvt_pk_bf16_f32 v94, v80, v81
    v_cvt_pk_bf16_f32 v95, v82, v83
    v_cvt_pk_bf16_f32 v96, v84, v85
    v_cvt_pk_bf16_f32 v97, v86, v87
    buffer_store_dwordx4 v[94:97], v88, s[16:19], s24 offen offset:1024 sc0 sc1
    s_setprio 0
    s_waitcnt vmcnt(0)
    s_lshl_b32 s24, s41, 4
    s_add_u32 s24, s24, s40
    s_lshl_b32 s24, s24, 7
    s_lshl_b32 s25, s20, 2
    s_add_u32 s24, s24, s25
    s_add_u32 s24, s24, 34668544
    v_mov_b32 v120, 0
    v_mov_b32 v121, s95
    s_mov_b64 exec, 1
    buffer_store_dword v121, v120, s[16:19], s24 offen sc1
    s_mov_b64 exec, -1
f1_done:
    s_sub_u32 s24, s2, 256
    s_and_b32 s25, s24, 7
    s_lshr_b32 s26, s24, 3
    s_and_b32 s27, s25, 3
    s_lshr_b32 s28, s25, 2
    s_and_b32 s29, s26, 7
    s_lshl_b32 s42, s27, 3
    s_add_u32 s42, s42, s29
    s_lshr_b32 s30, s26, 3
    s_lshl_b32 s43, s28, 2
    s_add_u32 s43, s43, s30
    s_cmp_ge_u32 s43, 7
    s_cbranch_scc1 fr_quit
    s_setprio 2
    s_load_dwordx2 s[44:45], s[0:1], 88
    s_load_dwordx2 s[52:53], s[0:1], 48
    s_load_dwordx2 s[54:55], s[0:1], 16
    s_load_dwordx2 s[58:59], s[0:1], 56
    s_load_dwordx2 s[4:5], s[0:1], 72
    s_mul_i32 s81, s29, 3
    s_add_u32 s81, s81, s30
    s_cmp_ge_u32 s81, 24
    s_cselect_b32 s31, 24, 0
    s_sub_u32 s81, s81, s31
    s_add_u32 s82, s29, s30
    s_and_b32 s82, s82, 3
    s_lshl_b32 s82, s82, 1
    s_waitcnt lgkmcnt(0)
    s_cmp_ge_u32 s20, 4
    s_cbranch_scc0 fr_comp
    s_setprio 2
    s_sub_u32 s24, s20, 4
    s_mul_i32 s25, s24, 192
    v_add_u32 v10, s25, v0
    v_mul_u32_u24 v11, 5462, v10
    v_lshrrev_b32 v11, 16, v11
    v_mul_u32_u24 v12, 12, v11
    v_sub_u32 v10, v10, v12
    v_lshlrev_b32 v10, 4, v10
    v_mul_u32_u24 v12, 1280, v11
    v_add_u32 v5, v10, v12
    s_mul_i32 s25, s24, 192
    v_add_u32 v10, s25, v0
    v_add_u32 v10, 64, v10
    v_mul_u32_u24 v11, 5462, v10
    v_lshrrev_b32 v11, 16, v11
    v_mul_u32_u24 v12, 12, v11
    v_sub_u32 v10, v10, v12
    v_lshlrev_b32 v10, 4, v10
    v_mul_u32_u24 v12, 1280, v11
    v_add_u32 v6, v10, v12
    v_subrev_u32 v6, 1024, v6
    s_mul_i32 s25, s24, 192
    v_add_u32 v10, s25, v0
    v_add_u32 v10, 128, v10
    v_mul_u32_u24 v11, 5462, v10
    v_lshrrev_b32 v11, 16, v11
    v_mul_u32_u24 v12, 12, v11
    v_sub_u32 v10, v10, v12
    v_lshlrev_b32 v10, 4, v10
    v_mul_u32_u24 v12, 1280, v11
    v_add_u32 v7, v10, v12
    v_subrev_u32 v7, 2048, v7
    s_mul_i32 s28, s24, 3072
    s_mov_b32 s84, s52
    s_and_b32 s85, s53, 0xffff
    s_mov_b32 s86, 1966080
    s_mov_b32 s87, 0x20000
    s_mov_b32 s88, s54
    s_and_b32 s89, s55, 0xffff
    s_mov_b32 s90, 819200
    s_mov_b32 s91, 0x20000
    s_mul_i32 s30, s43, 192
    s_mul_i32 s25, s24, 240
    v_add_u32 v10, s25, v0
    v_mul_u32_u24 v11, 5462, v10
    v_lshrrev_b32 v11, 16, v11
    v_mul_u32_u24 v12, 12, v11
    v_sub_u32 v10, v10, v12
    v_lshlrev_b32 v10, 4, v10
    v_mul_u32_u24 v12, 1280, v11
    v_add_u32 v14, v10, v12
    s_mul_i32 s25, s24, 240
    v_add_u32 v10, s25, v0
    v_add_u32 v10, 64, v10
    v_mul_u32_u24 v11, 5462, v10
    v_lshrrev_b32 v11, 16, v11
    v_mul_u32_u24 v12, 12, v11
    v_sub_u32 v10, v10, v12
    v_lshlrev_b32 v10, 4, v10
    v_mul_u32_u24 v12, 1280, v11
    v_add_u32 v15, v10, v12
    s_mul_i32 s25, s24, 240
    v_add_u32 v10, s25, v0
    v_add_u32 v10, 128, v10
    v_mul_u32_u24 v11, 5462, v10
    v_lshrrev_b32 v11, 16, v11
    v_mul_u32_u24 v12, 12, v11
    v_sub_u32 v10, v10, v12
    v_lshlrev_b32 v10, 4, v10
    v_mul_u32_u24 v12, 1280, v11
    v_add_u32 v16, v10, v12
    s_mul_i32 s25, s24, 240
    v_add_u32 v10, s25, v0
    v_add_u32 v10, 192, v10
    v_mul_u32_u24 v11, 5462, v10
    v_lshrrev_b32 v11, 16, v11
    v_mul_u32_u24 v12, 12, v11
    v_sub_u32 v10, v10, v12
    v_lshlrev_b32 v10, 4, v10
    v_mul_u32_u24 v12, 1280, v11
    v_add_u32 v17, v10, v12
    s_mul_i32 s29, s24, 3840
    v_lshlrev_b32 v20, 4, v0
    v_add_u32 v20, s29, v20
    s_mov_b32 s26, -1
    s_mov_b32 s27, 0xffff
    s_add_u32 s32, s81, 0
    s_cmp_ge_u32 s32, 24
    s_cselect_b32 s33, 24, 0
    s_sub_u32 s32, s32, s33
    s_mul_i32 s32, s32, 81920
    s_add_u32 s31, s32, s30
    s_add_u32 s34, s28, 0
    s_mov_b32 m0, s34
    s_nop 0
    buffer_load_dwordx4 v5, s[84:87], s31 offen offset:0 lds
    buffer_load_dwordx4 v6, s[84:87], s31 offen offset:1024 lds
    buffer_load_dwordx4 v7, s[84:87], s31 offen offset:2048 lds
    s_add_u32 s32, s81, 1
    s_cmp_ge_u32 s32, 24
    s_cselect_b32 s33, 24, 0
    s_sub_u32 s32, s32, s33
    s_mul_i32 s32, s32, 81920
    s_add_u32 s31, s32, s30
    s_add_u32 s34, s28, 12288
    s_mov_b32 m0, s34
    s_nop 0
    buffer_load_dwordx4 v5, s[84:87], s31 offen offset:0 lds
    buffer_load_dwordx4 v6, s[84:87], s31 offen offset:1024 lds
    buffer_load_dwordx4 v7, s[84:87], s31 offen offset:2048 lds
    s_add_u32 s32, s81, 2
    s_cmp_ge_u32 s32, 24
    s_cselect_b32 s33, 24, 0
    s_sub_u32 s32, s32, s33
    s_mul_i32 s32, s32, 81920
    s_add_u32 s31, s32, s30
    s_add_u32 s34, s28, 24576
    s_mov_b32 m0, s34
    s_nop 0
    buffer_load_dwordx4 v5, s[84:87], s31 offen offset:0 lds
    buffer_load_dwordx4 v6, s[84:87], s31 offen offset:1024 lds
    buffer_load_dwordx4 v7, s[84:87], s31 offen offset:2048 lds
    s_barrier
    s_add_u32 s32, s81, 3
    s_cmp_ge_u32 s32, 24
    s_cselect_b32 s33, 24, 0
    s_sub_u32 s32, s32, s33
    s_mul_i32 s32, s32, 81920
    s_add_u32 s31, s32, s30
    s_add_u32 s34, s28, 36864
    s_waitcnt vmcnt(6)
    s_barrier
    s_mov_b32 m0, s34
    s_nop 0
    buffer_load_dwordx4 v5, s[84:87], s31 offen offset:0 lds
    buffer_load_dwordx4 v6, s[84:87], s31 offen offset:1024 lds
    buffer_load_dwordx4 v7, s[84:87], s31 offen offset:2048 lds
    s_add_u32 s32, s81, 4
    s_cmp_ge_u32 s32, 24
    s_cselect_b32 s33, 24, 0
    s_sub_u32 s32, s32, s33
    s_mul_i32 s32, s32, 81920
    s_add_u32 s31, s32, s30
    s_add_u32 s34, s28, 49152
    s_waitcnt vmcnt(6)
    s_barrier
    s_mov_b32 m0, s34
    s_nop 0
    buffer_load_dwordx4 v5, s[84:87], s31 offen offset:0 lds
    buffer_load_dwordx4 v6, s[84:87], s31 offen offset:1024 lds
    buffer_load_dwordx4 v7, s[84:87], s31 offen offset:2048 lds
    s_add_u32 s32, s81, 5
    s_cmp_ge_u32 s32, 24
    s_cselect_b32 s33, 24, 0
    s_sub_u32 s32, s32, s33
    s_mul_i32 s32, s32, 81920
    s_add_u32 s31, s32, s30
    s_add_u32 s34, s28, 61440
    s_waitcnt vmcnt(6)
    s_barrier
    s_mov_b32 m0, s34
    s_nop 0
    buffer_load_dwordx4 v5, s[84:87], s31 offen offset:0 lds
    buffer_load_dwordx4 v6, s[84:87], s31 offen offset:1024 lds
    buffer_load_dwordx4 v7, s[84:87], s31 offen offset:2048 lds
    s_add_u32 s32, s81, 6
    s_cmp_ge_u32 s32, 24
    s_cselect_b32 s33, 24, 0
    s_sub_u32 s32, s32, s33
    s_mul_i32 s32, s32, 81920
    s_add_u32 s31, s32, s30
    s_add_u32 s34, s28, 0
    s_waitcnt vmcnt(6)
    s_barrier
    s_mov_b32 m0, s34
    s_nop 0
    buffer_load_dwordx4 v5, s[84:87], s31 offen offset:0 lds
    buffer_load_dwordx4 v6, s[84:87], s31 offen offset:1024 lds
    buffer_load_dwordx4 v7, s[84:87], s31 offen offset:2048 lds
    s_add_u32 s32, s81, 7
    s_cmp_ge_u32 s32, 24
    s_cselect_b32 s33, 24, 0
    s_sub_u32 s32, s32, s33
    s_mul_i32 s32, s32, 81920
    s_add_u32 s31, s32, s30
    s_add_u32 s34, s28, 12288
    s_waitcnt vmcnt(6)
    s_barrier
    s_mov_b32 m0, s34
    s_nop 0
    buffer_load_dwordx4 v5, s[84:87], s31 offen offset:0 lds
    buffer_load_dwordx4 v6, s[84:87], s31 offen offset:1024 lds
    buffer_load_dwordx4 v7, s[84:87], s31 offen offset:2048 lds
    s_add_u32 s32, s81, 8
    s_cmp_ge_u32 s32, 24
    s_cselect_b32 s33, 24, 0
    s_sub_u32 s32, s32, s33
    s_mul_i32 s32, s32, 81920
    s_add_u32 s31, s32, s30
    s_add_u32 s34, s28, 24576
    s_waitcnt vmcnt(6)
    s_barrier
    s_mov_b32 m0, s34
    s_nop 0
    buffer_load_dwordx4 v5, s[84:87], s31 offen offset:0 lds
    buffer_load_dwordx4 v6, s[84:87], s31 offen offset:1024 lds
    buffer_load_dwordx4 v7, s[84:87], s31 offen offset:2048 lds
    s_add_u32 s32, s81, 9
    s_cmp_ge_u32 s32, 24
    s_cselect_b32 s33, 24, 0
    s_sub_u32 s32, s32, s33
    s_mul_i32 s32, s32, 81920
    s_add_u32 s31, s32, s30
    s_add_u32 s34, s28, 36864
    s_waitcnt vmcnt(6)
    s_barrier
    s_mov_b32 m0, s34
    s_nop 0
    buffer_load_dwordx4 v5, s[84:87], s31 offen offset:0 lds
    buffer_load_dwordx4 v6, s[84:87], s31 offen offset:1024 lds
    buffer_load_dwordx4 v7, s[84:87], s31 offen offset:2048 lds
    s_add_u32 s35, s82, 0
    s_and_b32 s35, s35, 7
    s_mul_i32 s35, s35, 102400
    s_add_u32 s35, s35, s30
    buffer_load_dwordx4 v[28:31], v14, s[88:91], s35 offen
    buffer_load_dwordx4 v[32:35], v15, s[88:91], s35 offen
    s_add_u32 s32, s81, 10
    s_cmp_ge_u32 s32, 24
    s_cselect_b32 s33, 24, 0
    s_sub_u32 s32, s32, s33
    s_mul_i32 s32, s32, 81920
    s_add_u32 s31, s32, s30
    s_add_u32 s34, s28, 49152
    s_waitcnt vmcnt(8)
    s_barrier
    s_mov_b32 m0, s34
    s_nop 0
    buffer_load_dwordx4 v5, s[84:87], s31 offen offset:0 lds
    buffer_load_dwordx4 v6, s[84:87], s31 offen offset:1024 lds
    buffer_load_dwordx4 v7, s[84:87], s31 offen offset:2048 lds
    buffer_load_dwordx4 v[36:39], v16, s[88:91], s35 offen
    s_mov_b64 exec, s[26:27]
    buffer_load_dwordx4 v[40:43], v17, s[88:91], s35 offen
    s_mov_b64 exec, -1
    s_add_u32 s32, s81, 11
    s_cmp_ge_u32 s32, 24
    s_cselect_b32 s33, 24, 0
    s_sub_u32 s32, s32, s33
    s_mul_i32 s32, s32, 81920
    s_add_u32 s31, s32, s30
    s_add_u32 s34, s28, 61440
    s_waitcnt vmcnt(10)
    s_barrier
    s_mov_b32 m0, s34
    s_nop 0
    buffer_load_dwordx4 v5, s[84:87], s31 offen offset:0 lds
    buffer_load_dwordx4 v6, s[84:87], s31 offen offset:1024 lds
    buffer_load_dwordx4 v7, s[84:87], s31 offen offset:2048 lds
    s_add_u32 s35, s82, 1
    s_and_b32 s35, s35, 7
    s_mul_i32 s35, s35, 102400
    s_add_u32 s35, s35, s30
    buffer_load_dwordx4 v[44:47], v14, s[88:91], s35 offen
    buffer_load_dwordx4 v[48:51], v15, s[88:91], s35 offen
    s_add_u32 s32, s81, 12
    s_cmp_ge_u32 s32, 24
    s_cselect_b32 s33, 24, 0
    s_sub_u32 s32, s32, s33
    s_mul_i32 s32, s32, 81920
    s_add_u32 s31, s32, s30
    s_add_u32 s34, s28, 0
    s_waitcnt vmcnt(12)
    s_barrier
    s_mov_b32 m0, s34
    s_nop 0
    buffer_load_dwordx4 v5, s[84:87], s31 offen offset:0 lds
    buffer_load_dwordx4 v6, s[84:87], s31 offen offset:1024 lds
    buffer_load_dwordx4 v7, s[84:87], s31 offen offset:2048 lds
    buffer_load_dwordx4 v[52:55], v16, s[88:91], s35 offen
    s_mov_b64 exec, s[26:27]
    buffer_load_dwordx4 v[56:59], v17, s[88:91], s35 offen
    s_mov_b64 exec, -1
    s_add_u32 s32, s81, 13
    s_cmp_ge_u32 s32, 24
    s_cselect_b32 s33, 24, 0
    s_sub_u32 s32, s32, s33
    s_mul_i32 s32, s32, 81920
    s_add_u32 s31, s32, s30
    s_add_u32 s34, s28, 12288
    s_waitcnt vmcnt(12)
    s_barrier
    s_mov_b32 m0, s34
    s_nop 0
    buffer_load_dwordx4 v5, s[84:87], s31 offen offset:0 lds
    buffer_load_dwordx4 v6, s[84:87], s31 offen offset:1024 lds
    buffer_load_dwordx4 v7, s[84:87], s31 offen offset:2048 lds
    s_add_u32 s35, s82, 2
    s_and_b32 s35, s35, 7
    s_mul_i32 s35, s35, 102400
    s_add_u32 s35, s35, s30
    buffer_load_dwordx4 v[60:63], v14, s[88:91], s35 offen
    buffer_load_dwordx4 v[64:67], v15, s[88:91], s35 offen
    s_add_u32 s32, s81, 14
    s_cmp_ge_u32 s32, 24
    s_cselect_b32 s33, 24, 0
    s_sub_u32 s32, s32, s33
    s_mul_i32 s32, s32, 81920
    s_add_u32 s31, s32, s30
    s_add_u32 s34, s28, 24576
    s_waitcnt vmcnt(12)
    s_barrier
    s_mov_b32 m0, s34
    s_nop 0
    buffer_load_dwordx4 v5, s[84:87], s31 offen offset:0 lds
    buffer_load_dwordx4 v6, s[84:87], s31 offen offset:1024 lds
    buffer_load_dwordx4 v7, s[84:87], s31 offen offset:2048 lds
    buffer_load_dwordx4 v[68:71], v16, s[88:91], s35 offen
    s_mov_b64 exec, s[26:27]
    buffer_load_dwordx4 v[72:75], v17, s[88:91], s35 offen
    s_mov_b64 exec, -1
    s_add_u32 s32, s81, 15
    s_cmp_ge_u32 s32, 24
    s_cselect_b32 s33, 24, 0
    s_sub_u32 s32, s32, s33
    s_mul_i32 s32, s32, 81920
    s_add_u32 s31, s32, s30
    s_add_u32 s34, s28, 36864
    s_waitcnt vmcnt(12)
    s_barrier
    s_mov_b32 m0, s34
    s_nop 0
    buffer_load_dwordx4 v5, s[84:87], s31 offen offset:0 lds
    buffer_load_dwordx4 v6, s[84:87], s31 offen offset:1024 lds
    buffer_load_dwordx4 v7, s[84:87], s31 offen offset:2048 lds
    s_add_u32 s35, s82, 3
    s_and_b32 s35, s35, 7
    s_mul_i32 s35, s35, 102400
    s_add_u32 s35, s35, s30
    buffer_load_dwordx4 v[76:79], v14, s[88:91], s35 offen
    buffer_load_dwordx4 v[80:83], v15, s[88:91], s35 offen
    s_add_u32 s32, s81, 16
    s_cmp_ge_u32 s32, 24
    s_cselect_b32 s33, 24, 0
    s_sub_u32 s32, s32, s33
    s_mul_i32 s32, s32, 81920
    s_add_u32 s31, s32, s30
    s_add_u32 s34, s28, 49152
    s_waitcnt vmcnt(12)
    s_barrier
    s_mov_b32 m0, s34
    s_nop 0
    buffer_load_dwordx4 v5, s[84:87], s31 offen offset:0 lds
    buffer_load_dwordx4 v6, s[84:87], s31 offen offset:1024 lds
    buffer_load_dwordx4 v7, s[84:87], s31 offen offset:2048 lds
    buffer_load_dwordx4 v[84:87], v16, s[88:91], s35 offen
    s_mov_b64 exec, s[26:27]
    buffer_load_dwordx4 v[88:91], v17, s[88:91], s35 offen
    s_mov_b64 exec, -1
    s_add_u32 s32, s81, 17
    s_cmp_ge_u32 s32, 24
    s_cselect_b32 s33, 24, 0
    s_sub_u32 s32, s32, s33
    s_mul_i32 s32, s32, 81920
    s_add_u32 s31, s32, s30
    s_add_u32 s34, s28, 61440
    s_waitcnt vmcnt(12)
    s_barrier
    s_mov_b32 m0, s34
    s_nop 0
    buffer_load_dwordx4 v5, s[84:87], s31 offen offset:0 lds
    buffer_load_dwordx4 v6, s[84:87], s31 offen offset:1024 lds
    buffer_load_dwordx4 v7, s[84:87], s31 offen offset:2048 lds
    s_add_u32 s35, s82, 4
    s_and_b32 s35, s35, 7
    s_mul_i32 s35, s35, 102400
    s_add_u32 s35, s35, s30
    buffer_load_dwordx4 v[92:95], v14, s[88:91], s35 offen
    buffer_load_dwordx4 v[96:99], v15, s[88:91], s35 offen
    s_add_u32 s32, s81, 18
    s_cmp_ge_u32 s32, 24
    s_cselect_b32 s33, 24, 0
    s_sub_u32 s32, s32, s33
    s_mul_i32 s32, s32, 81920
    s_add_u32 s31, s32, s30
    s_add_u32 s34, s28, 0
    s_waitcnt vmcnt(12)
    s_barrier
    s_mov_b32 m0, s34
    s_nop 0
    buffer_load_dwordx4 v5, s[84:87], s31 offen offset:0 lds
    buffer_load_dwordx4 v6, s[84:87], s31 offen offset:1024 lds
    buffer_load_dwordx4 v7, s[84:87], s31 offen offset:2048 lds
    buffer_load_dwordx4 v[100:103], v16, s[88:91], s35 offen
    s_mov_b64 exec, s[26:27]
    buffer_load_dwordx4 v[104:107], v17, s[88:91], s35 offen
    s_mov_b64 exec, -1
    s_add_u32 s32, s81, 19
    s_cmp_ge_u32 s32, 24
    s_cselect_b32 s33, 24, 0
    s_sub_u32 s32, s32, s33
    s_mul_i32 s32, s32, 81920
    s_add_u32 s31, s32, s30
    s_add_u32 s34, s28, 12288
    s_waitcnt vmcnt(12)
    s_barrier
    s_mov_b32 m0, s34
    s_nop 0
    buffer_load_dwordx4 v5, s[84:87], s31 offen offset:0 lds
    buffer_load_dwordx4 v6, s[84:87], s31 offen offset:1024 lds
    buffer_load_dwordx4 v7, s[84:87], s31 offen offset:2048 lds
    s_add_u32 s35, s82, 5
    s_and_b32 s35, s35, 7
    s_mul_i32 s35, s35, 102400
    s_add_u32 s35, s35, s30
    buffer_load_dwordx4 v[108:111], v14, s[88:91], s35 offen
    buffer_load_dwordx4 v[112:115], v15, s[88:91], s35 offen
    s_add_u32 s32, s81, 20
    s_cmp_ge_u32 s32, 24
    s_cselect_b32 s33, 24, 0
    s_sub_u32 s32, s32, s33
    s_mul_i32 s32, s32, 81920
    s_add_u32 s31, s32, s30
    s_add_u32 s34, s28, 24576
    s_waitcnt vmcnt(12)
    s_barrier
    s_mov_b32 m0, s34
    s_nop 0
    buffer_load_dwordx4 v5, s[84:87], s31 offen offset:0 lds
    buffer_load_dwordx4 v6, s[84:87], s31 offen offset:1024 lds
    buffer_load_dwordx4 v7, s[84:87], s31 offen offset:2048 lds
    buffer_load_dwordx4 v[116:119], v16, s[88:91], s35 offen
    s_mov_b64 exec, s[26:27]
    buffer_load_dwordx4 v[120:123], v17, s[88:91], s35 offen
    s_mov_b64 exec, -1
    s_add_u32 s32, s81, 21
    s_cmp_ge_u32 s32, 24
    s_cselect_b32 s33, 24, 0
    s_sub_u32 s32, s32, s33
    s_mul_i32 s32, s32, 81920
    s_add_u32 s31, s32, s30
    s_add_u32 s34, s28, 36864
    s_waitcnt vmcnt(12)
    s_barrier
    s_mov_b32 m0, s34
    s_nop 0
    buffer_load_dwordx4 v5, s[84:87], s31 offen offset:0 lds
    buffer_load_dwordx4 v6, s[84:87], s31 offen offset:1024 lds
    buffer_load_dwordx4 v7, s[84:87], s31 offen offset:2048 lds
    s_add_u32 s32, s81, 22
    s_cmp_ge_u32 s32, 24
    s_cselect_b32 s33, 24, 0
    s_sub_u32 s32, s32, s33
    s_mul_i32 s32, s32, 81920
    s_add_u32 s31, s32, s30
    s_add_u32 s34, s28, 49152
    s_waitcnt vmcnt(10)
    s_barrier
    s_mov_b32 m0, s34
    s_nop 0
    buffer_load_dwordx4 v5, s[84:87], s31 offen offset:0 lds
    buffer_load_dwordx4 v6, s[84:87], s31 offen offset:1024 lds
    buffer_load_dwordx4 v7, s[84:87], s31 offen offset:2048 lds
    s_add_u32 s32, s81, 23
    s_cmp_ge_u32 s32, 24
    s_cselect_b32 s33, 24, 0
    s_sub_u32 s32, s32, s33
    s_mul_i32 s32, s32, 81920
    s_add_u32 s31, s32, s30
    s_add_u32 s34, s28, 61440
    s_waitcnt vmcnt(8)
    s_barrier
    s_mov_b32 m0, s34
    s_nop 0
    buffer_load_dwordx4 v5, s[84:87], s31 offen offset:0 lds
    buffer_load_dwordx4 v6, s[84:87], s31 offen offset:1024 lds
    buffer_load_dwordx4 v7, s[84:87], s31 offen offset:2048 lds
    s_waitcnt vmcnt(6)
    s_barrier
    s_waitcnt vmcnt(3)
    s_barrier
    s_waitcnt vmcnt(0)
    s_barrier
    s_barrier
    s_waitcnt vmcnt(0)
    ds_write_b128 v20, v[28:31] offset:0
    ds_write_b128 v20, v[32:35] offset:1024
    ds_write_b128 v20, v[36:39] offset:2048
    s_mov_b64 exec, s[26:27]
    ds_write_b128 v20, v[40:43] offset:3072
    s_mov_b64 exec, -1
    ds_write_b128 v20, v[44:47] offset:15360
    ds_write_b128 v20, v[48:51] offset:16384
    ds_write_b128 v20, v[52:55] offset:17408
    s_mov_b64 exec, s[26:27]
    ds_write_b128 v20, v[56:59] offset:18432
    s_mov_b64 exec, -1
    ds_write_b128 v20, v[60:63] offset:30720
    ds_write_b128 v20, v[64:67] offset:31744
    ds_write_b128 v20, v[68:71] offset:32768
    s_mov_b64 exec, s[26:27]
    ds_write_b128 v20, v[72:75] offset:33792
    s_mov_b64 exec, -1
    ds_write_b128 v20, v[76:79] offset:46080
    ds_write_b128 v20, v[80:83] offset:47104
    ds_write_b128 v20, v[84:87] offset:48128
    s_mov_b64 exec, s[26:27]
    ds_write_b128 v20, v[88:91] offset:49152
    s_mov_b64 exec, -1
    ds_write_b128 v20, v[92:95] offset:61440
    ds_write_b128 v20, v[96:99] offset:62464
    ds_write_b128 v20, v[100:103] offset:63488
    s_mov_b64 exec, s[26:27]
    ds_write_b128 v20, v[104:107] offset:64512
    s_mov_b64 exec, -1
    s_waitcnt lgkmcnt(0)
    s_add_u32 s35, s82, 6
    s_and_b32 s35, s35, 7
    s_mul_i32 s35, s35, 102400
    s_add_u32 s35, s35, s30
    buffer_load_dwordx4 v[28:31], v14, s[88:91], s35 offen
    buffer_load_dwordx4 v[32:35], v15, s[88:91], s35 offen
    buffer_load_dwordx4 v[36:39], v16, s[88:91], s35 offen
    s_mov_b64 exec, s[26:27]
    buffer_load_dwordx4 v[40:43], v17, s[88:91], s35 offen
    s_mov_b64 exec, -1
    s_add_u32 s35, s82, 7
    s_and_b32 s35, s35, 7
    s_mul_i32 s35, s35, 102400
    s_add_u32 s35, s35, s30
    buffer_load_dwordx4 v[44:47], v14, s[88:91], s35 offen
    buffer_load_dwordx4 v[48:51], v15, s[88:91], s35 offen
    buffer_load_dwordx4 v[52:55], v16, s[88:91], s35 offen
    s_mov_b64 exec, s[26:27]
    buffer_load_dwordx4 v[56:59], v17, s[88:91], s35 offen
    s_mov_b64 exec, -1
    s_barrier
    s_barrier
    s_waitcnt vmcnt(4)
    ds_write_b128 v20, v[108:111] offset:0
    ds_write_b128 v20, v[112:115] offset:1024
    ds_write_b128 v20, v[116:119] offset:2048
    s_mov_b64 exec, s[26:27]
    ds_write_b128 v20, v[120:123] offset:3072
    s_mov_b64 exec, -1
    ds_write_b128 v20, v[28:31] offset:15360
    ds_write_b128 v20, v[32:35] offset:16384
    ds_write_b128 v20, v[36:39] offset:17408
    s_mov_b64 exec, s[26:27]
    ds_write_b128 v20, v[40:43] offset:18432
    s_mov_b64 exec, -1
    s_waitcnt lgkmcnt(0)
    s_barrier
    s_barrier
    s_waitcnt vmcnt(0)
    ds_write_b128 v20, v[44:47] offset:30720
    ds_write_b128 v20, v[48:51] offset:31744
    ds_write_b128 v20, v[52:55] offset:32768
    s_mov_b64 exec, s[26:27]
    ds_write_b128 v20, v[56:59] offset:33792
    s_mov_b64 exec, -1
    s_waitcnt lgkmcnt(0)
    s_barrier
    s_endpgm
fr_comp:
    s_mov_b32 s8, s44
    s_and_b32 s9, s45, 0xffff
    s_mov_b32 s10, 50331648
    s_mov_b32 s11, 0x20000
    s_mov_b32 s16, s4
    s_and_b32 s17, s5, 0xffff
    s_mov_b32 s18, 2621440
    s_mov_b32 s19, 0x20000
    s_and_b32 s24, s20, 1
    s_lshr_b32 s7, s20, 1
    s_lshl_b32 s47, s42, 1
    s_add_u32 s47, s47, s24
    s_mov_b32 s28, s58
    s_and_b32 s29, s59, 0xffff
    s_mov_b32 s30, 1280
    s_mov_b32 s31, 0x20000
    v_lshrrev_b32 v127, 5, v0
    v_lshlrev_b32 v127, 3, v127
    s_mul_i32 s24, s43, 192
    buffer_load_dwordx2 v[80:81], v127, s[28:31], s24 offen offset:0
    buffer_load_dwordx2 v[84:85], v127, s[28:31], s24 offen offset:16
    buffer_load_dwordx2 v[88:89], v127, s[28:31], s24 offen offset:32
    buffer_load_dwordx2 v[92:93], v127, s[28:31], s24 offen offset:48
    buffer_load_dwordx2 v[96:97], v127, s[28:31], s24 offen offset:64
    buffer_load_dwordx2 v[100:101], v127, s[28:31], s24 offen offset:80
    buffer_load_dwordx2 v[104:105], v127, s[28:31], s24 offen offset:96
    buffer_load_dwordx2 v[108:109], v127, s[28:31], s24 offen offset:112
    buffer_load_dwordx2 v[112:113], v127, s[28:31], s24 offen offset:128
    buffer_load_dwordx2 v[116:117], v127, s[28:31], s24 offen offset:144
    buffer_load_dwordx2 v[120:121], v127, s[28:31], s24 offen offset:160
    buffer_load_dwordx2 v[124:125], v127, s[28:31], s24 offen offset:176
    v_lshlrev_b32 v2, 4, v0
    s_mul_i32 s21, s47, 98304
    s_lshl_b32 s24, s7, 11
    s_add_u32 s21, s21, s24
    s_add_u32 s21, s21, 10485760
    s_mov_b32 s83, s81
    s_lshl_b32 s32, s81, 12
    s_add_u32 s21, s21, s32
    v_lshrrev_b32 v54, 4, v0
    v_and_b32 v55, 15, v0
    v_lshrrev_b32 v56, 2, v55
    v_and_b32 v55, 3, v55
    v_lshrrev_b32 v57, 1, v54
    v_and_b32 v54, 1, v54
    v_lshlrev_b32 v54, 5, v54
    v_lshlrev_b32 v55, 3, v55
    v_add_u32 v54, v54, v55
    s_mul_i32 s24, s7, 6144
    v_add_u32 v54, s24, v54
    v_lshl_add_u32 v4, v57, 2, v56
    v_mul_u32_u24 v4, 192, v4
    v_add_u32 v4, v4, v54
    v_mov_b32 v5, v4
    s_mov_b32 s36, 0
    v_and_b32 v126, 31, v0
    s_lshl_b32 s34, s47, 5
    v_add_u32 v126, s34, v126
    v_lshlrev_b32 v126, 2, v126
    v_add_u32 v126, 16777216, v126
    s_waitcnt vmcnt(0)
    s_cmp_eq_u32 s7, 0
    s_cselect_b32 s25, -1, 0
    v_and_b32 v80, s25, v80
    v_and_b32 v81, s25, v81
    v_lshlrev_b32 v78, 16, v80
    v_and_b32 v79, 0xffff0000, v80
    v_lshlrev_b32 v80, 16, v81
    v_and_b32 v81, 0xffff0000, v81
    v_and_b32 v84, s25, v84
    v_and_b32 v85, s25, v85
    v_lshlrev_b32 v82, 16, v84
    v_and_b32 v83, 0xffff0000, v84
    v_lshlrev_b32 v84, 16, v85
    v_and_b32 v85, 0xffff0000, v85
    v_and_b32 v88, s25, v88
    v_and_b32 v89, s25, v89
    v_lshlrev_b32 v86, 16, v88
    v_and_b32 v87, 0xffff0000, v88
    v_lshlrev_b32 v88, 16, v89
    v_and_b32 v89, 0xffff0000, v89
    v_and_b32 v92, s25, v92
    v_and_b32 v93, s25, v93
    v_lshlrev_b32 v90, 16, v92
    v_and_b32 v91, 0xffff0000, v92
    v_lshlrev_b32 v92, 16, v93
    v_and_b32 v93, 0xffff0000, v93
    v_and_b32 v96, s25, v96
    v_and_b32 v97, s25, v97
    v_lshlrev_b32 v94, 16, v96
    v_and_b32 v95, 0xffff0000, v96
    v_lshlrev_b32 v96, 16, v97
    v_and_b32 v97, 0xffff0000, v97
    v_and_b32 v100, s25, v100
    v_and_b32 v101, s25, v101
    v_lshlrev_b32 v98, 16, v100
    v_and_b32 v99, 0xffff0000, v100
    v_lshlrev_b32 v100, 16, v101
    v_and_b32 v101, 0xffff0000, v101
    v_and_b32 v104, s25, v104
    v_and_b32 v105, s25, v105
    v_lshlrev_b32 v102, 16, v104
    v_and_b32 v103, 0xffff0000, v104
    v_lshlrev_b32 v104, 16, v105
    v_and_b32 v105, 0xffff0000, v105
    v_and_b32 v108, s25, v108
    v_and_b32 v109, s25, v109
    v_lshlrev_b32 v106, 16, v108
    v_and_b32 v107, 0xffff0000, v108
    v_lshlrev_b32 v108, 16, v109
    v_and_b32 v109, 0xffff0000, v109
    v_and_b32 v112, s25, v112
    v_and_b32 v113, s25, v113
    v_lshlrev_b32 v110, 16, v112
    v_and_b32 v111, 0xffff0000, v112
    v_lshlrev_b32 v112, 16, v113
    v_and_b32 v113, 0xffff0000, v113
    v_and_b32 v116, s25, v116
    v_and_b32 v117, s25, v117
    v_lshlrev_b32 v114, 16, v116
    v_and_b32 v115, 0xffff0000, v116
    v_lshlrev_b32 v116, 16, v117
    v_and_b32 v117, 0xffff0000, v117
    v_and_b32 v120, s25, v120
    v_and_b32 v121, s25, v121
    v_lshlrev_b32 v118, 16, v120
    v_and_b32 v119, 0xffff0000, v120
    v_lshlrev_b32 v120, 16, v121
    v_and_b32 v121, 0xffff0000, v121
    v_and_b32 v124, s25, v124
    v_and_b32 v125, s25, v125
    v_lshlrev_b32 v122, 16, v124
    v_and_b32 v123, 0xffff0000, v124
    v_lshlrev_b32 v124, 16, v125
    v_and_b32 v125, 0xffff0000, v125
    s_cmp_lg_u32 s20, 0
    s_cbranch_scc1 fr_h_pd
    s_lshr_b32 s24, s42, 1
    v_and_b32 v127, 15, v0
    s_lshl_b32 s25, s24, 4
    v_add_u32 v127, s25, v127
    v_lshlrev_b32 v127, 7, v127
    v_add_u32 v127, 34668544, v127
    s_add_u32 s25, s24, 240
    s_lshl_b32 s25, s25, 7
    s_add_u32 s25, s25, 34603008
    v_mov_b32 v14, s25
    v_cmp_gt_u32 vcc, 16, v0
    s_nop 1
    v_cndmask_b32 v127, v14, v127, vcc
    s_mov_b32 s32, 0x40000
fr_h_pl:
    buffer_load_dwordx4 v[6:9], v127, s[8:11], 0 offen sc1
    s_waitcnt vmcnt(0)
    v_xor_b32 v6, s95, v6
    v_xor_b32 v7, s95, v7
    v_xor_b32 v8, s95, v8
    v_xor_b32 v9, s95, v9
    v_or3_b32 v6, v6, v7, v8
    v_or_b32 v6, v6, v9
    v_cmp_ne_u32 vcc, 0, v6
    s_nop 4
    s_cbranch_vccz fr_h_pd
    s_sleep 4
    s_sub_u32 s32, s32, 1
    s_cmp_lg_u32 s32, 0
    s_cbranch_scc1 fr_h_pl
fr_h_pd:
    s_barrier
    buffer_load_dword v126, v126, s[8:11], 0 offen sc1
    buffer_load_dwordx4 v[6:9], v2, s[8:11], s21 offen offset:0 sc1
    buffer_load_dwordx4 v[10:13], v2, s[8:11], s21 offen offset:1024 sc1
    s_add_u32 s83, s83, 1
    s_cmp_eq_u32 s83, 24
    s_cselect_b32 s83, 0, s83
    s_cselect_b32 s32, 98304, 0
    s_add_u32 s21, s21, 4096
    s_sub_u32 s21, s21, s32
    buffer_load_dwordx4 v[14:17], v2, s[8:11], s21 offen offset:0 sc1
    buffer_load_dwordx4 v[18:21], v2, s[8:11], s21 offen offset:1024 sc1
    s_add_u32 s83, s83, 1
    s_cmp_eq_u32 s83, 24
    s_cselect_b32 s83, 0, s83
    s_cselect_b32 s32, 98304, 0
    s_add_u32 s21, s21, 4096
    s_sub_u32 s21, s21, s32
    buffer_load_dwordx4 v[22:25], v2, s[8:11], s21 offen offset:0 sc1
    buffer_load_dwordx4 v[26:29], v2, s[8:11], s21 offen offset:1024 sc1
    s_add_u32 s83, s83, 1
    s_cmp_eq_u32 s83, 24
    s_cselect_b32 s83, 0, s83
    s_cselect_b32 s32, 98304, 0
    s_add_u32 s21, s21, 4096
    s_sub_u32 s21, s21, s32
    buffer_load_dwordx4 v[30:33], v2, s[8:11], s21 offen offset:0 sc1
    buffer_load_dwordx4 v[34:37], v2, s[8:11], s21 offen offset:1024 sc1
    s_add_u32 s83, s83, 1
    s_cmp_eq_u32 s83, 24
    s_cselect_b32 s83, 0, s83
    s_cselect_b32 s32, 98304, 0
    s_add_u32 s21, s21, 4096
    s_sub_u32 s21, s21, s32
    buffer_load_dwordx4 v[38:41], v2, s[8:11], s21 offen offset:0 sc1
    buffer_load_dwordx4 v[42:45], v2, s[8:11], s21 offen offset:1024 sc1
    s_add_u32 s83, s83, 1
    s_cmp_eq_u32 s83, 24
    s_cselect_b32 s83, 0, s83
    s_cselect_b32 s32, 98304, 0
    s_add_u32 s21, s21, 4096
    s_sub_u32 s21, s21, s32
    buffer_load_dwordx4 v[46:49], v2, s[8:11], s21 offen offset:0 sc1
    buffer_load_dwordx4 v[50:53], v2, s[8:11], s21 offen offset:1024 sc1
    s_add_u32 s83, s83, 1
    s_cmp_eq_u32 s83, 24
    s_cselect_b32 s83, 0, s83
    s_cselect_b32 s32, 98304, 0
    s_add_u32 s21, s21, 4096
    s_sub_u32 s21, s21, s32
    s_barrier
    s_setprio 0
    ds_read_b64_tr_b16 v[54:55], v5 offset:0
    ds_read_b64_tr_b16 v[56:57], v5 offset:1536
    ds_read_b64_tr_b16 v[58:59], v5 offset:64
    ds_read_b64_tr_b16 v[60:61], v5 offset:1600
    ds_read_b64_tr_b16 v[62:63], v5 offset:128
    ds_read_b64_tr_b16 v[64:65], v5 offset:1664
    s_mov_b32 s37, 3
fr_f2l:
    s_waitcnt vmcnt(11) lgkmcnt(0)
    v_mfma_f32_32x32x16_bf16 v[78:93], v[54:57], v[6:9], v[78:93]
    ds_read_b64_tr_b16 v[66:67], v5 offset:3072
    ds_read_b64_tr_b16 v[68:69], v5 offset:4608
    v_mfma_f32_32x32x16_bf16 v[94:109], v[58:61], v[6:9], v[94:109]
    ds_read_b64_tr_b16 v[70:71], v5 offset:3136
    ds_read_b64_tr_b16 v[72:73], v5 offset:4672
    v_mfma_f32_32x32x16_bf16 v[110:125], v[62:65], v[6:9], v[110:125]
    ds_read_b64_tr_b16 v[74:75], v5 offset:3200
    ds_read_b64_tr_b16 v[76:77], v5 offset:4736
    buffer_load_dwordx4 v[6:9], v2, s[8:11], s21 offen offset:0 sc1
    s_add_u32 s36, s36, 12288
    s_cmp_ge_u32 s36, 73728
    s_cselect_b32 s38, 73728, 0
    s_sub_u32 s36, s36, s38
    s_sub_u32 s38, 12288, s38
    v_add_u32 v5, s38, v5
    s_waitcnt vmcnt(11) lgkmcnt(0)
    s_barrier
    v_mfma_f32_32x32x16_bf16 v[78:93], v[66:69], v[10:13], v[78:93]
    ds_read_b64_tr_b16 v[54:55], v5 offset:0
    ds_read_b64_tr_b16 v[56:57], v5 offset:1536
    v_mfma_f32_32x32x16_bf16 v[94:109], v[70:73], v[10:13], v[94:109]
    ds_read_b64_tr_b16 v[58:59], v5 offset:64
    ds_read_b64_tr_b16 v[60:61], v5 offset:1600
    v_mfma_f32_32x32x16_bf16 v[110:125], v[74:77], v[10:13], v[110:125]
    ds_read_b64_tr_b16 v[62:63], v5 offset:128
    ds_read_b64_tr_b16 v[64:65], v5 offset:1664
    buffer_load_dwordx4 v[10:13], v2, s[8:11], s21 offen offset:1024 sc1
    s_add_u32 s83, s83, 1
    s_cmp_eq_u32 s83, 24
    s_cselect_b32 s83, 0, s83
    s_cselect_b32 s32, 98304, 0
    s_add_u32 s21, s21, 4096
    s_sub_u32 s21, s21, s32
    s_waitcnt vmcnt(11) lgkmcnt(0)
    v_mfma_f32_32x32x16_bf16 v[78:93], v[54:57], v[14:17], v[78:93]
    ds_read_b64_tr_b16 v[66:67], v5 offset:3072
    ds_read_b64_tr_b16 v[68:69], v5 offset:4608
    v_mfma_f32_32x32x16_bf16 v[94:109], v[58:61], v[14:17], v[94:109]
    ds_read_b64_tr_b16 v[70:71], v5 offset:3136
    ds_read_b64_tr_b16 v[72:73], v5 offset:4672
    v_mfma_f32_32x32x16_bf16 v[110:125], v[62:65], v[14:17], v[110:125]
    ds_read_b64_tr_b16 v[74:75], v5 offset:3200
    ds_read_b64_tr_b16 v[76:77], v5 offset:4736
    buffer_load_dwordx4 v[14:17], v2, s[8:11], s21 offen offset:0 sc1
    s_add_u32 s36, s36, 12288
    s_cmp_ge_u32 s36, 73728
    s_cselect_b32 s38, 73728, 0
    s_sub_u32 s36, s36, s38
    s_sub_u32 s38, 12288, s38
    v_add_u32 v5, s38, v5
    s_waitcnt vmcnt(11) lgkmcnt(0)
    s_barrier
    v_mfma_f32_32x32x16_bf16 v[78:93], v[66:69], v[18:21], v[78:93]
    ds_read_b64_tr_b16 v[54:55], v5 offset:0
    ds_read_b64_tr_b16 v[56:57], v5 offset:1536
    v_mfma_f32_32x32x16_bf16 v[94:109], v[70:73], v[18:21], v[94:109]
    ds_read_b64_tr_b16 v[58:59], v5 offset:64
    ds_read_b64_tr_b16 v[60:61], v5 offset:1600
    v_mfma_f32_32x32x16_bf16 v[110:125], v[74:77], v[18:21], v[110:125]
    ds_read_b64_tr_b16 v[62:63], v5 offset:128
    ds_read_b64_tr_b16 v[64:65], v5 offset:1664
    buffer_load_dwordx4 v[18:21], v2, s[8:11], s21 offen offset:1024 sc1
    s_add_u32 s83, s83, 1
    s_cmp_eq_u32 s83, 24
    s_cselect_b32 s83, 0, s83
    s_cselect_b32 s32, 98304, 0
    s_add_u32 s21, s21, 4096
    s_sub_u32 s21, s21, s32
    s_waitcnt vmcnt(11) lgkmcnt(0)
    v_mfma_f32_32x32x16_bf16 v[78:93], v[54:57], v[22:25], v[78:93]
    ds_read_b64_tr_b16 v[66:67], v5 offset:3072
    ds_read_b64_tr_b16 v[68:69], v5 offset:4608
    v_mfma_f32_32x32x16_bf16 v[94:109], v[58:61], v[22:25], v[94:109]
    ds_read_b64_tr_b16 v[70:71], v5 offset:3136
    ds_read_b64_tr_b16 v[72:73], v5 offset:4672
    v_mfma_f32_32x32x16_bf16 v[110:125], v[62:65], v[22:25], v[110:125]
    ds_read_b64_tr_b16 v[74:75], v5 offset:3200
    ds_read_b64_tr_b16 v[76:77], v5 offset:4736
    buffer_load_dwordx4 v[22:25], v2, s[8:11], s21 offen offset:0 sc1
    s_add_u32 s36, s36, 12288
    s_cmp_ge_u32 s36, 73728
    s_cselect_b32 s38, 73728, 0
    s_sub_u32 s36, s36, s38
    s_sub_u32 s38, 12288, s38
    v_add_u32 v5, s38, v5
    s_waitcnt vmcnt(11) lgkmcnt(0)
    s_barrier
    v_mfma_f32_32x32x16_bf16 v[78:93], v[66:69], v[26:29], v[78:93]
    ds_read_b64_tr_b16 v[54:55], v5 offset:0
    ds_read_b64_tr_b16 v[56:57], v5 offset:1536
    v_mfma_f32_32x32x16_bf16 v[94:109], v[70:73], v[26:29], v[94:109]
    ds_read_b64_tr_b16 v[58:59], v5 offset:64
    ds_read_b64_tr_b16 v[60:61], v5 offset:1600
    v_mfma_f32_32x32x16_bf16 v[110:125], v[74:77], v[26:29], v[110:125]
    ds_read_b64_tr_b16 v[62:63], v5 offset:128
    ds_read_b64_tr_b16 v[64:65], v5 offset:1664
    buffer_load_dwordx4 v[26:29], v2, s[8:11], s21 offen offset:1024 sc1
    s_add_u32 s83, s83, 1
    s_cmp_eq_u32 s83, 24
    s_cselect_b32 s83, 0, s83
    s_cselect_b32 s32, 98304, 0
    s_add_u32 s21, s21, 4096
    s_sub_u32 s21, s21, s32
    s_waitcnt vmcnt(11) lgkmcnt(0)
    v_mfma_f32_32x32x16_bf16 v[78:93], v[54:57], v[30:33], v[78:93]
    ds_read_b64_tr_b16 v[66:67], v5 offset:3072
    ds_read_b64_tr_b16 v[68:69], v5 offset:4608
    v_mfma_f32_32x32x16_bf16 v[94:109], v[58:61], v[30:33], v[94:109]
    ds_read_b64_tr_b16 v[70:71], v5 offset:3136
    ds_read_b64_tr_b16 v[72:73], v5 offset:4672
    v_mfma_f32_32x32x16_bf16 v[110:125], v[62:65], v[30:33], v[110:125]
    ds_read_b64_tr_b16 v[74:75], v5 offset:3200
    ds_read_b64_tr_b16 v[76:77], v5 offset:4736
    buffer_load_dwordx4 v[30:33], v2, s[8:11], s21 offen offset:0 sc1
    s_add_u32 s36, s36, 12288
    s_cmp_ge_u32 s36, 73728
    s_cselect_b32 s38, 73728, 0
    s_sub_u32 s36, s36, s38
    s_sub_u32 s38, 12288, s38
    v_add_u32 v5, s38, v5
    s_waitcnt vmcnt(11) lgkmcnt(0)
    s_barrier
    v_mfma_f32_32x32x16_bf16 v[78:93], v[66:69], v[34:37], v[78:93]
    ds_read_b64_tr_b16 v[54:55], v5 offset:0
    ds_read_b64_tr_b16 v[56:57], v5 offset:1536
    v_mfma_f32_32x32x16_bf16 v[94:109], v[70:73], v[34:37], v[94:109]
    ds_read_b64_tr_b16 v[58:59], v5 offset:64
    ds_read_b64_tr_b16 v[60:61], v5 offset:1600
    v_mfma_f32_32x32x16_bf16 v[110:125], v[74:77], v[34:37], v[110:125]
    ds_read_b64_tr_b16 v[62:63], v5 offset:128
    ds_read_b64_tr_b16 v[64:65], v5 offset:1664
    buffer_load_dwordx4 v[34:37], v2, s[8:11], s21 offen offset:1024 sc1
    s_add_u32 s83, s83, 1
    s_cmp_eq_u32 s83, 24
    s_cselect_b32 s83, 0, s83
    s_cselect_b32 s32, 98304, 0
    s_add_u32 s21, s21, 4096
    s_sub_u32 s21, s21, s32
    s_waitcnt vmcnt(11) lgkmcnt(0)
    v_mfma_f32_32x32x16_bf16 v[78:93], v[54:57], v[38:41], v[78:93]
    ds_read_b64_tr_b16 v[66:67], v5 offset:3072
    ds_read_b64_tr_b16 v[68:69], v5 offset:4608
    v_mfma_f32_32x32x16_bf16 v[94:109], v[58:61], v[38:41], v[94:109]
    ds_read_b64_tr_b16 v[70:71], v5 offset:3136
    ds_read_b64_tr_b16 v[72:73], v5 offset:4672
    v_mfma_f32_32x32x16_bf16 v[110:125], v[62:65], v[38:41], v[110:125]
    ds_read_b64_tr_b16 v[74:75], v5 offset:3200
    ds_read_b64_tr_b16 v[76:77], v5 offset:4736
    buffer_load_dwordx4 v[38:41], v2, s[8:11], s21 offen offset:0 sc1
    s_add_u32 s36, s36, 12288
    s_cmp_ge_u32 s36, 73728
    s_cselect_b32 s38, 73728, 0
    s_sub_u32 s36, s36, s38
    s_sub_u32 s38, 12288, s38
    v_add_u32 v5, s38, v5
    s_waitcnt vmcnt(11) lgkmcnt(0)
    s_barrier
    v_mfma_f32_32x32x16_bf16 v[78:93], v[66:69], v[42:45], v[78:93]
    ds_read_b64_tr_b16 v[54:55], v5 offset:0
    ds_read_b64_tr_b16 v[56:57], v5 offset:1536
    v_mfma_f32_32x32x16_bf16 v[94:109], v[70:73], v[42:45], v[94:109]
    ds_read_b64_tr_b16 v[58:59], v5 offset:64
    ds_read_b64_tr_b16 v[60:61], v5 offset:1600
    v_mfma_f32_32x32x16_bf16 v[110:125], v[74:77], v[42:45], v[110:125]
    ds_read_b64_tr_b16 v[62:63], v5 offset:128
    ds_read_b64_tr_b16 v[64:65], v5 offset:1664
    buffer_load_dwordx4 v[42:45], v2, s[8:11], s21 offen offset:1024 sc1
    s_add_u32 s83, s83, 1
    s_cmp_eq_u32 s83, 24
    s_cselect_b32 s83, 0, s83
    s_cselect_b32 s32, 98304, 0
    s_add_u32 s21, s21, 4096
    s_sub_u32 s21, s21, s32
    s_waitcnt vmcnt(11) lgkmcnt(0)
    v_mfma_f32_32x32x16_bf16 v[78:93], v[54:57], v[46:49], v[78:93]
    ds_read_b64_tr_b16 v[66:67], v5 offset:3072
    ds_read_b64_tr_b16 v[68:69], v5 offset:4608
    v_mfma_f32_32x32x16_bf16 v[94:109], v[58:61], v[46:49], v[94:109]
    ds_read_b64_tr_b16 v[70:71], v5 offset:3136
    ds_read_b64_tr_b16 v[72:73], v5 offset:4672
    v_mfma_f32_32x32x16_bf16 v[110:125], v[62:65], v[46:49], v[110:125]
    ds_read_b64_tr_b16 v[74:75], v5 offset:3200
    ds_read_b64_tr_b16 v[76:77], v5 offset:4736
    buffer_load_dwordx4 v[46:49], v2, s[8:11], s21 offen offset:0 sc1
    s_add_u32 s36, s36, 12288
    s_cmp_ge_u32 s36, 73728
    s_cselect_b32 s38, 73728, 0
    s_sub_u32 s36, s36, s38
    s_sub_u32 s38, 12288, s38
    v_add_u32 v5, s38, v5
    s_waitcnt vmcnt(11) lgkmcnt(0)
    s_barrier
    v_mfma_f32_32x32x16_bf16 v[78:93], v[66:69], v[50:53], v[78:93]
    ds_read_b64_tr_b16 v[54:55], v5 offset:0
    ds_read_b64_tr_b16 v[56:57], v5 offset:1536
    v_mfma_f32_32x32x16_bf16 v[94:109], v[70:73], v[50:53], v[94:109]
    ds_read_b64_tr_b16 v[58:59], v5 offset:64
    ds_read_b64_tr_b16 v[60:61], v5 offset:1600
    v_mfma_f32_32x32x16_bf16 v[110:125], v[74:77], v[50:53], v[110:125]
    ds_read_b64_tr_b16 v[62:63], v5 offset:128
    ds_read_b64_tr_b16 v[64:65], v5 offset:1664
    buffer_load_dwordx4 v[50:53], v2, s[8:11], s21 offen offset:1024 sc1
    s_add_u32 s83, s83, 1
    s_cmp_eq_u32 s83, 24
    s_cselect_b32 s83, 0, s83
    s_cselect_b32 s32, 98304, 0
    s_add_u32 s21, s21, 4096
    s_sub_u32 s21, s21, s32
    s_sub_u32 s37, s37, 1
    s_cmp_lg_u32 s37, 0
    s_cbranch_scc1 fr_f2l
    s_waitcnt vmcnt(11) lgkmcnt(0)
    v_mfma_f32_32x32x16_bf16 v[78:93], v[54:57], v[6:9], v[78:93]
    ds_read_b64_tr_b16 v[66:67], v5 offset:3072
    ds_read_b64_tr_b16 v[68:69], v5 offset:4608
    v_mfma_f32_32x32x16_bf16 v[94:109], v[58:61], v[6:9], v[94:109]
    ds_read_b64_tr_b16 v[70:71], v5 offset:3136
    ds_read_b64_tr_b16 v[72:73], v5 offset:4672
    v_mfma_f32_32x32x16_bf16 v[110:125], v[62:65], v[6:9], v[110:125]
    ds_read_b64_tr_b16 v[74:75], v5 offset:3200
    ds_read_b64_tr_b16 v[76:77], v5 offset:4736
    s_add_u32 s36, s36, 12288
    s_cmp_ge_u32 s36, 73728
    s_cselect_b32 s38, 73728, 0
    s_sub_u32 s36, s36, s38
    s_sub_u32 s38, 12288, s38
    v_add_u32 v5, s38, v5
    s_waitcnt vmcnt(10) lgkmcnt(0)
    s_barrier
    v_mfma_f32_32x32x16_bf16 v[78:93], v[66:69], v[10:13], v[78:93]
    ds_read_b64_tr_b16 v[54:55], v5 offset:0
    ds_read_b64_tr_b16 v[56:57], v5 offset:1536
    v_mfma_f32_32x32x16_bf16 v[94:109], v[70:73], v[10:13], v[94:109]
    ds_read_b64_tr_b16 v[58:59], v5 offset:64
    ds_read_b64_tr_b16 v[60:61], v5 offset:1600
    v_mfma_f32_32x32x16_bf16 v[110:125], v[74:77], v[10:13], v[110:125]
    ds_read_b64_tr_b16 v[62:63], v5 offset:128
    ds_read_b64_tr_b16 v[64:65], v5 offset:1664
    s_waitcnt vmcnt(9) lgkmcnt(0)
    v_mfma_f32_32x32x16_bf16 v[78:93], v[54:57], v[14:17], v[78:93]
    ds_read_b64_tr_b16 v[66:67], v5 offset:3072
    ds_read_b64_tr_b16 v[68:69], v5 offset:4608
    v_mfma_f32_32x32x16_bf16 v[94:109], v[58:61], v[14:17], v[94:109]
    ds_read_b64_tr_b16 v[70:71], v5 offset:3136
    ds_read_b64_tr_b16 v[72:73], v5 offset:4672
    v_mfma_f32_32x32x16_bf16 v[110:125], v[62:65], v[14:17], v[110:125]
    ds_read_b64_tr_b16 v[74:75], v5 offset:3200
    ds_read_b64_tr_b16 v[76:77], v5 offset:4736
    s_add_u32 s36, s36, 12288
    s_cmp_ge_u32 s36, 73728
    s_cselect_b32 s38, 73728, 0
    s_sub_u32 s36, s36, s38
    s_sub_u32 s38, 12288, s38
    v_add_u32 v5, s38, v5
    s_waitcnt vmcnt(8) lgkmcnt(0)
    s_barrier
    v_mfma_f32_32x32x16_bf16 v[78:93], v[66:69], v[18:21], v[78:93]
    ds_read_b64_tr_b16 v[54:55], v5 offset:0
    ds_read_b64_tr_b16 v[56:57], v5 offset:1536
    v_mfma_f32_32x32x16_bf16 v[94:109], v[70:73], v[18:21], v[94:109]
    ds_read_b64_tr_b16 v[58:59], v5 offset:64
    ds_read_b64_tr_b16 v[60:61], v5 offset:1600
    v_mfma_f32_32x32x16_bf16 v[110:125], v[74:77], v[18:21], v[110:125]
    ds_read_b64_tr_b16 v[62:63], v5 offset:128
    ds_read_b64_tr_b16 v[64:65], v5 offset:1664
    s_waitcnt vmcnt(7) lgkmcnt(0)
    v_mfma_f32_32x32x16_bf16 v[78:93], v[54:57], v[22:25], v[78:93]
    ds_read_b64_tr_b16 v[66:67], v5 offset:3072
    ds_read_b64_tr_b16 v[68:69], v5 offset:4608
    v_mfma_f32_32x32x16_bf16 v[94:109], v[58:61], v[22:25], v[94:109]
    ds_read_b64_tr_b16 v[70:71], v5 offset:3136
    ds_read_b64_tr_b16 v[72:73], v5 offset:4672
    v_mfma_f32_32x32x16_bf16 v[110:125], v[62:65], v[22:25], v[110:125]
    ds_read_b64_tr_b16 v[74:75], v5 offset:3200
    ds_read_b64_tr_b16 v[76:77], v5 offset:4736
    s_add_u32 s36, s36, 12288
    s_cmp_ge_u32 s36, 73728
    s_cselect_b32 s38, 73728, 0
    s_sub_u32 s36, s36, s38
    s_sub_u32 s38, 12288, s38
    v_add_u32 v5, s38, v5
    s_waitcnt vmcnt(6) lgkmcnt(0)
    s_barrier
    v_mfma_f32_32x32x16_bf16 v[78:93], v[66:69], v[26:29], v[78:93]
    ds_read_b64_tr_b16 v[54:55], v5 offset:0
    ds_read_b64_tr_b16 v[56:57], v5 offset:1536
    v_mfma_f32_32x32x16_bf16 v[94:109], v[70:73], v[26:29], v[94:109]
    ds_read_b64_tr_b16 v[58:59], v5 offset:64
    ds_read_b64_tr_b16 v[60:61], v5 offset:1600
    v_mfma_f32_32x32x16_bf16 v[110:125], v[74:77], v[26:29], v[110:125]
    ds_read_b64_tr_b16 v[62:63], v5 offset:128
    ds_read_b64_tr_b16 v[64:65], v5 offset:1664
    s_waitcnt vmcnt(5) lgkmcnt(0)
    v_mfma_f32_32x32x16_bf16 v[78:93], v[54:57], v[30:33], v[78:93]
    ds_read_b64_tr_b16 v[66:67], v5 offset:3072
    ds_read_b64_tr_b16 v[68:69], v5 offset:4608
    v_mfma_f32_32x32x16_bf16 v[94:109], v[58:61], v[30:33], v[94:109]
    ds_read_b64_tr_b16 v[70:71], v5 offset:3136
    ds_read_b64_tr_b16 v[72:73], v5 offset:4672
    v_mfma_f32_32x32x16_bf16 v[110:125], v[62:65], v[30:33], v[110:125]
    ds_read_b64_tr_b16 v[74:75], v5 offset:3200
    ds_read_b64_tr_b16 v[76:77], v5 offset:4736
    s_add_u32 s36, s36, 12288
    s_cmp_ge_u32 s36, 73728
    s_cselect_b32 s38, 73728, 0
    s_sub_u32 s36, s36, s38
    s_sub_u32 s38, 12288, s38
    v_add_u32 v5, s38, v5
    s_waitcnt vmcnt(4) lgkmcnt(0)
    s_barrier
    v_mfma_f32_32x32x16_bf16 v[78:93], v[66:69], v[34:37], v[78:93]
    ds_read_b64_tr_b16 v[54:55], v5 offset:0
    ds_read_b64_tr_b16 v[56:57], v5 offset:1536
    v_mfma_f32_32x32x16_bf16 v[94:109], v[70:73], v[34:37], v[94:109]
    ds_read_b64_tr_b16 v[58:59], v5 offset:64
    ds_read_b64_tr_b16 v[60:61], v5 offset:1600
    v_mfma_f32_32x32x16_bf16 v[110:125], v[74:77], v[34:37], v[110:125]
    ds_read_b64_tr_b16 v[62:63], v5 offset:128
    ds_read_b64_tr_b16 v[64:65], v5 offset:1664
    s_waitcnt vmcnt(3) lgkmcnt(0)
    v_mfma_f32_32x32x16_bf16 v[78:93], v[54:57], v[38:41], v[78:93]
    ds_read_b64_tr_b16 v[66:67], v5 offset:3072
    ds_read_b64_tr_b16 v[68:69], v5 offset:4608
    v_mfma_f32_32x32x16_bf16 v[94:109], v[58:61], v[38:41], v[94:109]
    ds_read_b64_tr_b16 v[70:71], v5 offset:3136
    ds_read_b64_tr_b16 v[72:73], v5 offset:4672
    v_mfma_f32_32x32x16_bf16 v[110:125], v[62:65], v[38:41], v[110:125]
    ds_read_b64_tr_b16 v[74:75], v5 offset:3200
    ds_read_b64_tr_b16 v[76:77], v5 offset:4736
    s_add_u32 s36, s36, 12288
    s_cmp_ge_u32 s36, 73728
    s_cselect_b32 s38, 73728, 0
    s_sub_u32 s36, s36, s38
    s_sub_u32 s38, 12288, s38
    v_add_u32 v5, s38, v5
    s_waitcnt vmcnt(2) lgkmcnt(0)
    s_barrier
    v_mfma_f32_32x32x16_bf16 v[78:93], v[66:69], v[42:45], v[78:93]
    ds_read_b64_tr_b16 v[54:55], v5 offset:0
    ds_read_b64_tr_b16 v[56:57], v5 offset:1536
    v_mfma_f32_32x32x16_bf16 v[94:109], v[70:73], v[42:45], v[94:109]
    ds_read_b64_tr_b16 v[58:59], v5 offset:64
    ds_read_b64_tr_b16 v[60:61], v5 offset:1600
    v_mfma_f32_32x32x16_bf16 v[110:125], v[74:77], v[42:45], v[110:125]
    ds_read_b64_tr_b16 v[62:63], v5 offset:128
    ds_read_b64_tr_b16 v[64:65], v5 offset:1664
    s_waitcnt vmcnt(1) lgkmcnt(0)
    v_mfma_f32_32x32x16_bf16 v[78:93], v[54:57], v[46:49], v[78:93]
    ds_read_b64_tr_b16 v[66:67], v5 offset:3072
    ds_read_b64_tr_b16 v[68:69], v5 offset:4608
    v_mfma_f32_32x32x16_bf16 v[94:109], v[58:61], v[46:49], v[94:109]
    ds_read_b64_tr_b16 v[70:71], v5 offset:3136
    ds_read_b64_tr_b16 v[72:73], v5 offset:4672
    v_mfma_f32_32x32x16_bf16 v[110:125], v[62:65], v[46:49], v[110:125]
    ds_read_b64_tr_b16 v[74:75], v5 offset:3200
    ds_read_b64_tr_b16 v[76:77], v5 offset:4736
    s_waitcnt vmcnt(0) lgkmcnt(0)
    v_mfma_f32_32x32x16_bf16 v[78:93], v[66:69], v[50:53], v[78:93]
    v_mfma_f32_32x32x16_bf16 v[94:109], v[70:73], v[50:53], v[94:109]
    v_mfma_f32_32x32x16_bf16 v[110:125], v[74:77], v[50:53], v[110:125]
    s_barrier
    s_setprio 3
    v_sub_f32 v126, 1.0, v126
    v_cvt_pk_bf16_f32 v126, v126, v126
    v_lshlrev_b32 v126, 16, v126
    s_nop 7
    s_nop 3
    v_mul_f32 v78, v78, v126
    v_mul_f32 v79, v79, v126
    v_mul_f32 v80, v80, v126
    v_mul_f32 v81, v81, v126
    v_mul_f32 v82, v82, v126
    v_mul_f32 v83, v83, v126
    v_mul_f32 v84, v84, v126
    v_mul_f32 v85, v85, v126
    v_mul_f32 v86, v86, v126
    v_mul_f32 v87, v87, v126
    v_mul_f32 v88, v88, v126
    v_mul_f32 v89, v89, v126
    v_mul_f32 v90, v90, v126
    v_mul_f32 v91, v91, v126
    v_mul_f32 v92, v92, v126
    v_mul_f32 v93, v93, v126
    v_mul_f32 v94, v94, v126
    v_mul_f32 v95, v95, v126
    v_mul_f32 v96, v96, v126
    v_mul_f32 v97, v97, v126
    v_mul_f32 v98, v98, v126
    v_mul_f32 v99, v99, v126
    v_mul_f32 v100, v100, v126
    v_mul_f32 v101, v101, v126
    v_mul_f32 v102, v102, v126
    v_mul_f32 v103, v103, v126
    v_mul_f32 v104, v104, v126
    v_mul_f32 v105, v105, v126
    v_mul_f32 v106, v106, v126
    v_mul_f32 v107, v107, v126
    v_mul_f32 v108, v108, v126
    v_mul_f32 v109, v109, v126
    v_mul_f32 v110, v110, v126
    v_mul_f32 v111, v111, v126
    v_mul_f32 v112, v112, v126
    v_mul_f32 v113, v113, v126
    v_mul_f32 v114, v114, v126
    v_mul_f32 v115, v115, v126
    v_mul_f32 v116, v116, v126
    v_mul_f32 v117, v117, v126
    v_mul_f32 v118, v118, v126
    v_mul_f32 v119, v119, v126
    v_mul_f32 v120, v120, v126
    v_mul_f32 v121, v121, v126
    v_mul_f32 v122, v122, v126
    v_mul_f32 v123, v123, v126
    v_mul_f32 v124, v124, v126
    v_mul_f32 v125, v125, v126
    v_lshrrev_b32 v54, 4, v0
    v_and_b32 v55, 15, v0
    v_lshrrev_b32 v56, 2, v55
    v_and_b32 v55, 3, v55
    v_lshrrev_b32 v57, 1, v54
    v_and_b32 v54, 1, v54
    v_lshlrev_b32 v54, 5, v54
    v_lshlrev_b32 v55, 3, v55
    v_add_u32 v54, v54, v55
    v_lshl_add_u32 v4, v57, 2, v56
    v_mul_u32_u24 v4, 192, v4
    v_add_u32 v4, v4, v54
    v_mul_u32_u24 v3, 40, v57
    v_add_u32 v3, v3, v56
    v_mul_u32_u24 v3, 192, v3
    v_add_u32 v3, v3, v54
    s_cmp_eq_u32 s7, 0
    s_cselect_b32 s86, 0, 0
    s_cselect_b32 s25, 0, 15360
    s_add_u32 s86, s86, s25
    s_cmp_eq_u32 s7, 0
    s_cselect_b32 s87, 30720, 0
    s_cselect_b32 s25, 0, 46080
    s_add_u32 s87, s87, s25
    s_cmp_eq_u32 s7, 0
    s_cselect_b32 s88, 61440, 0
    s_cselect_b32 s25, 0, 0
    s_add_u32 s88, s88, s25
    s_cmp_eq_u32 s7, 0
    s_cselect_b32 s89, 15360, 0
    s_cselect_b32 s25, 0, 30720
    s_add_u32 s89, s89, s25
    s_add_u32 s25, s7, s82
    s_add_u32 s25, s25, 0
    s_and_b32 s25, s25, 7
    s_lshl_b32 s25, s25, 2
    s_lshl_b32 s26, s47, 5
    s_add_u32 s90, s25, s26
    s_add_u32 s25, s7, s82
    s_add_u32 s25, s25, 2
    s_and_b32 s25, s25, 7
    s_lshl_b32 s25, s25, 2
    s_lshl_b32 s26, s47, 5
    s_add_u32 s91, s25, s26
    s_add_u32 s25, s7, s82
    s_add_u32 s25, s25, 4
    s_and_b32 s25, s25, 7
    s_lshl_b32 s25, s25, 2
    s_lshl_b32 s26, s47, 5
    s_add_u32 s92, s25, s26
    s_add_u32 s25, s7, s82
    s_add_u32 s25, s25, 6
    s_and_b32 s25, s25, 7
    s_lshl_b32 s25, s25, 2
    s_lshl_b32 s26, s47, 5
    s_add_u32 s93, s25, s26
    v_lshrrev_b32 v127, 5, v0
    v_lshlrev_b32 v5, 9, v127
    v_and_b32 v54, 31, v0
    v_lshl_add_u32 v5, v54, 3, v5
    s_lshl_b32 s25, s47, 5
    v_add_u32 v126, s25, v54
    v_mul_u32_u24 v126, 1280, v126
    v_lshl_add_u32 v126, v127, 4, v126
    s_mul_i32 s85, s43, 192
    s_lshl_b32 s25, s7, 5
    s_add_u32 s85, s85, s25
    s_setprio 0
    s_cmp_lg_u32 s20, 0
    s_cbranch_scc1 fr_o_pd
    s_lshl_b32 s24, s42, 6
    v_add_u32 v51, s24, v0
    v_lshlrev_b32 v51, 7, v51
    v_add_u32 v51, 34734080, v51
    s_mov_b32 s32, 0x40000
fr_o_pl:
    buffer_load_dword v50, v51, s[8:11], 0 offen sc1
    s_waitcnt vmcnt(0)
    v_xor_b32 v50, s95, v50
    v_cmp_ne_u32 vcc, 0, v50
    s_nop 4
    s_cbranch_vccz fr_o_pd
    s_sleep 4
    s_sub_u32 s32, s32, 1
    s_cmp_lg_u32 s32, 0
    s_cbranch_scc1 fr_o_pl
fr_o_pd:
    s_barrier
    s_setprio 3
    s_lshl_b32 s28, s90, 10
    s_add_u32 s28, s28, 7864320
    s_lshl_b32 s29, s90, 8
    s_add_u32 s29, s29, 9961472
    buffer_load_dwordx4 v[6:9], v2, s[8:11], s28 offen offset:0 sc1
    buffer_load_dwordx4 v[10:13], v2, s[8:11], s28 offen offset:1024 sc1
    buffer_load_dwordx4 v[14:17], v2, s[8:11], s28 offen offset:2048 sc1
    buffer_load_dwordx4 v[18:21], v2, s[8:11], s28 offen offset:3072 sc1
    buffer_load_dwordx2 v[22:23], v5, s[8:11], s29 offen sc1
    buffer_load_dwordx2 v[24:25], v5, s[8:11], s29 offen offset:256 sc1
    s_lshl_b32 s28, s91, 10
    s_add_u32 s28, s28, 7864320
    s_lshl_b32 s29, s91, 8
    s_add_u32 s29, s29, 9961472
    buffer_load_dwordx4 v[26:29], v2, s[8:11], s28 offen offset:0 sc1
    buffer_load_dwordx4 v[30:33], v2, s[8:11], s28 offen offset:1024 sc1
    buffer_load_dwordx4 v[34:37], v2, s[8:11], s28 offen offset:2048 sc1
    buffer_load_dwordx4 v[38:41], v2, s[8:11], s28 offen offset:3072 sc1
    buffer_load_dwordx2 v[42:43], v5, s[8:11], s29 offen sc1
    buffer_load_dwordx2 v[44:45], v5, s[8:11], s29 offen offset:256 sc1
    s_lshl_b32 s28, s92, 10
    s_add_u32 s28, s28, 7864320
    s_lshl_b32 s29, s92, 8
    s_add_u32 s29, s29, 9961472
    buffer_load_dwordx4 v[46:49], v2, s[8:11], s28 offen offset:0 sc1
    buffer_load_dwordx4 v[50:53], v2, s[8:11], s28 offen offset:1024 sc1
    v_add_u32 v1, s86, v3
    v_add_u32 v127, s86, v4
    ds_read_b64_tr_b16 v[54:55], v127 offset:0
    ds_read_b64_tr_b16 v[56:57], v127 offset:1536
    ds_read_b64_tr_b16 v[58:59], v127 offset:64
    ds_read_b64_tr_b16 v[60:61], v127 offset:1600
    ds_read_b64_tr_b16 v[62:63], v127 offset:128
    ds_read_b64_tr_b16 v[64:65], v127 offset:1664
    s_waitcnt vmcnt(13) lgkmcnt(0)
    v_mfma_f32_32x32x16_bf16 v[78:93], v[54:57], v[6:9], v[78:93]
    ds_read_b64_tr_b16 v[66:67], v127 offset:3840
    ds_read_b64_tr_b16 v[68:69], v127 offset:5376
    v_mfma_f32_32x32x16_bf16 v[94:109], v[58:61], v[6:9], v[94:109]
    ds_read_b64_tr_b16 v[70:71], v127 offset:3904
    ds_read_b64_tr_b16 v[72:73], v127 offset:5440
    v_mfma_f32_32x32x16_bf16 v[110:125], v[62:65], v[6:9], v[110:125]
    ds_read_b64_tr_b16 v[74:75], v127 offset:3968
    ds_read_b64_tr_b16 v[76:77], v127 offset:5504
    buffer_load_dwordx4 v[6:9], v2, s[8:11], s28 offen offset:2048 sc1
    s_waitcnt vmcnt(13) lgkmcnt(0)
    v_mfma_f32_32x32x16_bf16 v[78:93], v[66:69], v[10:13], v[78:93]
    ds_read_b64_tr_b16 v[54:55], v127 offset:7680
    ds_read_b64_tr_b16 v[56:57], v127 offset:9216
    v_mfma_f32_32x32x16_bf16 v[94:109], v[70:73], v[10:13], v[94:109]
    ds_read_b64_tr_b16 v[58:59], v127 offset:7744
    ds_read_b64_tr_b16 v[60:61], v127 offset:9280
    v_mfma_f32_32x32x16_bf16 v[110:125], v[74:77], v[10:13], v[110:125]
    ds_read_b64_tr_b16 v[62:63], v127 offset:7808
    ds_read_b64_tr_b16 v[64:65], v127 offset:9344
    buffer_load_dwordx4 v[10:13], v2, s[8:11], s28 offen offset:3072 sc1
    s_waitcnt vmcnt(13) lgkmcnt(0)
    v_mfma_f32_32x32x16_bf16 v[78:93], v[54:57], v[14:17], v[78:93]
    ds_read_b64_tr_b16 v[66:67], v127 offset:11520
    ds_read_b64_tr_b16 v[68:69], v127 offset:13056
    v_mfma_f32_32x32x16_bf16 v[94:109], v[58:61], v[14:17], v[94:109]
    ds_read_b64_tr_b16 v[70:71], v127 offset:11584
    ds_read_b64_tr_b16 v[72:73], v127 offset:13120
    v_mfma_f32_32x32x16_bf16 v[110:125], v[62:65], v[14:17], v[110:125]
    ds_read_b64_tr_b16 v[74:75], v127 offset:11648
    ds_read_b64_tr_b16 v[76:77], v127 offset:13184
    buffer_load_dwordx2 v[14:15], v5, s[8:11], s29 offen sc1
    buffer_load_dwordx2 v[16:17], v5, s[8:11], s29 offen offset:256 sc1
    s_waitcnt vmcnt(14) lgkmcnt(0)
    v_mfma_f32_32x32x16_bf16 v[78:93], v[66:69], v[18:21], v[78:93]
    ds_read_b64_tr_b16 v[54:55], v1 offset:3072
    ds_read_b64_tr_b16 v[56:57], v1 offset:6912
    v_mfma_f32_32x32x16_bf16 v[94:109], v[70:73], v[18:21], v[94:109]
    ds_read_b64_tr_b16 v[58:59], v1 offset:3136
    ds_read_b64_tr_b16 v[60:61], v1 offset:6976
    v_mfma_f32_32x32x16_bf16 v[110:125], v[74:77], v[18:21], v[110:125]
    ds_read_b64_tr_b16 v[62:63], v1 offset:3200
    ds_read_b64_tr_b16 v[64:65], v1 offset:7040
    s_lshl_b32 s28, s93, 10
    s_add_u32 s28, s28, 7864320
    s_lshl_b32 s29, s93, 8
    s_add_u32 s29, s29, 9961472
    buffer_load_dwordx4 v[18:21], v2, s[8:11], s28 offen offset:0 sc1
    s_waitcnt vmcnt(13) lgkmcnt(0)
    s_barrier
    v_mfma_f32_32x32x16_bf16 v[78:93], v[54:57], v[22:25], v[78:93]
    v_add_u32 v127, s87, v4
    ds_read_b64_tr_b16 v[66:67], v127 offset:0
    ds_read_b64_tr_b16 v[68:69], v127 offset:1536
    v_mfma_f32_32x32x16_bf16 v[94:109], v[58:61], v[22:25], v[94:109]
    ds_read_b64_tr_b16 v[70:71], v127 offset:64
    ds_read_b64_tr_b16 v[72:73], v127 offset:1600
    v_mfma_f32_32x32x16_bf16 v[110:125], v[62:65], v[22:25], v[110:125]
    ds_read_b64_tr_b16 v[74:75], v127 offset:128
    ds_read_b64_tr_b16 v[76:77], v127 offset:1664
    v_add_u32 v1, s87, v3
    buffer_load_dwordx4 v[22:25], v2, s[8:11], s28 offen offset:1024 sc1
    s_waitcnt vmcnt(13) lgkmcnt(0)
    v_mfma_f32_32x32x16_bf16 v[78:93], v[66:69], v[26:29], v[78:93]
    ds_read_b64_tr_b16 v[54:55], v127 offset:3840
    ds_read_b64_tr_b16 v[56:57], v127 offset:5376
    v_mfma_f32_32x32x16_bf16 v[94:109], v[70:73], v[26:29], v[94:109]
    ds_read_b64_tr_b16 v[58:59], v127 offset:3904
    ds_read_b64_tr_b16 v[60:61], v127 offset:5440
    v_mfma_f32_32x32x16_bf16 v[110:125], v[74:77], v[26:29], v[110:125]
    ds_read_b64_tr_b16 v[62:63], v127 offset:3968
    ds_read_b64_tr_b16 v[64:65], v127 offset:5504
    buffer_load_dwordx4 v[26:29], v2, s[8:11], s28 offen offset:2048 sc1
    s_waitcnt vmcnt(13) lgkmcnt(0)
    v_mfma_f32_32x32x16_bf16 v[78:93], v[54:57], v[30:33], v[78:93]
    ds_read_b64_tr_b16 v[66:67], v127 offset:7680
    ds_read_b64_tr_b16 v[68:69], v127 offset:9216
    v_mfma_f32_32x32x16_bf16 v[94:109], v[58:61], v[30:33], v[94:109]
    ds_read_b64_tr_b16 v[70:71], v127 offset:7744
    ds_read_b64_tr_b16 v[72:73], v127 offset:9280
    v_mfma_f32_32x32x16_bf16 v[110:125], v[62:65], v[30:33], v[110:125]
    ds_read_b64_tr_b16 v[74:75], v127 offset:7808
    ds_read_b64_tr_b16 v[76:77], v127 offset:9344
    buffer_load_dwordx4 v[30:33], v2, s[8:11], s28 offen offset:3072 sc1
    s_waitcnt vmcnt(13) lgkmcnt(0)
    v_mfma_f32_32x32x16_bf16 v[78:93], v[66:69], v[34:37], v[78:93]
    ds_read_b64_tr_b16 v[54:55], v127 offset:11520
    ds_read_b64_tr_b16 v[56:57], v127 offset:13056
    v_mfma_f32_32x32x16_bf16 v[94:109], v[70:73], v[34:37], v[94:109]
    ds_read_b64_tr_b16 v[58:59], v127 offset:11584
    ds_read_b64_tr_b16 v[60:61], v127 offset:13120
    v_mfma_f32_32x32x16_bf16 v[110:125], v[74:77], v[34:37], v[110:125]
    ds_read_b64_tr_b16 v[62:63], v127 offset:11648
    ds_read_b64_tr_b16 v[64:65], v127 offset:13184
    buffer_load_dwordx2 v[34:35], v5, s[8:11], s29 offen sc1
    buffer_load_dwordx2 v[36:37], v5, s[8:11], s29 offen offset:256 sc1
    s_waitcnt vmcnt(14) lgkmcnt(0)
    v_mfma_f32_32x32x16_bf16 v[78:93], v[54:57], v[38:41], v[78:93]
    ds_read_b64_tr_b16 v[66:67], v1 offset:3072
    ds_read_b64_tr_b16 v[68:69], v1 offset:6912
    v_mfma_f32_32x32x16_bf16 v[94:109], v[58:61], v[38:41], v[94:109]
    ds_read_b64_tr_b16 v[70:71], v1 offset:3136
    ds_read_b64_tr_b16 v[72:73], v1 offset:6976
    v_mfma_f32_32x32x16_bf16 v[110:125], v[62:65], v[38:41], v[110:125]
    ds_read_b64_tr_b16 v[74:75], v1 offset:3200
    ds_read_b64_tr_b16 v[76:77], v1 offset:7040
    s_waitcnt vmcnt(12) lgkmcnt(0)
    s_barrier
    s_barrier
    v_mfma_f32_32x32x16_bf16 v[78:93], v[66:69], v[42:45], v[78:93]
    v_add_u32 v127, s88, v4
    ds_read_b64_tr_b16 v[54:55], v127 offset:0
    ds_read_b64_tr_b16 v[56:57], v127 offset:1536
    v_mfma_f32_32x32x16_bf16 v[94:109], v[70:73], v[42:45], v[94:109]
    ds_read_b64_tr_b16 v[58:59], v127 offset:64
    ds_read_b64_tr_b16 v[60:61], v127 offset:1600
    v_mfma_f32_32x32x16_bf16 v[110:125], v[74:77], v[42:45], v[110:125]
    ds_read_b64_tr_b16 v[62:63], v127 offset:128
    ds_read_b64_tr_b16 v[64:65], v127 offset:1664
    v_add_u32 v1, s88, v3
    s_waitcnt vmcnt(11) lgkmcnt(0)
    v_mfma_f32_32x32x16_bf16 v[78:93], v[54:57], v[46:49], v[78:93]
    ds_read_b64_tr_b16 v[66:67], v127 offset:3840
    ds_read_b64_tr_b16 v[68:69], v127 offset:5376
    v_mfma_f32_32x32x16_bf16 v[94:109], v[58:61], v[46:49], v[94:109]
    ds_read_b64_tr_b16 v[70:71], v127 offset:3904
    ds_read_b64_tr_b16 v[72:73], v127 offset:5440
    v_mfma_f32_32x32x16_bf16 v[110:125], v[62:65], v[46:49], v[110:125]
    ds_read_b64_tr_b16 v[74:75], v127 offset:3968
    ds_read_b64_tr_b16 v[76:77], v127 offset:5504
    s_waitcnt vmcnt(10) lgkmcnt(0)
    v_mfma_f32_32x32x16_bf16 v[78:93], v[66:69], v[50:53], v[78:93]
    ds_read_b64_tr_b16 v[54:55], v127 offset:7680
    ds_read_b64_tr_b16 v[56:57], v127 offset:9216
    v_mfma_f32_32x32x16_bf16 v[94:109], v[70:73], v[50:53], v[94:109]
    ds_read_b64_tr_b16 v[58:59], v127 offset:7744
    ds_read_b64_tr_b16 v[60:61], v127 offset:9280
    v_mfma_f32_32x32x16_bf16 v[110:125], v[74:77], v[50:53], v[110:125]
    ds_read_b64_tr_b16 v[62:63], v127 offset:7808
    ds_read_b64_tr_b16 v[64:65], v127 offset:9344
    s_waitcnt vmcnt(9) lgkmcnt(0)
    v_mfma_f32_32x32x16_bf16 v[78:93], v[54:57], v[6:9], v[78:93]
    ds_read_b64_tr_b16 v[66:67], v127 offset:11520
    ds_read_b64_tr_b16 v[68:69], v127 offset:13056
    v_mfma_f32_32x32x16_bf16 v[94:109], v[58:61], v[6:9], v[94:109]
    ds_read_b64_tr_b16 v[70:71], v127 offset:11584
    ds_read_b64_tr_b16 v[72:73], v127 offset:13120
    v_mfma_f32_32x32x16_bf16 v[110:125], v[62:65], v[6:9], v[110:125]
    ds_read_b64_tr_b16 v[74:75], v127 offset:11648
    ds_read_b64_tr_b16 v[76:77], v127 offset:13184
    s_waitcnt vmcnt(8) lgkmcnt(0)
    v_mfma_f32_32x32x16_bf16 v[78:93], v[66:69], v[10:13], v[78:93]
    ds_read_b64_tr_b16 v[54:55], v1 offset:3072
    ds_read_b64_tr_b16 v[56:57], v1 offset:6912
    v_mfma_f32_32x32x16_bf16 v[94:109], v[70:73], v[10:13], v[94:109]
    ds_read_b64_tr_b16 v[58:59], v1 offset:3136
    ds_read_b64_tr_b16 v[60:61], v1 offset:6976
    v_mfma_f32_32x32x16_bf16 v[110:125], v[74:77], v[10:13], v[110:125]
    ds_read_b64_tr_b16 v[62:63], v1 offset:3200
    ds_read_b64_tr_b16 v[64:65], v1 offset:7040
    s_waitcnt vmcnt(6) lgkmcnt(0)
    s_barrier
    v_mfma_f32_32x32x16_bf16 v[78:93], v[54:57], v[14:17], v[78:93]
    v_add_u32 v127, s89, v4
    ds_read_b64_tr_b16 v[66:67], v127 offset:0
    ds_read_b64_tr_b16 v[68:69], v127 offset:1536
    v_mfma_f32_32x32x16_bf16 v[94:109], v[58:61], v[14:17], v[94:109]
    ds_read_b64_tr_b16 v[70:71], v127 offset:64
    ds_read_b64_tr_b16 v[72:73], v127 offset:1600
    v_mfma_f32_32x32x16_bf16 v[110:125], v[62:65], v[14:17], v[110:125]
    ds_read_b64_tr_b16 v[74:75], v127 offset:128
    ds_read_b64_tr_b16 v[76:77], v127 offset:1664
    v_add_u32 v1, s89, v3
    s_waitcnt vmcnt(5) lgkmcnt(0)
    v_mfma_f32_32x32x16_bf16 v[78:93], v[66:69], v[18:21], v[78:93]
    ds_read_b64_tr_b16 v[54:55], v127 offset:3840
    ds_read_b64_tr_b16 v[56:57], v127 offset:5376
    v_mfma_f32_32x32x16_bf16 v[94:109], v[70:73], v[18:21], v[94:109]
    ds_read_b64_tr_b16 v[58:59], v127 offset:3904
    ds_read_b64_tr_b16 v[60:61], v127 offset:5440
    v_mfma_f32_32x32x16_bf16 v[110:125], v[74:77], v[18:21], v[110:125]
    ds_read_b64_tr_b16 v[62:63], v127 offset:3968
    ds_read_b64_tr_b16 v[64:65], v127 offset:5504
    s_waitcnt vmcnt(4) lgkmcnt(0)
    v_mfma_f32_32x32x16_bf16 v[78:93], v[54:57], v[22:25], v[78:93]
    ds_read_b64_tr_b16 v[66:67], v127 offset:7680
    ds_read_b64_tr_b16 v[68:69], v127 offset:9216
    v_mfma_f32_32x32x16_bf16 v[94:109], v[58:61], v[22:25], v[94:109]
    ds_read_b64_tr_b16 v[70:71], v127 offset:7744
    ds_read_b64_tr_b16 v[72:73], v127 offset:9280
    v_mfma_f32_32x32x16_bf16 v[110:125], v[62:65], v[22:25], v[110:125]
    ds_read_b64_tr_b16 v[74:75], v127 offset:7808
    ds_read_b64_tr_b16 v[76:77], v127 offset:9344
    s_waitcnt vmcnt(3) lgkmcnt(0)
    v_mfma_f32_32x32x16_bf16 v[78:93], v[66:69], v[26:29], v[78:93]
    ds_read_b64_tr_b16 v[54:55], v127 offset:11520
    ds_read_b64_tr_b16 v[56:57], v127 offset:13056
    v_mfma_f32_32x32x16_bf16 v[94:109], v[70:73], v[26:29], v[94:109]
    ds_read_b64_tr_b16 v[58:59], v127 offset:11584
    ds_read_b64_tr_b16 v[60:61], v127 offset:13120
    v_mfma_f32_32x32x16_bf16 v[110:125], v[74:77], v[26:29], v[110:125]
    ds_read_b64_tr_b16 v[62:63], v127 offset:11648
    ds_read_b64_tr_b16 v[64:65], v127 offset:13184
    s_waitcnt vmcnt(2) lgkmcnt(0)
    v_mfma_f32_32x32x16_bf16 v[78:93], v[54:57], v[30:33], v[78:93]
    ds_read_b64_tr_b16 v[66:67], v1 offset:3072
    ds_read_b64_tr_b16 v[68:69], v1 offset:6912
    v_mfma_f32_32x32x16_bf16 v[94:109], v[58:61], v[30:33], v[94:109]
    ds_read_b64_tr_b16 v[70:71], v1 offset:3136
    ds_read_b64_tr_b16 v[72:73], v1 offset:6976
    v_mfma_f32_32x32x16_bf16 v[110:125], v[62:65], v[30:33], v[110:125]
    ds_read_b64_tr_b16 v[74:75], v1 offset:3200
    ds_read_b64_tr_b16 v[76:77], v1 offset:7040
    s_waitcnt vmcnt(0) lgkmcnt(0)
    v_mfma_f32_32x32x16_bf16 v[78:93], v[66:69], v[34:37], v[78:93]
    v_mfma_f32_32x32x16_bf16 v[94:109], v[70:73], v[34:37], v[94:109]
    v_mfma_f32_32x32x16_bf16 v[110:125], v[74:77], v[34:37], v[110:125]
    s_and_b32 s24, s20, 1
    s_mul_i32 s24, s24, 12288
    s_add_u32 s24, s24, 46080
    s_mul_i32 s25, s7, 6144
    s_add_u32 s26, s24, s25
    s_xor_b32 s25, s25, 6144
    s_add_u32 s27, s24, s25
    v_add_u32 v5, s26, v2
    v_add_u32 v3, s27, v2
    s_nop 7
    s_cmp_eq_u32 s7, 0
    s_cbranch_scc0 fr_r1
    ds_write_b128 v5, v[86:89] offset:0
    ds_write_b128 v5, v[90:93] offset:1024
    ds_write_b128 v5, v[102:105] offset:2048
    ds_write_b128 v5, v[106:109] offset:3072
    ds_write_b128 v5, v[118:121] offset:4096
    ds_write_b128 v5, v[122:125] offset:5120
    s_waitcnt lgkmcnt(0)
    s_barrier
    ds_read_b128 v[6:9], v3 offset:0
    ds_read_b128 v[10:13], v3 offset:1024
    ds_read_b128 v[14:17], v3 offset:2048
    ds_read_b128 v[18:21], v3 offset:3072
    ds_read_b128 v[22:25], v3 offset:4096
    ds_read_b128 v[26:29], v3 offset:5120
    s_waitcnt lgkmcnt(4)
    v_add_f32 v78, v78, v6
    v_add_f32 v79, v79, v7
    v_add_f32 v80, v80, v8
    v_add_f32 v81, v81, v9
    v_add_f32 v82, v82, v10
    v_add_f32 v83, v83, v11
    v_add_f32 v84, v84, v12
    v_add_f32 v85, v85, v13
    v_cvt_pk_bf16_f32 v54, v78, v79
    v_cvt_pk_bf16_f32 v55, v80, v81
    v_cvt_pk_bf16_f32 v56, v82, v83
    v_cvt_pk_bf16_f32 v57, v84, v85
    s_nop 1
    v_permlane32_swap_b32 v54, v56
    v_permlane32_swap_b32 v55, v57
    s_nop 1
    buffer_store_dwordx4 v[54:57], v126, s[16:19], s85 offen offset:0 nt
    s_waitcnt lgkmcnt(2)
    v_add_f32 v94, v94, v14
    v_add_f32 v95, v95, v15
    v_add_f32 v96, v96, v16
    v_add_f32 v97, v97, v17
    v_add_f32 v98, v98, v18
    v_add_f32 v99, v99, v19
    v_add_f32 v100, v100, v20
    v_add_f32 v101, v101, v21
    v_cvt_pk_bf16_f32 v58, v94, v95
    v_cvt_pk_bf16_f32 v59, v96, v97
    v_cvt_pk_bf16_f32 v60, v98, v99
    v_cvt_pk_bf16_f32 v61, v100, v101
    s_nop 1
    v_permlane32_swap_b32 v58, v60
    v_permlane32_swap_b32 v59, v61
    s_nop 1
    buffer_store_dwordx4 v[58:61], v126, s[16:19], s85 offen offset:64 nt
    s_cmp_eq_u32 s43, 6
    s_cbranch_scc1 fr_end
    s_waitcnt lgkmcnt(0)
    v_add_f32 v110, v110, v22
    v_add_f32 v111, v111, v23
    v_add_f32 v112, v112, v24
    v_add_f32 v113, v113, v25
    v_add_f32 v114, v114, v26
    v_add_f32 v115, v115, v27
    v_add_f32 v116, v116, v28
    v_add_f32 v117, v117, v29
    v_cvt_pk_bf16_f32 v62, v110, v111
    v_cvt_pk_bf16_f32 v63, v112, v113
    v_cvt_pk_bf16_f32 v64, v114, v115
    v_cvt_pk_bf16_f32 v65, v116, v117
    s_nop 1
    v_permlane32_swap_b32 v62, v64
    v_permlane32_swap_b32 v63, v65
    s_nop 1
    buffer_store_dwordx4 v[62:65], v126, s[16:19], s85 offen offset:128 nt
    s_branch fr_end
fr_r1:
    ds_write_b128 v5, v[78:81] offset:0
    ds_write_b128 v5, v[82:85] offset:1024
    ds_write_b128 v5, v[94:97] offset:2048
    ds_write_b128 v5, v[98:101] offset:3072
    ds_write_b128 v5, v[110:113] offset:4096
    ds_write_b128 v5, v[114:117] offset:5120
    s_waitcnt lgkmcnt(0)
    s_barrier
    ds_read_b128 v[6:9], v3 offset:0
    ds_read_b128 v[10:13], v3 offset:1024
    ds_read_b128 v[14:17], v3 offset:2048
    ds_read_b128 v[18:21], v3 offset:3072
    ds_read_b128 v[22:25], v3 offset:4096
    ds_read_b128 v[26:29], v3 offset:5120
    s_waitcnt lgkmcnt(4)
    v_add_f32 v86, v86, v6
    v_add_f32 v87, v87, v7
    v_add_f32 v88, v88, v8
    v_add_f32 v89, v89, v9
    v_add_f32 v90, v90, v10
    v_add_f32 v91, v91, v11
    v_add_f32 v92, v92, v12
    v_add_f32 v93, v93, v13
    v_cvt_pk_bf16_f32 v54, v86, v87
    v_cvt_pk_bf16_f32 v55, v88, v89
    v_cvt_pk_bf16_f32 v56, v90, v91
    v_cvt_pk_bf16_f32 v57, v92, v93
    s_nop 1
    v_permlane32_swap_b32 v54, v56
    v_permlane32_swap_b32 v55, v57
    s_nop 1
    buffer_store_dwordx4 v[54:57], v126, s[16:19], s85 offen offset:0 nt
    s_waitcnt lgkmcnt(2)
    v_add_f32 v102, v102, v14
    v_add_f32 v103, v103, v15
    v_add_f32 v104, v104, v16
    v_add_f32 v105, v105, v17
    v_add_f32 v106, v106, v18
    v_add_f32 v107, v107, v19
    v_add_f32 v108, v108, v20
    v_add_f32 v109, v109, v21
    v_cvt_pk_bf16_f32 v58, v102, v103
    v_cvt_pk_bf16_f32 v59, v104, v105
    v_cvt_pk_bf16_f32 v60, v106, v107
    v_cvt_pk_bf16_f32 v61, v108, v109
    s_nop 1
    v_permlane32_swap_b32 v58, v60
    v_permlane32_swap_b32 v59, v61
    s_nop 1
    buffer_store_dwordx4 v[58:61], v126, s[16:19], s85 offen offset:64 nt
    s_cmp_eq_u32 s43, 6
    s_cbranch_scc1 fr_end
    s_waitcnt lgkmcnt(0)
    v_add_f32 v118, v118, v22
    v_add_f32 v119, v119, v23
    v_add_f32 v120, v120, v24
    v_add_f32 v121, v121, v25
    v_add_f32 v122, v122, v26
    v_add_f32 v123, v123, v27
    v_add_f32 v124, v124, v28
    v_add_f32 v125, v125, v29
    v_cvt_pk_bf16_f32 v62, v118, v119
    v_cvt_pk_bf16_f32 v63, v120, v121
    v_cvt_pk_bf16_f32 v64, v122, v123
    v_cvt_pk_bf16_f32 v65, v124, v125
    s_nop 1
    v_permlane32_swap_b32 v62, v64
    v_permlane32_swap_b32 v63, v65
    s_nop 1
    buffer_store_dwordx4 v[62:65], v126, s[16:19], s85 offen offset:128 nt
fr_end:
fr_quit:
    s_endpgm
fz_exit:
    s_endpgm
.section .rodata,"a"
.p2align 6
.amdhsa_kernel fz_kernel
  .amdhsa_next_free_vgpr 128
  .amdhsa_next_free_sgpr 96
  .amdhsa_accum_offset 128
  .amdhsa_group_segment_fixed_size 0
  .amdhsa_kernarg_size 96
  .amdhsa_user_sgpr_count 2
  .amdhsa_user_sgpr_kernarg_segment_ptr 1
  .amdhsa_system_sgpr_workgroup_id_x 1
.end_amdhsa_kernel
```
